```python
import torch

def _softmax(x, axis=-1):
    return torch.softmax(x, dim=axis)
def _gelu(x):
    return torch.nn.functional.gelu(x, approximate="tanh")
def _silu(x):
    return torch.nn.functional.silu(x)
def _sigmoid(x):
    return torch.sigmoid(x)
def _layernorm(x, axis=-1, eps=1e-5):
    m = x.mean(dim=axis, keepdim=True)
    v = x.var(dim=axis, keepdim=True, unbiased=False)
    return (x - m) / torch.sqrt(v + eps)
def _scatter_add(tgt, idx, src, axis=0):
    return tgt.clone().index_add_(axis, idx, src)
def _segment_sum(src, seg, n):
    out = torch.zeros((n,) + src.shape[1:], dtype=src.dtype)
    return out.index_add_(0, seg, src)
def _pad(x, pw):
    flat = tuple(v for pair in reversed(pw) for v in pair)
    return torch.nn.functional.pad(x, flat)

kernel_name = 'recurrent_scan__linear_attn_block__glu_gated_glu__prompt'

def setup_inputs():

    _w = (lambda a: (lambda t: t.to(torch.bfloat16) if t.is_floating_point() else t)(torch.as_tensor(a)))
    def _A_setup():
        B, S, D = 1, 2048, 512
        return {
            "x": _w((lambda *s: torch.randn(*s, dtype=torch.bfloat16) * 0.05)(B, S, D)),
            "wqkv": _w((lambda *s: torch.randn(*s, dtype=torch.bfloat16) * 0.05)(D, 3 * D)),
            "wo": _w((lambda *s: torch.randn(*s, dtype=torch.bfloat16) * 0.05)(D, D)),
        }
    _A_in = _A_setup()

    def _B_setup():
        B, S, D, F = 1, 2048, 512, 1792
        return {
            "x": _w((lambda *s: torch.randn(*s, dtype=torch.bfloat16) * 0.05)(B, S, D)),
            "w_gate": _w((lambda *s: torch.randn(*s, dtype=torch.bfloat16) * 0.05)(D, F)),
            "w_up": _w((lambda *s: torch.randn(*s, dtype=torch.bfloat16) * 0.05)(D, F)),
            "w_down": _w((lambda *s: torch.randn(*s, dtype=torch.bfloat16) * 0.05)(F, D)),
        }
    _B_in = _B_setup()

    return {
        "A_x": _A_in["x"],
        "A_wqkv": _A_in["wqkv"],
        "A_wo": _A_in["wo"],
        "B_x": _B_in["x"],
        "B_w_gate": _B_in["w_gate"],
        "B_w_up": _B_in["w_up"],
        "B_w_down": _B_in["w_down"],
    }

def reference(A_x, A_wqkv, A_wo, B_x, B_w_gate, B_w_up, B_w_down):
    def _A_ref(x, wqkv, wo):
        B, S, D = x.shape
        H = 32; Dh = D // H
        qkv = (lambda x, *d: x.permute(*d))((x @ wqkv).reshape(B, S, 3, H, Dh), 2, 0, 3, 1, 4)
        q, k, v = qkv[0], qkv[1], qkv[2]
        phi = lambda t: torch.where(t > 0, t + 1, torch.exp(t)) + 1e-6
        pq, pk = phi(q), phi(k)
        kv = torch.einsum("bhsd,bhse->bhde", pk, v)
        z = torch.einsum("bhsd->bhd", pk)
        num = torch.einsum("bhqd,bhde->bhqe", pq, kv)
        den = torch.einsum("bhqd,bhd->bhq", pq, z)[..., None] + 1e-6
        o = num / den
        return (lambda x, *d: x.permute(*d))(o, 0, 2, 1, 3).reshape(B, S, D) @ wo

    def _B_ref(x, w_gate, w_up, w_down):
        g = torch.einsum("bsd,df->bsf", x, w_gate)
        u = torch.einsum("bsd,df->bsf", x, w_up)
        h = _sigmoid(g) * u
        return torch.einsum("bsf,fd->bsd", h, w_down)

    x = A_x
    xn = _layernorm(x, axis=-1)
    s = _A_ref(xn, A_wqkv, A_wo)
    g = _silu(_B_ref(xn, B_w_gate, B_w_up, B_w_down))
    return x + s * g
```

```asm
; @launch grid=(256,1,1) block=(256,1,1) lds=163840
.amdgcn_target "amdgcn-amd-amdhsa--gfx950"
.text
.globl recurrent_scan__linear_attn_block__glu_gated_glu__prompt_kernel
.p2align 8
.type recurrent_scan__linear_attn_block__glu_gated_glu__prompt_kernel,@function
recurrent_scan__linear_attn_block__glu_gated_glu__prompt_kernel:
    s_load_dwordx16 s[4:19], s[0:1], 0
    s_load_dwordx2 s[22:23], s[0:1], 72
    s_cmp_ge_u32 s2, 256
    s_cbranch_scc1 L_exit
    v_lshrrev_b32 v3, 6, v0
    v_and_b32 v1, 63, v0
    v_readfirstlane_b32 s60, v3
    s_lshr_b32 s75, s2, 3
    s_getpc_b64 s[98:99]
    s_lshl_b32 s76, s75, 2
    s_add_u32 s76, s76, s60
    s_mul_i32 s76, s76, 384
    v_min_u32 v3, 2, v1
    v_lshl_add_u32 v3, v3, 7, s76
    v_min_u32 v3, L_codeend-recurrent_scan__linear_attn_block__glu_gated_glu__prompt_kernel-256, v3
    global_load_dword v255, v3, s[98:99]
    s_lshl_b32 s71, s60, 12
    s_and_b32 s63, s2, 1
    s_lshl_b32 s63, s63, 3
    s_and_b32 s76, s75, 7
    s_or_b32 s63, s63, s76
    s_and_b32 s64, s2, 6
    s_bfe_u32 s76, s75, 0x10003
    s_or_b32 s64, s64, s76
    s_xor_b32 s95, s76, s75
    s_and_b32 s95, s95, 1
    v_lshrrev_b32 v64, 3, v1
    v_and_b32 v65, 7, v1
    v_lshrrev_b32 v66, 4, v1
    v_xor_b32 v67, v65, v66
    v_lshlrev_b32 v67, 4, v67
    v_lshl_add_u32 v4, v64, 10, v67
    v_xor_b32 v5, 64, v4
    v_add_u32 v5, 7168, v5
    v_add_u32 v6, 14336, v4
    v_add_u32 v7, 14336, v5
    v_lshrrev_b32 v68, 5, v1
    v_and_b32 v69, 31, v1
    v_lshlrev_b32 v69, 4, v69
    v_lshl_add_u32 v69, v68, 10, v69
    s_lshr_b32 s77, s75, 4
    s_lshl_b32 s77, s77, 3
    s_add_u32 s77, s77, s64
    s_lshl_b32 s77, s77, 2
    s_add_u32 s77, s77, s60
    s_lshl_b32 s77, s77, 1
    s_lshl_b32 s78, s63, 7
    s_add_u32 s77, s77, s78
    s_lshl_b32 s74, s77, 10
    s_lshl_b32 s78, s63, 7
    s_lshl_b32 s69, s60, 5
    s_add_u32 s69, s69, s78
    s_lshl_b32 s69, s69, 10
    s_lshl_b32 s78, s95, 9
    s_add_u32 s69, s69, s78
    s_mov_b32 s26, 0x200000
    s_mov_b32 s27, 0x20000
    s_mov_b32 s43, 0x20000
    s_mov_b32 s55, 0x20000
    s_lshl_b32 s3, s60, 12
    s_mov_b32 m0, s3
    s_cmp_ge_u32 s75, 16
    s_waitcnt lgkmcnt(0)
    s_mov_b64 s[24:25], s[4:5]
    buffer_load_dwordx4 v[72:75], v69, s[24:27], s74 offen
    buffer_load_dwordx4 v[76:79], v69, s[24:27], s74 offen offset:512
    buffer_load_dwordx4 v4, s[24:27], s69 offen offset:0 lds
    buffer_load_dwordx4 v5, s[24:27], s69 offen offset:1024 lds
    buffer_load_dwordx4 v6, s[24:27], s69 offen offset:2048 lds
    buffer_load_dwordx4 v7, s[24:27], s69 offen offset:3072 lds
    s_lshl_b32 s70, s64, 7
    s_add_u32 s78, s70, 1024
    s_mul_i32 s70, s70, 3
    s_movk_i32 s20, 3072
    s_mov_b32 s42, 1572864
    s_cmp_ge_u32 s75, 16
    s_cselect_b32 s20, 3584, s20
    s_cselect_b32 s21, 0, 1024
    s_cselect_b32 s70, s70, s78
    s_cselect_b32 s42, 1835008, s42
    s_lshl_b32 s78, s95, 4
    s_add_u32 s78, s78, s60
    s_lshl_b32 s78, s78, 4
    s_mul_i32 s78, s78, s20
    s_add_u32 s70, s70, s78
    v_and_b32 v66, 1, v66
    v_lshlrev_b32 v66, 2, v66
    v_xor_b32 v66, v66, v65
    v_lshlrev_b32 v66, 4, v66
    v_mad_u32_u24 v8, v64, s20, v66
    s_lshl_b32 s78, s20, 3
    s_sub_u32 s78, s78, 1024
    v_add_u32 v9, s78, v8
    v_xor_b32 v10, 32, v8
    v_add_u32 v10, s21, v10
    v_add_u32 v11, s78, v10
    s_mov_b32 s54, s42
    s_cmp_ge_u32 s75, 16
    s_cselect_b64 s[40:41], s[12:13], s[6:7]
    s_cselect_b64 s[52:53], s[14:15], s[6:7]
    s_add_u32 m0, s3, 16384
    s_load_dword s66, s[22:23], 0
    buffer_load_dwordx4 v8, s[40:43], s70 offen offset:0 lds
    buffer_load_dwordx4 v9, s[40:43], s70 offen offset:1024 lds
    s_add_u32 m0, s3, 18432
    s_add_u32 s69, s69, 128
    buffer_load_dwordx4 v10, s[52:55], s70 offen offset:0 lds
    buffer_load_dwordx4 v11, s[52:55], s70 offen offset:1024 lds
    s_lshl_b32 s78, s20, 6
    s_add_u32 s70, s70, s78
    s_mov_b32 s1, s95
    s_lshl_b32 s77, s77, 3
    s_add_u32 s3, s77, 4096
    v_lshlrev_b32 v2, 4, v1
    s_lshr_b32 s61, s60, 1
    s_and_b32 s62, s60, 1
    s_and_b32 s76, s2, 1
    s_lshl_b32 s76, s76, 5
    s_add_u32 s76, s76, s75
    s_and_b32 s91, s2, 6
    s_cmp_ge_u32 s76, 16
    s_cselect_b32 s87, 8, 0
    s_cmp_ge_u32 s76, 48
    s_cselect_b32 s87, 16, s87
    s_sub_u32 s87, s76, s87
    s_and_b32 s90, s76, 24
    s_cmp_eq_u32 s90, 8
    s_cselect_b32 s87, 63, s87
    s_max_u32 s90, s91, 2
    s_lshl_b32 s90, s90, 1
    s_add_u32 s90, s90, s76
    s_sub_u32 s90, s90, 16
    s_cmp_ge_u32 s76, 60
    s_cselect_b32 s90, s90, s76
    s_cselect_b32 s88, 2, s91
    s_cmp_eq_u32 s91, 2
    s_cselect_b32 s76, s87, s90
    s_cselect_b32 s91, 2, s88
    s_mul_i32 s89, s76, 43691
    s_lshr_b32 s89, s89, 17
    s_mul_i32 s86, s89, 3
    s_sub_u32 s76, s76, s86
    s_lshr_b32 s87, s89, 1
    s_add_u32 s87, s87, 1
    s_cmp_eq_u32 s87, 3
    s_cselect_b32 s87, 0, s87
    s_lshl_b32 s87, s87, 3
    s_mov_b32 s90, s91
    s_add_u32 s87, s87, s90
    s_and_b32 s88, s89, 1
    s_add_u32 s87, s87, s88
    s_cmp_ge_u32 s89, 13
    s_cselect_b32 s88, 13, 6
    s_cselect_b32 s86, 52, 24
    s_cselect_b64 s[56:57], s[14:15], s[12:13]
    s_sub_u32 s88, s89, s88
    s_mul_i32 s84, s90, 3
    s_add_u32 s84, s84, s88
    s_lshr_b32 s90, s90, 1
    s_add_u32 s90, s90, 24
    s_cmp_eq_u32 s88, 6
    s_cselect_b32 s90, s90, s84
    s_add_u32 s88, s86, s90
    s_cmp_lt_u32 s89, 6
    s_mov_b32 s58, 1835008
    s_cselect_b32 s58, 1572864, s58
    s_cselect_b64 s[56:57], s[6:7], s[56:57]
    s_cselect_b32 s88, s87, s88
    s_cselect_b32 s90, s87, s90
    s_movk_i32 s87, 3584
    s_cselect_b32 s87, 3072, s87
    s_mov_b32 s59, 0x20000
    s_lshl_b32 s85, s87, 3
    s_lshl_b32 s84, s76, 2
    s_add_u32 s84, s84, s60
    s_mul_i32 s84, s84, 6
    s_mul_i32 s84, s84, s85
    s_lshl_b32 s90, s90, 7
    s_add_u32 s84, s84, s90
    s_lshl_b32 s86, s88, 11
    s_lshl_b32 s76, s76, 3
    s_add_u32 s86, s86, s76
    s_add_u32 s86, s86, 65536
    s_cmp_lg_u32 s60, 0
    s_cselect_b32 s86, 1073741824, s86
    s_cmp_ge_u32 s89, 20
    s_cselect_b32 s86, 1073741824, s86
    s_cselect_b32 s84, 1073741824, s84
    s_mov_b32 s90, 74319
    s_lshr_b32 s90, s90, s89
    s_and_b32 s90, s90, 1
    s_cmp_eq_u32 s90, 0
    s_cselect_b32 s94, s84, 1073741824
    s_cselect_b32 s84, 1073741824, s84
    v_lshlrev_b32 v83, 4, v65
    v_mad_u32_u24 v83, v64, s87, v83
    s_cmp_ge_u32 s84, 1073741824
    s_cselect_b32 s72, 2, 0
    s_cmp_ge_u32 s94, 1073741824
    s_cselect_b32 s90, 4, 0
    s_or_b32 s72, s72, s90
    s_bitcmp1_b32 s72, 1
    s_cbranch_scc1 L_sk_1
    buffer_load_dwordx4 v[24:27], v83, s[56:59], s84 offen
    s_add_u32 s84, s84, s85
    buffer_load_dwordx4 v[28:31], v83, s[56:59], s84 offen
    s_add_u32 s84, s84, s85
    buffer_load_dwordx4 v[32:35], v83, s[56:59], s84 offen
    s_add_u32 s84, s84, s85
    buffer_load_dwordx4 v[36:39], v83, s[56:59], s84 offen
    s_add_u32 s84, s84, s85
    buffer_load_dwordx4 v[40:43], v83, s[56:59], s84 offen
    s_add_u32 s84, s84, s85
    buffer_load_dwordx4 v[44:47], v83, s[56:59], s84 offen
L_sk_1:
    s_mov_b64 s[44:45], s[56:57]
    s_mov_b32 s46, s58
    s_mov_b32 s47, 0x20000
    s_lshl_b32 s96, s60, 8
    s_add_u32 s96, s96, s2
    s_lshr_b32 s97, s16, 7
    s_sub_u32 s97, 3, s97
    s_and_b32 s97, s97, 7
    s_sub_u32 s76, s96, 224
    s_cmp_lt_u32 s96, 224
    s_cselect_b64 s[56:57], s[16:17], s[8:9]
    s_cselect_b32 s76, s96, s76
    s_mov_b32 s58, 524288
    s_cselect_b32 s58, 1835008, s58
    s_lshl_b32 s76, s76, 13
    s_lshl_b32 s78, s97, 7
    s_add_u32 s76, s76, s78
    v_bfe_u32 v125, v1, 4, 2
    v_lshlrev_b32 v125, 1, v125
    v_xor_b32 v125, v125, v65
    v_lshlrev_b32 v125, 4, v125
    v_lshl_add_u32 v125, v64, 10, v125
    s_cmp_ge_u32 s96, 288
    s_cselect_b32 s78, 1, 0
    s_or_b32 s72, s72, s78
    s_bitcmp1_b32 s72, 0
    s_cbranch_scc1 L_sk_2
    buffer_load_dwordx4 v[84:87], v125, s[56:59], s76 offen
L_sk_2:
    s_mov_b64 s[28:29], s[6:7]
    s_mov_b32 s30, 1572864
    s_mov_b32 s31, 0x20000
    s_mov_b64 s[32:33], s[12:13]
    s_mov_b32 s34, 1835008
    s_mov_b32 s35, 0x20000
    s_mov_b64 s[36:37], s[14:15]
    s_mov_b32 s38, 1835008
    s_mov_b32 s39, 0x20000
    s_mov_b64 s[48:49], s[22:23]
    s_mov_b32 s50, 1900544
    s_mov_b32 s51, 0x20000
    s_cmp_eq_u32 s60, 0
    s_cselect_b64 s[40:41], s[8:9], s[16:17]
    s_mov_b32 s42, 1835008
    s_cselect_b32 s42, 524288, s42
    s_cselect_b32 s77, 1, s60
    s_cselect_b64 s[16:17], -1, 1
    s_sub_u32 s77, s77, 1
    s_mul_i32 s77, s77, 19
    s_add_u32 s52, s22, 2097152
    s_addc_u32 s53, s23, 0
    s_mov_b32 s54, 9437184
    s_and_b32 s67, s2, 7
    s_lshl_b32 s67, s67, 1
    s_lshr_b32 s78, s75, 4
    s_xor_b32 s78, s78, s75
    s_and_b32 s78, s78, 1
    s_or_b32 s67, s67, s78
    s_lshl_b32 s67, s67, 1
    s_bfe_u32 s78, s75, 0x10003
    s_or_b32 s67, s67, s78
    s_and_b32 s68, s75, 7
    s_cmp_eq_u32 s60, 3
    s_cselect_b32 s76, 18, 19
    s_cselect_b32 s13, 1073741824, 0
    s_cmp_eq_u32 s60, 0
    s_cselect_b32 s76, 16, s76
    s_cselect_b32 s12, 1073741824, 0
    s_cselect_b32 s88, 56, s77
    s_or_b32 s13, s13, s12
    s_bfe_u32 s78, s75, 0x10003
    s_mul_i32 s8, s76, s78
    s_sub_u32 s76, s76, 9
    s_mul_i32 s76, s76, s78
    s_lshl_b32 s9, s8, 12
    s_add_u32 s88, s88, s76
    s_mov_b32 s89, s88
    s_lshl_b32 s88, s88, 12
    s_mul_i32 s78, s67, 294912
    s_add_u32 s88, s88, s78
    s_add_u32 s87, s77, s76
    s_lshl_b32 s87, s87, 15
    s_lshl_b32 s78, s68, 7
    s_add_u32 s87, s87, s78
    s_mov_b32 s7, 32768
    s_movk_i32 s14, 7168
    s_lshl_b32 s89, s89, 12
    s_add_u32 s20, s22, 1048576
    s_addc_u32 s21, s23, 0
    s_cmp_eq_u32 s68, s97
    s_cselect_b64 s[56:57], s[20:21], s[40:41]
    s_cselect_b32 s58, 294912, s42
    s_cselect_b32 s87, s89, s87
    s_cselect_b32 s7, 4096, s7
    s_cselect_b32 s14, 0, s14
    s_cselect_b64 vcc, -1, 0
    s_cselect_b32 s97, -1, 0
    v_cndmask_b32 v125, v125, v2, vcc
    s_lshl_b32 s6, s96, 10
    s_add_u32 s6, s6, 1048576
    s_cmp_lt_u32 s96, 288
    s_cselect_b64 s[4:5], -1, 1
    s_cselect_b32 s6, s6, 1073741824
    s_cselect_b32 s96, s96, 268435456
    s_lshl_b32 s96, s96, 2
    s_add_u32 s96, s96, 40960
    s_mul_i32 s8, s8, s7
    s_lshl_b32 s90, s67, 8
    s_add_u32 s77, s90, 20608
    s_add_u32 s90, s90, 28672
    s_cmp_eq_u32 s60, 0
    s_cselect_b32 s90, s77, s90
    s_lshl_b32 s76, s63, 1
    s_add_u32 s76, s76, s61
    s_mul_i32 s73, s76, 294912
    s_lshl_b32 s74, s76, 5
    s_lshl_b32 s77, s64, 1
    s_add_u32 s77, s77, s62
    s_add_u32 s74, s74, s77
    s_and_b32 s78, s75, 16
    s_add_u32 s74, s74, s78
    s_lshl_b32 s74, s74, 3
    s_lshl_b32 s77, s77, 1
    s_add_u32 s91, s77, s61
    v_lshrrev_b32 v23, 5, v1
    v_and_b32 v21, 31, v1
    v_lshlrev_b32 v21, 5, v21
    v_lshl_add_u32 v21, v23, 4, v21
    v_and_b32 v19, 0x1ff, v21
    v_bfe_u32 v80, v1, 4, 1
    v_mul_u32_u24 v80, 57344, v80
    v_add_u32 v19, v19, v80
    s_lshl_b32 s76, s76, 9
    s_add_u32 s76, s76, 4096
    v_lshl_add_u32 v18, v1, 3, s76
    v_bfe_u32 v0, v1, 2, 2
    v_lshrrev_b32 v3, 5, v1
    v_lshl_add_u32 v0, v3, 3, v0
    v_lshlrev_b32 v120, 7, v0
    v_and_b32 v0, 2, v0
    v_bfe_u32 v3, v1, 4, 1
    v_xor_b32 v0, v0, v3
    v_lshl_add_u32 v120, v3, 11, v120
    s_lshl_b32 s0, s62, 1
    v_xor_b32 v0, s0, v0
    v_lshl_add_u32 v120, v0, 5, v120
    v_and_b32 v0, 3, v1
    v_lshl_add_u32 v120, v0, 3, v120
    v_bfe_u32 v0, v1, 2, 3
    v_lshrrev_b32 v3, 5, v1
    v_lshl_add_u32 v3, v3, 4, v0
    v_lshlrev_b32 v122, 7, v3
    v_lshrrev_b32 v0, 1, v0
    v_lshl_add_u32 v122, v0, 5, v122
    v_and_b32 v0, 3, v1
    v_lshl_add_u32 v122, v0, 3, v122
    v_add_u32 v122, s71, v122
    v_and_b32 v12, 31, v1
    s_lshl_b32 s78, s61, 6
    v_add_u32 v12, s78, v12
    v_lshlrev_b32 v12, 7, v12
    v_lshrrev_b32 v80, 5, v1
    v_bfe_u32 v13, v1, 1, 3
    v_xor_b32 v80, v80, v13
    v_lshl_add_u32 v12, v80, 4, v12
    v_xor_b32 v13, 32, v12
    v_xor_b32 v14, 64, v12
    v_xor_b32 v15, 96, v12
    s_mul_i32 s78, s2, 3
    s_add_u32 s78, s78, s60
    s_sub_u32 s78, s78, 1
    s_mul_i32 s78, s78, 19
    s_lshl_b32 s0, s2, 4
    s_cmp_eq_u32 s60, 0
    s_cselect_b32 s78, s0, s78
    s_cselect_b32 s0, 15, 18
    v_min_u32 v23, s0, v1
    v_add_u32 v23, s78, v23
    v_lshlrev_b32 v23, 7, v23
    s_cmp_ge_u32 s75, 16
    s_cbranch_scc1 L_typeQ
    s_lshl_b32 s79, s64, 11
    s_lshl_b32 s76, s62, 10
    s_add_u32 s79, s79, s76
    s_add_u32 s80, s79, 98304
    s_add_u32 s79, s79, 81920
    s_mul_i32 s81, s64, 6144
    s_add_u32 s81, s81, s76
    s_add_u32 s81, s81, 118784
    s_add_u32 s82, s81, 512
    s_lshr_b32 s83, s64, 1
    s_lshl_b32 s83, s83, 11
    s_and_b32 s76, s64, 1
    s_lshl_b32 s76, s76, 1
    s_add_u32 s76, s76, s62
    s_lshl_b32 s76, s76, 9
    s_add_u32 s83, s83, s76
    s_add_u32 s83, s83, 163840
    s_lshl_b32 s91, s91, 4
    s_add_u32 s91, s91, s63
    s_lshl_b32 s92, s91, 3
    s_add_u32 s92, s92, 36864
    s_mul_i32 s91, s91, 640
    s_add_u32 s91, s91, 262144
    v_mul_u32_u24 v123, 3584, v64
    v_add_u32 v123, v123, v66
    v_and_b32 v80, 3, v1
    v_lshlrev_b32 v80, 4, v80
    v_lshrrev_b32 v124, 2, v1
    v_mul_u32_u24 v124, 3584, v124
    v_add_u32 v124, v124, v80
    s_mov_b32 s10, 0xffff0000
    s_mov_b32 s11, 0xffff0000
    v_bfe_u32 v0, v1, 2, 2
    v_lshrrev_b32 v3, 5, v1
    v_lshl_add_u32 v0, v3, 3, v0
    v_lshlrev_b32 v16, 7, v0
    v_and_b32 v0, 2, v0
    v_bfe_u32 v3, v1, 4, 1
    v_xor_b32 v0, v0, v3
    s_lshl_b32 s0, s62, 1
    v_xor_b32 v0, s0, v0
    v_lshl_add_u32 v16, v0, 5, v16
    v_and_b32 v0, 3, v1
    v_lshl_add_u32 v16, v0, 3, v16
    v_add_u32 v16, 16384, v16
    v_xor_b32 v17, 32, v16
    v_add_u32 v17, 2048, v17
    v_bfe_u32 v0, v1, 2, 2
    v_lshrrev_b32 v3, 5, v1
    v_lshl_add_u32 v0, v3, 3, v0
    v_lshlrev_b32 v121, 6, v0
    v_bfe_u32 v0, v1, 4, 1
    v_lshl_add_u32 v121, v0, 11, v121
    v_xor_b32 v0, s62, v0
    v_lshl_add_u32 v121, v0, 5, v121
    v_and_b32 v0, 3, v1
    v_lshl_add_u32 v121, v0, 3, v121
    v_mov_b32 v60, 0x3f803f80
    v_mov_b32 v61, 0x3f803f80
    v_mov_b32 v62, 0x3f803f80
    v_mov_b32 v63, 0x3f803f80
    s_add_u32 m0, s71, 32768
    s_nop 0
    buffer_load_dwordx4 v4, s[24:27], s69 offen offset:0 lds
    buffer_load_dwordx4 v5, s[24:27], s69 offen offset:1024 lds
    buffer_load_dwordx4 v6, s[24:27], s69 offen offset:2048 lds
    buffer_load_dwordx4 v7, s[24:27], s69 offen offset:3072 lds
    s_add_u32 s69, s69, 128
    v_mov_b32 v64, 0
    v_mov_b32 v65, 0
    v_mov_b32 v66, 0x3f803f80
    s_bitcmp1_b32 s72, 0
    s_cbranch_scc1 L_wc_4
    s_bitcmp1_b32 s72, 1
    s_cbranch_scc1 L_wc_5
    s_waitcnt vmcnt(19)
    s_branch L_we_3
L_wc_5:
    s_waitcnt vmcnt(13)
    s_branch L_we_3
L_wc_4:
    s_bitcmp1_b32 s72, 1
    s_cbranch_scc1 L_wc_6
    s_waitcnt vmcnt(18)
    s_branch L_we_3
L_wc_6:
    s_waitcnt vmcnt(12)
L_we_3:
    v_dot2c_f32_bf16 v64, v72, v66
    v_dot2c_f32_bf16 v65, v72, v72
    v_dot2c_f32_bf16 v64, v73, v66
    v_dot2c_f32_bf16 v65, v73, v73
    v_dot2c_f32_bf16 v64, v74, v66
    v_dot2c_f32_bf16 v65, v74, v74
    v_dot2c_f32_bf16 v64, v75, v66
    v_dot2c_f32_bf16 v65, v75, v75
    v_dot2c_f32_bf16 v64, v76, v66
    v_dot2c_f32_bf16 v65, v76, v76
    v_dot2c_f32_bf16 v64, v77, v66
    v_dot2c_f32_bf16 v65, v77, v77
    v_dot2c_f32_bf16 v64, v78, v66
    v_dot2c_f32_bf16 v65, v78, v78
    v_dot2c_f32_bf16 v64, v79, v66
    v_dot2c_f32_bf16 v65, v79, v79
    s_nop 1
    v_add_f32 v64, v64, v64 row_shr:1 row_mask:0xf bank_mask:0xf bound_ctrl:1
    v_add_f32 v65, v65, v65 row_shr:1 row_mask:0xf bank_mask:0xf bound_ctrl:1
    s_nop 0
    v_add_f32 v64, v64, v64 row_shr:2 row_mask:0xf bank_mask:0xf bound_ctrl:1
    v_add_f32 v65, v65, v65 row_shr:2 row_mask:0xf bank_mask:0xf bound_ctrl:1
    s_nop 0
    v_add_f32 v64, v64, v64 row_shr:4 row_mask:0xf bank_mask:0xf bound_ctrl:1
    v_add_f32 v65, v65, v65 row_shr:4 row_mask:0xf bank_mask:0xf bound_ctrl:1
    s_nop 0
    v_add_f32 v64, v64, v64 row_shr:8 row_mask:0xf bank_mask:0xf bound_ctrl:1
    v_add_f32 v65, v65, v65 row_shr:8 row_mask:0xf bank_mask:0xf bound_ctrl:1
    s_nop 0
    v_add_f32 v64, v64, v64 row_bcast:15 row_mask:0xa bank_mask:0xf
    v_add_f32 v65, v65, v65 row_bcast:15 row_mask:0xa bank_mask:0xf
    v_mul_f32 v64, 0x3b000000, v64
    v_mul_f32 v65, 0x3b000000, v65
    v_fma_f32 v65, -v64, v64, v65
    v_max_f32 v65, 0, v65
    v_cvt_pk_bf16_f32 v66, v64, v65
    v_and_b32 v65, 0xffff0000, v66
    v_add_f32 v65, 0x3727c5ac, v65
    v_cvt_pk_bf16_f32 v65, v65, v65
    v_and_b32 v65, 0xffff0000, v65
    v_sqrt_f32 v65, v65
    s_mov_b32 s78, 0xffff
    v_cvt_pk_bf16_f32 v65, v65, v65
    v_lshlrev_b32 v68, 3, v68
    v_bfi_b32 v66, s78, v66, v65
    s_waitcnt lgkmcnt(0)
    s_mul_i32 s66, s66, 0x9E3779B1
    s_add_u32 s66, s66, 0x7F4A7C15
    s_and_b32 s65, s66, 0xBFFFBFFF
    v_mov_b32 v67, s65
    s_mov_b32 exec_lo, 0x80000000
    s_mov_b32 exec_hi, 0x80000000
    buffer_store_dwordx2 v[66:67], v68, s[48:51], s3 offen sc1
    s_mov_b64 exec, -1
    s_add_u32 m0, s71, 49152
    s_nop 0
    buffer_load_dwordx4 v8, s[28:31], s70 offen offset:0 lds
    buffer_load_dwordx4 v9, s[28:31], s70 offen offset:1024 lds
    s_add_u32 m0, s71, 51200
    s_nop 0
    buffer_load_dwordx4 v10, s[28:31], s70 offen offset:0 lds
    buffer_load_dwordx4 v11, s[28:31], s70 offen offset:1024 lds
    s_add_u32 s70, s70, 196608
    s_bitcmp1_b32 s72, 2
    s_cbranch_scc1 L_sk_7
    buffer_load_dwordx4 v[24:27], v83, s[44:47], s94 offen
    s_add_u32 s94, s94, s85
    buffer_load_dwordx4 v[28:31], v83, s[44:47], s94 offen
    s_add_u32 s94, s94, s85
    buffer_load_dwordx4 v[32:35], v83, s[44:47], s94 offen
    s_add_u32 s94, s94, s85
    buffer_load_dwordx4 v[36:39], v83, s[44:47], s94 offen
    s_add_u32 s94, s94, s85
    buffer_load_dwordx4 v[40:43], v83, s[44:47], s94 offen
    s_add_u32 s94, s94, s85
    buffer_load_dwordx4 v[44:47], v83, s[44:47], s94 offen
L_sk_7:
    s_mov_b64 s[44:45], s[18:19]
    s_mov_b32 s46, 0x200000
    s_bitcmp1_b32 s72, 0
    s_cbranch_scc1 L_wc_9
    s_bitcmp1_b32 s72, 1
    s_cbranch_scc1 L_wc_10
    s_bitcmp1_b32 s72, 2
    s_cbranch_scc1 L_wc_11
    s_waitcnt vmcnt(22)
    s_branch L_we_8
L_wc_11:
    s_waitcnt vmcnt(16)
    s_branch L_we_8
L_wc_10:
    s_bitcmp1_b32 s72, 2
    s_cbranch_scc1 L_wc_12
    s_waitcnt vmcnt(16)
    s_branch L_we_8
L_wc_12:
    s_waitcnt vmcnt(10)
    s_branch L_we_8
L_wc_9:
    s_bitcmp1_b32 s72, 1
    s_cbranch_scc1 L_wc_13
    s_bitcmp1_b32 s72, 2
    s_cbranch_scc1 L_wc_14
    s_waitcnt vmcnt(21)
    s_branch L_we_8
L_wc_14:
    s_waitcnt vmcnt(15)
    s_branch L_we_8
L_wc_13:
    s_bitcmp1_b32 s72, 2
    s_cbranch_scc1 L_wc_15
    s_waitcnt vmcnt(15)
    s_branch L_we_8
L_wc_15:
    s_waitcnt vmcnt(9)
L_we_8:
    s_barrier
    ds_read_b128 a[0:3], v12
    ds_read_b64_tr_b16 v[96:97], v16 offset:0
    ds_read_b64_tr_b16 v[98:99], v16 offset:512
    ds_read_b128 a[4:7], v12 offset:4096
    v_add_u32 v12, 0x8000, v12
    ds_read_b64_tr_b16 v[100:101], v17 offset:0
    ds_read_b64_tr_b16 v[102:103], v17 offset:512
    ds_read_b128 a[8:11], v13
    ds_read_b64_tr_b16 v[104:105], v16 offset:4096
    ds_read_b64_tr_b16 v[106:107], v16 offset:4608
    ds_read_b128 a[12:15], v13 offset:4096
    v_add_u32 v13, 0x8000, v13
    ds_read_b64_tr_b16 v[108:109], v17 offset:4096
    ds_read_b64_tr_b16 v[110:111], v17 offset:4608
    s_add_u32 m0, s71, 65536
    s_nop 0
    buffer_load_dwordx4 v4, s[24:27], s69 offen offset:0 lds
    buffer_load_dwordx4 v5, s[24:27], s69 offen offset:1024 lds
    buffer_load_dwordx4 v6, s[24:27], s69 offen offset:2048 lds
    buffer_load_dwordx4 v7, s[24:27], s69 offen offset:3072 lds
    s_add_u32 s69, s69, 128
    s_add_u32 m0, s71, 81920
    s_nop 0
    buffer_load_dwordx4 v8, s[28:31], s70 offen offset:0 lds
    buffer_load_dwordx4 v9, s[28:31], s70 offen offset:1024 lds
    s_add_u32 m0, s71, 83968
    s_nop 0
    buffer_load_dwordx4 v10, s[28:31], s70 offen offset:0 lds
    buffer_load_dwordx4 v11, s[28:31], s70 offen offset:1024 lds
    s_add_u32 s70, s70, 196608
    s_waitcnt lgkmcnt(6)
    v_mfma_f32_32x32x16_bf16 v[128:143], a[0:3], v[96:99], 0
    ds_read_b128 a[16:19], v14
    ds_read_b64_tr_b16 v[112:113], v16 offset:8192
    s_add_u32 m0, s71, 98304
    s_nop 0
    buffer_load_dwordx4 v4, s[24:27], s69 offen offset:0 lds
    v_mfma_f32_32x32x16_bf16 v[144:159], a[4:7], v[96:99], 0
    ds_read_b64_tr_b16 v[114:115], v16 offset:8704
    buffer_load_dwordx4 v5, s[24:27], s69 offen offset:1024 lds
    v_mfma_f32_32x32x16_bf16 v[160:175], a[0:3], v[100:103], 0
    ds_read_b128 a[20:23], v14 offset:4096
    v_add_u32 v14, 0x8000, v14
    ds_read_b64_tr_b16 v[116:117], v17 offset:8192
    buffer_load_dwordx4 v6, s[24:27], s69 offen offset:2048 lds
    v_mfma_f32_32x32x16_bf16 v[176:191], a[4:7], v[100:103], 0
    ds_read_b64_tr_b16 v[118:119], v17 offset:8704
    buffer_load_dwordx4 v7, s[24:27], s69 offen offset:3072 lds
    s_waitcnt lgkmcnt(6)
    v_mfma_f32_32x32x16_bf16 v[128:143], a[8:11], v[104:107], v[128:143]
    ds_read_b128 a[24:27], v15
    ds_read_b64_tr_b16 v[96:97], v16 offset:12288
    s_add_u32 s69, s69, 128
    s_add_u32 m0, s71, 114688
    s_nop 0
    buffer_load_dwordx4 v8, s[28:31], s70 offen offset:0 lds
    v_mfma_f32_32x32x16_bf16 v[144:159], a[12:15], v[104:107], v[144:159]
    ds_read_b64_tr_b16 v[98:99], v16 offset:12800
    v_add_u32 v16, 0x8000, v16
    buffer_load_dwordx4 v9, s[28:31], s70 offen offset:1024 lds
    v_mfma_f32_32x32x16_bf16 v[160:175], a[8:11], v[108:111], v[160:175]
    ds_read_b128 a[28:31], v15 offset:4096
    v_add_u32 v15, 0x8000, v15
    ds_read_b64_tr_b16 v[100:101], v17 offset:12288
    s_add_u32 m0, s71, 116736
    s_nop 0
    buffer_load_dwordx4 v10, s[28:31], s70 offen offset:0 lds
    s_bitcmp1_b32 s72, 0
    s_cbranch_scc1 L_sk_16
    s_bitcmp1_b32 s72, 2
    s_cbranch_scc1 L_wc_18
    s_waitcnt vmcnt(30)
    s_branch L_we_17
L_wc_18:
    s_waitcnt vmcnt(24)
L_we_17:
    buffer_store_dwordx4 v[84:87], v2, s[48:51], s6 offen sc1
L_sk_16:
    v_mfma_f32_32x32x16_bf16 v[176:191], a[12:15], v[108:111], v[176:191]
    ds_read_b64_tr_b16 v[102:103], v17 offset:12800
    v_add_u32 v17, 0x8000, v17
    buffer_load_dwordx4 v11, s[28:31], s70 offen offset:1024 lds
    s_waitcnt lgkmcnt(6)
    v_mfma_f32_32x32x16_bf16 v[128:143], a[16:19], v[112:115], v[128:143]
    s_bitcmp1_b32 s72, 2
    s_cbranch_scc1 L_wc_20
    s_waitcnt vmcnt(22)
    s_branch L_we_19
L_wc_20:
    s_waitcnt vmcnt(16)
L_we_19:
    s_barrier
    ds_read_b128 a[32:35], v12
    ds_read_b64_tr_b16 v[104:105], v16 offset:0
    v_mfma_f32_32x32x16_bf16 v[144:159], a[20:23], v[112:115], v[144:159]
    ds_read_b64_tr_b16 v[106:107], v16 offset:512
    s_add_u32 s70, s70, 196608
    s_lshl_b32 s3, s1, 10
    s_sub_u32 s69, s69, s3
    s_add_u32 m0, s71, 131072
    s_nop 0
    buffer_load_dwordx4 v4, s[24:27], s69 offen offset:0 lds
    v_mfma_f32_32x32x16_bf16 v[160:175], a[16:19], v[116:119], v[160:175]
    ds_read_b128 a[36:39], v12 offset:4096
    v_add_u32 v12, 0x8000, v12
    ds_read_b64_tr_b16 v[108:109], v17 offset:0
    v_mfma_f32_32x32x16_bf16 v[176:191], a[20:23], v[116:119], v[176:191]
    ds_read_b64_tr_b16 v[110:111], v17 offset:512
    buffer_load_dwordx4 v5, s[24:27], s69 offen offset:1024 lds
    s_waitcnt lgkmcnt(6)
    v_mfma_f32_32x32x16_bf16 v[128:143], a[24:27], v[96:99], v[128:143]
    ds_read_b128 a[40:43], v13
    ds_read_b64_tr_b16 v[112:113], v16 offset:4096
    v_mfma_f32_32x32x16_bf16 v[144:159], a[28:31], v[96:99], v[144:159]
    ds_read_b64_tr_b16 v[114:115], v16 offset:4608
    buffer_load_dwordx4 v6, s[24:27], s69 offen offset:2048 lds
    s_waitcnt vmcnt(15)
    v_lshlrev_b32 v88, 16, v24
    v_and_b32 v89, 0xffff0000, v24
    v_lshlrev_b32 v90, 16, v25
    v_and_b32 v91, 0xffff0000, v25
    v_lshlrev_b32 v92, 16, v26
    v_mfma_f32_32x32x16_bf16 v[160:175], a[24:27], v[100:103], v[160:175]
    ds_read_b128 a[44:47], v13 offset:4096
    v_add_u32 v13, 0x8000, v13
    ds_read_b64_tr_b16 v[116:117], v17 offset:4096
    v_and_b32 v93, 0xffff0000, v26
    v_lshlrev_b32 v94, 16, v27
    v_and_b32 v95, 0xffff0000, v27
    v_lshlrev_b32 v64, 16, v28
    v_and_b32 v28, 0xffff0000, v28
    v_mfma_f32_32x32x16_bf16 v[176:191], a[28:31], v[100:103], v[176:191]
    ds_read_b64_tr_b16 v[118:119], v17 offset:4608
    buffer_load_dwordx4 v7, s[24:27], s69 offen offset:3072 lds
    v_add_f32 v88, v88, v64
    v_add_f32 v89, v89, v28
    v_lshlrev_b32 v65, 16, v29
    v_and_b32 v29, 0xffff0000, v29
    s_waitcnt lgkmcnt(6)
    v_mfma_f32_32x32x16_bf16 v[128:143], a[32:35], v[104:107], v[128:143]
    ds_read_b128 a[48:51], v14
    ds_read_b64_tr_b16 v[96:97], v16 offset:8192
    v_add_f32 v90, v90, v65
    v_add_f32 v91, v91, v29
    v_lshlrev_b32 v66, 16, v30
    v_and_b32 v30, 0xffff0000, v30
    v_add_f32 v92, v92, v66
    v_add_f32 v93, v93, v30
    v_mfma_f32_32x32x16_bf16 v[144:159], a[36:39], v[104:107], v[144:159]
    ds_read_b64_tr_b16 v[98:99], v16 offset:8704
    v_lshlrev_b32 v67, 16, v31
    v_and_b32 v31, 0xffff0000, v31
    v_add_f32 v94, v94, v67
    v_add_f32 v95, v95, v31
    v_lshlrev_b32 v64, 16, v32
    v_and_b32 v32, 0xffff0000, v32
    v_add_f32 v88, v88, v64
    v_mfma_f32_32x32x16_bf16 v[160:175], a[32:35], v[108:111], v[160:175]
    ds_read_b128 a[52:55], v14 offset:4096
    v_add_u32 v14, 0x8000, v14
    ds_read_b64_tr_b16 v[100:101], v17 offset:8192
    s_add_u32 s69, s69, 128
    s_mul_i32 s3, s1, 1572864
    s_sub_u32 s70, s70, s3
    v_add_f32 v89, v89, v32
    v_lshlrev_b32 v65, 16, v33
    v_and_b32 v33, 0xffff0000, v33
    v_mfma_f32_32x32x16_bf16 v[176:191], a[36:39], v[108:111], v[176:191]
    ds_read_b64_tr_b16 v[102:103], v17 offset:8704
    v_add_f32 v90, v90, v65
    v_add_f32 v91, v91, v33
    v_lshlrev_b32 v66, 16, v34
    v_and_b32 v34, 0xffff0000, v34
    v_add_f32 v92, v92, v66
    v_add_f32 v93, v93, v34
    v_lshlrev_b32 v67, 16, v35
    s_waitcnt lgkmcnt(6)
    v_mfma_f32_32x32x16_bf16 v[128:143], a[40:43], v[112:115], v[128:143]
    ds_read_b128 a[56:59], v15
    ds_read_b64_tr_b16 v[104:105], v16 offset:12288
    v_and_b32 v35, 0xffff0000, v35
    v_add_f32 v94, v94, v67
    v_add_f32 v95, v95, v35
    v_lshlrev_b32 v64, 16, v36
    v_and_b32 v36, 0xffff0000, v36
    v_add_f32 v88, v88, v64
    v_mfma_f32_32x32x16_bf16 v[144:159], a[44:47], v[112:115], v[144:159]
    ds_read_b64_tr_b16 v[106:107], v16 offset:12800
    v_add_u32 v16, 0x8000, v16
    v_add_f32 v89, v89, v36
    v_lshlrev_b32 v65, 16, v37
    v_and_b32 v37, 0xffff0000, v37
    v_add_f32 v90, v90, v65
    v_add_f32 v91, v91, v37
    v_lshlrev_b32 v66, 16, v38
    v_mfma_f32_32x32x16_bf16 v[160:175], a[40:43], v[116:119], v[160:175]
    ds_read_b128 a[60:63], v15 offset:4096
    v_add_u32 v15, 0x8000, v15
    ds_read_b64_tr_b16 v[108:109], v17 offset:12288
    v_and_b32 v38, 0xffff0000, v38
    v_add_f32 v92, v92, v66
    v_add_f32 v93, v93, v38
    v_lshlrev_b32 v67, 16, v39
    v_and_b32 v39, 0xffff0000, v39
    v_mfma_f32_32x32x16_bf16 v[176:191], a[44:47], v[116:119], v[176:191]
    ds_read_b64_tr_b16 v[110:111], v17 offset:12800
    v_add_u32 v17, 0x8000, v17
    v_add_f32 v94, v94, v67
    v_add_f32 v95, v95, v39
    v_lshlrev_b32 v64, 16, v40
    v_and_b32 v40, 0xffff0000, v40
    v_add_f32 v88, v88, v64
    s_waitcnt lgkmcnt(6)
    v_mfma_f32_32x32x16_bf16 v[128:143], a[48:51], v[96:99], v[128:143]
    s_waitcnt vmcnt(12)
    s_barrier
    ds_read_b128 a[64:67], v12
    ds_read_b64_tr_b16 v[112:113], v16 offset:0
    s_add_u32 m0, s71, 0
    s_nop 0
    buffer_load_dwordx4 v8, s[28:31], s70 offen offset:0 lds
    v_mfma_f32_32x32x16_bf16 v[144:159], a[52:55], v[96:99], v[144:159]
    ds_read_b64_tr_b16 v[114:115], v16 offset:512
    v_add_f32 v89, v89, v40
    v_lshlrev_b32 v65, 16, v41
    v_and_b32 v41, 0xffff0000, v41
    v_add_f32 v90, v90, v65
    v_mfma_f32_32x32x16_bf16 v[160:175], a[48:51], v[100:103], v[160:175]
    ds_read_b128 a[68:71], v12 offset:4096
    v_add_u32 v12, 0x8000, v12
    ds_read_b64_tr_b16 v[116:117], v17 offset:0
    buffer_load_dwordx4 v9, s[28:31], s70 offen offset:1024 lds
    v_add_f32 v91, v91, v41
    v_lshlrev_b32 v66, 16, v42
    v_and_b32 v42, 0xffff0000, v42
    v_mfma_f32_32x32x16_bf16 v[176:191], a[52:55], v[100:103], v[176:191]
    ds_read_b64_tr_b16 v[118:119], v17 offset:512
    v_add_f32 v92, v92, v66
    v_add_f32 v93, v93, v42
    v_lshlrev_b32 v67, 16, v43
    v_and_b32 v43, 0xffff0000, v43
    v_add_f32 v94, v94, v67
    v_add_f32 v95, v95, v43
    s_waitcnt lgkmcnt(6)
    v_mfma_f32_32x32x16_bf16 v[128:143], a[56:59], v[104:107], v[128:143]
    ds_read_b128 a[72:75], v13
    ds_read_b64_tr_b16 v[96:97], v16 offset:4096
    s_add_u32 m0, s71, 2048
    s_nop 0
    buffer_load_dwordx4 v10, s[28:31], s70 offen offset:0 lds
    v_lshlrev_b32 v64, 16, v44
    v_and_b32 v44, 0xffff0000, v44
    v_add_f32 v88, v88, v64
    v_mfma_f32_32x32x16_bf16 v[144:159], a[60:63], v[104:107], v[144:159]
    ds_read_b64_tr_b16 v[98:99], v16 offset:4608
    v_add_f32 v89, v89, v44
    v_lshlrev_b32 v65, 16, v45
    v_and_b32 v45, 0xffff0000, v45
    v_add_f32 v90, v90, v65
    v_add_f32 v91, v91, v45
    v_lshlrev_b32 v66, 16, v46
    v_and_b32 v46, 0xffff0000, v46
    v_mfma_f32_32x32x16_bf16 v[160:175], a[56:59], v[108:111], v[160:175]
    ds_read_b128 a[76:79], v13 offset:4096
    v_add_u32 v13, 0x8000, v13
    ds_read_b64_tr_b16 v[100:101], v17 offset:4096
    buffer_load_dwordx4 v11, s[28:31], s70 offen offset:1024 lds
    v_add_f32 v92, v92, v66
    v_add_f32 v93, v93, v46
    v_lshlrev_b32 v67, 16, v47
    v_mfma_f32_32x32x16_bf16 v[176:191], a[60:63], v[108:111], v[176:191]
    ds_read_b64_tr_b16 v[102:103], v17 offset:4608
    v_and_b32 v47, 0xffff0000, v47
    v_add_f32 v94, v94, v67
    v_add_f32 v95, v95, v47
    v_permlane32_swap_b32 v88, v92
    v_permlane32_swap_b32 v89, v93
    v_permlane32_swap_b32 v90, v94
    s_waitcnt lgkmcnt(6)
    v_mfma_f32_32x32x16_bf16 v[128:143], a[64:67], v[112:115], v[128:143]
    ds_read_b128 a[80:83], v14
    ds_read_b64_tr_b16 v[104:105], v16 offset:8192
    v_permlane32_swap_b32 v91, v95
    v_and_b32 v64, 7, v1
    v_lshlrev_b32 v64, 3, v64
    v_add_f32 v88, v88, v92
    v_add_f32 v89, v89, v93
    v_add_f32 v90, v90, v94
    v_mfma_f32_32x32x16_bf16 v[144:159], a[68:71], v[112:115], v[144:159]
    ds_read_b64_tr_b16 v[106:107], v16 offset:8704
    s_add_u32 s70, s70, 196608
    s_add_u32 m0, s71, 16384
    s_nop 0
    buffer_load_dwordx4 v4, s[24:27], s69 offen offset:0 lds
    v_add_f32 v91, v91, v95
    v_lshrrev_b32 v65, 3, v1
    v_or_b32 v64, v64, v65
    v_mfma_f32_32x32x16_bf16 v[160:175], a[64:67], v[116:119], v[160:175]
    ds_read_b128 a[84:87], v14 offset:4096
    v_add_u32 v14, 0x8000, v14
    ds_read_b64_tr_b16 v[108:109], v17 offset:8192
    v_permlane16_swap_b32 v88, v90
    v_permlane16_swap_b32 v89, v91
    s_lshl_b32 s85, s60, 2
    s_add_u32 s85, s85, 149504
    v_add_f32 v88, v88, v90
    v_add_f32 v89, v89, v91
    v_mfma_f32_32x32x16_bf16 v[176:191], a[68:71], v[116:119], v[176:191]
    ds_read_b64_tr_b16 v[110:111], v17 offset:8704
    buffer_load_dwordx4 v5, s[24:27], s69 offen offset:1024 lds
    v_lshl_add_u32 v64, v64, 4, s85
    v_add_u32 v65, 149504, v2
    v_add_f32 v90, v88, v88 row_ror:8 row_mask:0xf bank_mask:0x3
    v_lshlrev_b32 v74, 1, v2
    s_waitcnt lgkmcnt(6)
    v_mfma_f32_32x32x16_bf16 v[128:143], a[72:75], v[96:99], v[128:143]
    ds_read_b128 a[88:91], v15
    ds_read_b64_tr_b16 v[112:113], v16 offset:12288
    v_mov_b32 v73, s65
    v_add_f32 v90, v89, v89 row_ror:8 row_mask:0xf bank_mask:0xc
    ds_write_b32 v64, v90
    v_mfma_f32_32x32x16_bf16 v[144:159], a[76:79], v[96:99], v[144:159]
    ds_read_b64_tr_b16 v[114:115], v16 offset:12800
    v_add_u32 v16, 0x8000, v16
    buffer_load_dwordx4 v6, s[24:27], s69 offen offset:2048 lds
    v_mfma_f32_32x32x16_bf16 v[160:175], a[72:75], v[100:103], v[160:175]
    ds_read_b128 a[92:95], v15 offset:4096
    v_add_u32 v15, 0x8000, v15
    ds_read_b64_tr_b16 v[116:117], v17 offset:12288
    v_mfma_f32_32x32x16_bf16 v[176:191], a[76:79], v[100:103], v[176:191]
    ds_read_b64_tr_b16 v[118:119], v17 offset:12800
    v_add_u32 v17, 0x8000, v17
    buffer_load_dwordx4 v7, s[24:27], s69 offen offset:3072 lds
    s_waitcnt lgkmcnt(7)
    v_mfma_f32_32x32x16_bf16 v[128:143], a[80:83], v[104:107], v[128:143]
    s_waitcnt vmcnt(12) lgkmcnt(4)
    s_barrier
    ds_read_b128 a[96:99], v12
    ds_read_b64_tr_b16 v[96:97], v16 offset:0
    ds_read_b128 v[68:71], v65
    v_mfma_f32_32x32x16_bf16 v[144:159], a[84:87], v[104:107], v[144:159]
    ds_read_b64_tr_b16 v[98:99], v16 offset:512
    v_mfma_f32_32x32x16_bf16 v[160:175], a[80:83], v[108:111], v[160:175]
    ds_read_b128 a[100:103], v12 offset:4096
    v_add_u32 v12, 0x8000, v12
    ds_read_b64_tr_b16 v[100:101], v17 offset:0
    s_add_u32 s69, s69, 128
    s_add_u32 m0, s71, 32768
    s_nop 0
    buffer_load_dwordx4 v8, s[28:31], s70 offen offset:0 lds
    v_mfma_f32_32x32x16_bf16 v[176:191], a[84:87], v[108:111], v[176:191]
    ds_read_b64_tr_b16 v[102:103], v17 offset:512
    s_waitcnt lgkmcnt(7)
    v_mfma_f32_32x32x16_bf16 v[128:143], a[88:91], v[112:115], v[128:143]
    ds_read_b128 a[104:107], v13
    ds_read_b64_tr_b16 v[104:105], v16 offset:4096
    buffer_load_dwordx4 v9, s[28:31], s70 offen offset:1024 lds
    s_waitcnt lgkmcnt(6)
    v_add_f32 v68, v68, v69
    v_add_f32 v70, v70, v71
    v_mov_b32 v71, v73
    v_add_f32 v68, v68, v70
    v_mfma_f32_32x32x16_bf16 v[144:159], a[92:95], v[112:115], v[144:159]
    ds_read_b64_tr_b16 v[106:107], v16 offset:4608
    v_cvt_pk_bf16_f32 v69, v68, v68
    v_lshlrev_b32 v69, 16, v69
    v_sub_f32 v69, v68, v69
    v_cvt_pk_bf16_f32 v70, v68, v69
    v_mov_b32 v72, 0
    s_cmp_ge_u32 s86, 1073741824
    s_cbranch_scc1 L_sk_21
    s_bitcmp1_b32 s86, 4
    s_cbranch_scc1 L_sk_22
    buffer_store_dwordx2 v[70:71], v74, s[48:51], s86 offen sc1
L_sk_22:
    s_bitcmp0_b32 s86, 4
    s_cbranch_scc1 L_sk_23
    buffer_store_dwordx4 v[70:73], v74, s[48:51], s86 offen sc1
L_sk_23:
L_sk_21:
    s_cmp_ge_u32 s6, 1073741824
    s_cbranch_scc1 L_sk_24
    s_waitcnt vmcnt(15)
    s_mov_b64 exec, 1
    buffer_store_dword v71, off, s[48:51], s96 sc1
    s_mov_b64 exec, -1
L_sk_24:
    v_mfma_f32_32x32x16_bf16 v[160:175], a[88:91], v[116:119], v[160:175]
    ds_read_b128 a[108:111], v13 offset:4096
    v_add_u32 v13, 0x8000, v13
    ds_read_b64_tr_b16 v[108:109], v17 offset:4096
    v_mfma_f32_32x32x16_bf16 v[176:191], a[92:95], v[116:119], v[176:191]
    ds_read_b64_tr_b16 v[110:111], v17 offset:4608
    s_add_u32 m0, s71, 34816
    s_nop 0
    buffer_load_dwordx4 v10, s[28:31], s70 offen offset:0 lds
    s_waitcnt lgkmcnt(6)
    v_mfma_f32_32x32x16_bf16 v[128:143], a[96:99], v[96:99], v[128:143]
    ds_read_b128 a[112:115], v14
    ds_read_b64_tr_b16 v[112:113], v16 offset:8192
    v_mfma_f32_32x32x16_bf16 v[144:159], a[100:103], v[96:99], v[144:159]
    ds_read_b64_tr_b16 v[114:115], v16 offset:8704
    buffer_load_dwordx4 v11, s[28:31], s70 offen offset:1024 lds
    v_mfma_f32_32x32x16_bf16 v[160:175], a[96:99], v[100:103], v[160:175]
    ds_read_b128 a[116:119], v14 offset:4096
    v_add_u32 v14, 0x8000, v14
    ds_read_b64_tr_b16 v[116:117], v17 offset:8192
    v_mfma_f32_32x32x16_bf16 v[176:191], a[100:103], v[100:103], v[176:191]
    ds_read_b64_tr_b16 v[118:119], v17 offset:8704
    s_add_u32 s70, s70, 196608
    buffer_load_dword v3, v23, s[40:43], 0 offen
    s_waitcnt lgkmcnt(6)
    v_mfma_f32_32x32x16_bf16 v[128:143], a[104:107], v[104:107], v[128:143]
    ds_read_b128 a[120:123], v15
    ds_read_b64_tr_b16 v[96:97], v16 offset:12288
    v_mfma_f32_32x32x16_bf16 v[144:159], a[108:111], v[104:107], v[144:159]
    ds_read_b64_tr_b16 v[98:99], v16 offset:12800
    v_add_u32 v16, 0xfffe4000, v16
    v_mfma_f32_32x32x16_bf16 v[160:175], a[104:107], v[108:111], v[160:175]
    ds_read_b128 a[124:127], v15 offset:4096
    v_add_u32 v15, 0x8000, v15
    ds_read_b64_tr_b16 v[100:101], v17 offset:12288
    v_mfma_f32_32x32x16_bf16 v[176:191], a[108:111], v[108:111], v[176:191]
    ds_read_b64_tr_b16 v[102:103], v17 offset:12800
    v_add_u32 v17, 0xfffe4000, v17
    s_waitcnt lgkmcnt(6)
    v_mfma_f32_32x32x16_bf16 v[128:143], a[112:115], v[112:115], v[128:143]
    s_waitcnt vmcnt(9)
    s_barrier
    ds_read_b128 a[128:131], v12
    ds_read_b64_tr_b16 v[104:105], v16 offset:0
    s_add_u32 m0, s71, 49152
    s_nop 0
    buffer_load_dwordx4 v4, s[24:27], s69 offen offset:0 lds
    v_mfma_f32_32x32x16_bf16 v[144:159], a[116:119], v[112:115], v[144:159]
    ds_read_b64_tr_b16 v[106:107], v16 offset:512
    v_mfma_f32_32x32x16_bf16 v[160:175], a[112:115], v[116:119], v[160:175]
    ds_read_b128 a[132:135], v12 offset:4096
    v_add_u32 v12, 0xfffe4000, v12
    ds_read_b64_tr_b16 v[108:109], v17 offset:0
    buffer_load_dwordx4 v5, s[24:27], s69 offen offset:1024 lds
    v_mfma_f32_32x32x16_bf16 v[176:191], a[116:119], v[116:119], v[176:191]
    ds_read_b64_tr_b16 v[110:111], v17 offset:512
    s_waitcnt lgkmcnt(6)
    v_mfma_f32_32x32x16_bf16 v[128:143], a[120:123], v[96:99], v[128:143]
    ds_read_b128 a[136:139], v13
    ds_read_b64_tr_b16 v[112:113], v16 offset:4096
    v_mfma_f32_32x32x16_bf16 v[144:159], a[124:127], v[96:99], v[144:159]
    ds_read_b64_tr_b16 v[114:115], v16 offset:4608
    buffer_load_dwordx4 v6, s[24:27], s69 offen offset:2048 lds
    v_mfma_f32_32x32x16_bf16 v[160:175], a[120:123], v[100:103], v[160:175]
    ds_read_b128 a[140:143], v13 offset:4096
    v_add_u32 v13, 0xfffe4000, v13
    ds_read_b64_tr_b16 v[116:117], v17 offset:4096
    v_mfma_f32_32x32x16_bf16 v[176:191], a[124:127], v[100:103], v[176:191]
    ds_read_b64_tr_b16 v[118:119], v17 offset:4608
    buffer_load_dwordx4 v7, s[24:27], s69 offen offset:3072 lds
    s_waitcnt lgkmcnt(6)
    v_mfma_f32_32x32x16_bf16 v[128:143], a[128:131], v[104:107], v[128:143]
    ds_read_b128 a[144:147], v14
    ds_read_b64_tr_b16 v[96:97], v16 offset:8192
    v_mfma_f32_32x32x16_bf16 v[144:159], a[132:135], v[104:107], v[144:159]
    ds_read_b64_tr_b16 v[98:99], v16 offset:8704
    s_add_u32 s69, s69, 128
    s_add_u32 m0, s71, 65536
    s_nop 0
    buffer_load_dwordx4 v8, s[28:31], s70 offen offset:0 lds
    v_mfma_f32_32x32x16_bf16 v[160:175], a[128:131], v[108:111], v[160:175]
    ds_read_b128 a[148:151], v14 offset:4096
    v_add_u32 v14, 0xfffe4000, v14
    ds_read_b64_tr_b16 v[100:101], v17 offset:8192
    v_mfma_f32_32x32x16_bf16 v[176:191], a[132:135], v[108:111], v[176:191]
    ds_read_b64_tr_b16 v[102:103], v17 offset:8704
    buffer_load_dwordx4 v9, s[28:31], s70 offen offset:1024 lds
    s_waitcnt lgkmcnt(6)
    v_mfma_f32_32x32x16_bf16 v[128:143], a[136:139], v[112:115], v[128:143]
    ds_read_b128 a[152:155], v15
    ds_read_b64_tr_b16 v[104:105], v16 offset:12288
    v_mfma_f32_32x32x16_bf16 v[144:159], a[140:143], v[112:115], v[144:159]
    ds_read_b64_tr_b16 v[106:107], v16 offset:12800
    v_add_u32 v16, 0x8000, v16
    v_mfma_f32_32x32x16_bf16 v[160:175], a[136:139], v[116:119], v[160:175]
    ds_read_b128 a[156:159], v15 offset:4096
    v_add_u32 v15, 0xfffe4000, v15
    ds_read_b64_tr_b16 v[108:109], v17 offset:12288
    s_add_u32 m0, s71, 67584
    s_nop 0
    buffer_load_dwordx4 v10, s[28:31], s70 offen offset:0 lds
    v_mfma_f32_32x32x16_bf16 v[176:191], a[140:143], v[116:119], v[176:191]
    ds_read_b64_tr_b16 v[110:111], v17 offset:12800
    v_add_u32 v17, 0x8000, v17
    s_waitcnt lgkmcnt(6)
    v_mfma_f32_32x32x16_bf16 v[128:143], a[144:147], v[96:99], v[128:143]
    s_waitcnt vmcnt(8)
    s_barrier
    ds_read_b128 a[160:163], v12
    ds_read_b64_tr_b16 v[112:113], v16 offset:0
    buffer_load_dwordx4 v11, s[28:31], s70 offen offset:1024 lds
    v_mfma_f32_32x32x16_bf16 v[144:159], a[148:151], v[96:99], v[144:159]
    ds_read_b64_tr_b16 v[114:115], v16 offset:512
    s_add_u32 s70, s70, 196608
    s_add_u32 m0, s71, 81920
    s_nop 0
    buffer_load_dwordx4 v4, s[24:27], s69 offen offset:0 lds
    v_mfma_f32_32x32x16_bf16 v[160:175], a[144:147], v[100:103], v[160:175]
    ds_read_b128 a[164:167], v12 offset:4096
    v_add_u32 v12, 0x8000, v12
    ds_read_b64_tr_b16 v[116:117], v17 offset:0
    v_mfma_f32_32x32x16_bf16 v[176:191], a[148:151], v[100:103], v[176:191]
    ds_read_b64_tr_b16 v[118:119], v17 offset:512
    s_waitcnt lgkmcnt(6)
    v_mfma_f32_32x32x16_bf16 v[128:143], a[152:155], v[104:107], v[128:143]
    ds_read_b128 a[168:171], v13
    ds_read_b64_tr_b16 v[96:97], v16 offset:4096
    buffer_load_dwordx4 v5, s[24:27], s69 offen offset:1024 lds
    v_mfma_f32_32x32x16_bf16 v[144:159], a[156:159], v[104:107], v[144:159]
    ds_read_b64_tr_b16 v[98:99], v16 offset:4608
    v_mfma_f32_32x32x16_bf16 v[160:175], a[152:155], v[108:111], v[160:175]
    ds_read_b128 a[172:175], v13 offset:4096
    v_add_u32 v13, 0x8000, v13
    ds_read_b64_tr_b16 v[100:101], v17 offset:4096
    v_mfma_f32_32x32x16_bf16 v[176:191], a[156:159], v[108:111], v[176:191]
    ds_read_b64_tr_b16 v[102:103], v17 offset:4608
    buffer_load_dwordx4 v6, s[24:27], s69 offen offset:2048 lds
    s_waitcnt lgkmcnt(6)
    v_mfma_f32_32x32x16_bf16 v[128:143], a[160:163], v[112:115], v[128:143]
    ds_read_b128 a[176:179], v14
    ds_read_b64_tr_b16 v[104:105], v16 offset:8192
    v_mfma_f32_32x32x16_bf16 v[144:159], a[164:167], v[112:115], v[144:159]
    ds_read_b64_tr_b16 v[106:107], v16 offset:8704
    buffer_load_dwordx4 v7, s[24:27], s69 offen offset:3072 lds
    v_mfma_f32_32x32x16_bf16 v[160:175], a[160:163], v[116:119], v[160:175]
    ds_read_b128 a[180:183], v14 offset:4096
    v_add_u32 v14, 0x8000, v14
    ds_read_b64_tr_b16 v[108:109], v17 offset:8192
    v_mfma_f32_32x32x16_bf16 v[176:191], a[164:167], v[116:119], v[176:191]
    ds_read_b64_tr_b16 v[110:111], v17 offset:8704
    s_add_u32 s69, s69, 128
    s_add_u32 m0, s71, 98304
    s_nop 0
    buffer_load_dwordx4 v8, s[28:31], s70 offen offset:0 lds
    s_waitcnt lgkmcnt(6)
    v_mfma_f32_32x32x16_bf16 v[128:143], a[168:171], v[96:99], v[128:143]
    ds_read_b128 a[184:187], v15
    ds_read_b64_tr_b16 v[112:113], v16 offset:12288
    v_mfma_f32_32x32x16_bf16 v[144:159], a[172:175], v[96:99], v[144:159]
    ds_read_b64_tr_b16 v[114:115], v16 offset:12800
    v_add_u32 v16, 0x8000, v16
    buffer_load_dwordx4 v9, s[28:31], s70 offen offset:1024 lds
    v_mfma_f32_32x32x16_bf16 v[160:175], a[168:171], v[100:103], v[160:175]
    ds_read_b128 a[188:191], v15 offset:4096
    v_add_u32 v15, 0x8000, v15
    ds_read_b64_tr_b16 v[116:117], v17 offset:12288
    v_mfma_f32_32x32x16_bf16 v[176:191], a[172:175], v[100:103], v[176:191]
    ds_read_b64_tr_b16 v[118:119], v17 offset:12800
    v_add_u32 v17, 0x8000, v17
    s_waitcnt lgkmcnt(6)
    v_mfma_f32_32x32x16_bf16 v[128:143], a[176:179], v[104:107], v[128:143]
    s_waitcnt vmcnt(6)
    s_barrier
    ds_read_b128 a[192:195], v12
    ds_read_b64_tr_b16 v[96:97], v16 offset:0
    s_add_u32 m0, s71, 100352
    s_nop 0
    buffer_load_dwordx4 v10, s[28:31], s70 offen offset:0 lds
    v_mfma_f32_32x32x16_bf16 v[144:159], a[180:183], v[104:107], v[144:159]
    ds_read_b64_tr_b16 v[98:99], v16 offset:512
    buffer_load_dwordx4 v11, s[28:31], s70 offen offset:1024 lds
    v_mfma_f32_32x32x16_bf16 v[160:175], a[176:179], v[108:111], v[160:175]
    ds_read_b128 a[196:199], v12 offset:4096
    v_add_u32 v12, 0x8000, v12
    ds_read_b64_tr_b16 v[100:101], v17 offset:0
    s_add_u32 s70, s70, 196608
    buffer_load_dwordx2 v[44:45], v18, s[48:51], 0 offen sc1
    v_mfma_f32_32x32x16_bf16 v[176:191], a[180:183], v[108:111], v[176:191]
    ds_read_b64_tr_b16 v[102:103], v17 offset:512
    s_waitcnt lgkmcnt(6)
    v_mfma_f32_32x32x16_bf16 v[128:143], a[184:187], v[112:115], v[128:143]
    ds_read_b128 a[200:203], v13
    ds_read_b64_tr_b16 v[104:105], v16 offset:4096
    v_mfma_f32_32x32x16_bf16 v[144:159], a[188:191], v[112:115], v[144:159]
    ds_read_b64_tr_b16 v[106:107], v16 offset:4608
    v_mfma_f32_32x32x16_bf16 v[160:175], a[184:187], v[116:119], v[160:175]
    ds_read_b128 a[204:207], v13 offset:4096
    v_add_u32 v13, 0x8000, v13
    ds_read_b64_tr_b16 v[108:109], v17 offset:4096
    buffer_load_dwordx4 v[24:27], v21, s[48:51], s79 offen sc1
    v_mfma_f32_32x32x16_bf16 v[176:191], a[188:191], v[116:119], v[176:191]
    ds_read_b64_tr_b16 v[110:111], v17 offset:4608
    s_waitcnt lgkmcnt(6)
    v_mfma_f32_32x32x16_bf16 v[128:143], a[192:195], v[96:99], v[128:143]
    ds_read_b128 a[208:211], v14
    ds_read_b64_tr_b16 v[112:113], v16 offset:8192
    v_mfma_f32_32x32x16_bf16 v[144:159], a[196:199], v[96:99], v[144:159]
    ds_read_b64_tr_b16 v[114:115], v16 offset:8704
    buffer_load_dwordx4 v[28:31], v21, s[48:51], s80 offen sc1
    v_mfma_f32_32x32x16_bf16 v[160:175], a[192:195], v[100:103], v[160:175]
    ds_read_b128 a[212:215], v14 offset:4096
    v_add_u32 v14, 0x8000, v14
    ds_read_b64_tr_b16 v[116:117], v17 offset:8192
    v_mfma_f32_32x32x16_bf16 v[176:191], a[196:199], v[100:103], v[176:191]
    ds_read_b64_tr_b16 v[118:119], v17 offset:8704
    buffer_load_dwordx4 v[32:35], v19, s[48:51], s81 offen sc1
    s_waitcnt lgkmcnt(6)
    v_mfma_f32_32x32x16_bf16 v[128:143], a[200:203], v[104:107], v[128:143]
    ds_read_b128 a[216:219], v15
    ds_read_b64_tr_b16 v[96:97], v16 offset:12288
    v_mfma_f32_32x32x16_bf16 v[144:159], a[204:207], v[104:107], v[144:159]
    ds_read_b64_tr_b16 v[98:99], v16 offset:12800
    v_add_u32 v16, 0x8000, v16
    buffer_load_dwordx4 v[36:39], v19, s[48:51], s82 offen sc1
    v_mfma_f32_32x32x16_bf16 v[160:175], a[200:203], v[108:111], v[160:175]
    ds_read_b128 a[220:223], v15 offset:4096
    v_add_u32 v15, 0x8000, v15
    ds_read_b64_tr_b16 v[100:101], v17 offset:12288
    v_mfma_f32_32x32x16_bf16 v[176:191], a[204:207], v[108:111], v[176:191]
    ds_read_b64_tr_b16 v[102:103], v17 offset:12800
    v_add_u32 v17, 0x8000, v17
    buffer_load_dwordx4 v[40:43], v19, s[48:51], s83 offen sc1
    s_waitcnt lgkmcnt(6)
    v_mfma_f32_32x32x16_bf16 v[128:143], a[208:211], v[112:115], v[128:143]
    s_waitcnt vmcnt(6)
    s_barrier
    ds_read_b128 a[224:227], v12
    ds_read_b64_tr_b16 v[104:105], v16 offset:0
    v_mov_b32 v8, v123
    v_add_u32 v9, 27648, v123
    v_mfma_f32_32x32x16_bf16 v[144:159], a[212:215], v[112:115], v[144:159]
    ds_read_b64_tr_b16 v[106:107], v16 offset:512
    v_xor_b32 v10, 32, v123
    v_add_u32 v11, 27648, v10
    s_mul_i32 s70, s64, 384
    s_mul_i32 s3, s60, 57344
    s_add_u32 s70, s70, s3
    s_mul_i32 s3, s1, 917504
    s_add_u32 s70, s70, s3
    v_mfma_f32_32x32x16_bf16 v[160:175], a[208:211], v[116:119], v[160:175]
    ds_read_b128 a[228:231], v12 offset:4096
    ds_read_b64_tr_b16 v[108:109], v17 offset:0
    s_add_u32 s70, s70, 256
    s_add_u32 m0, s71, 114688
    s_nop 0
    buffer_load_dwordx4 v8, s[32:35], s70 offen offset:0 lds
    v_mfma_f32_32x32x16_bf16 v[176:191], a[212:215], v[116:119], v[176:191]
    ds_read_b64_tr_b16 v[110:111], v17 offset:512
    buffer_load_dwordx4 v9, s[32:35], s70 offen offset:1024 lds
    s_waitcnt lgkmcnt(6)
    v_mfma_f32_32x32x16_bf16 v[128:143], a[216:219], v[96:99], v[128:143]
    ds_read_b128 a[232:235], v13
    ds_read_b64_tr_b16 v[112:113], v16 offset:4096
    s_add_u32 m0, s71, 116736
    s_nop 0
    buffer_load_dwordx4 v10, s[36:39], s70 offen offset:0 lds
    v_mfma_f32_32x32x16_bf16 v[144:159], a[220:223], v[96:99], v[144:159]
    ds_read_b64_tr_b16 v[114:115], v16 offset:4608
    buffer_load_dwordx4 v11, s[36:39], s70 offen offset:1024 lds
    v_mfma_f32_32x32x16_bf16 v[160:175], a[216:219], v[100:103], v[160:175]
    ds_read_b128 a[236:239], v13 offset:4096
    ds_read_b64_tr_b16 v[116:117], v17 offset:4096
    s_add_u32 s70, s70, 229376
    s_add_u32 m0, s71, 131072
    s_nop 0
    buffer_load_dwordx4 v8, s[32:35], s70 offen offset:0 lds
    v_mfma_f32_32x32x16_bf16 v[176:191], a[220:223], v[100:103], v[176:191]
    ds_read_b64_tr_b16 v[118:119], v17 offset:4608
    s_waitcnt lgkmcnt(6)
    v_mfma_f32_32x32x16_bf16 v[128:143], a[224:227], v[104:107], v[128:143]
    ds_read_b128 a[240:243], v14
    ds_read_b64_tr_b16 v[96:97], v16 offset:8192
    v_mfma_f32_32x32x16_bf16 v[144:159], a[228:231], v[104:107], v[144:159]
    ds_read_b64_tr_b16 v[98:99], v16 offset:8704
    v_mfma_f32_32x32x16_bf16 v[160:175], a[224:227], v[108:111], v[160:175]
    ds_read_b128 a[244:247], v14 offset:4096
    ds_read_b64_tr_b16 v[100:101], v17 offset:8192
    v_mfma_f32_32x32x16_bf16 v[176:191], a[228:231], v[108:111], v[176:191]
    ds_read_b64_tr_b16 v[102:103], v17 offset:8704
    s_waitcnt lgkmcnt(6)
    v_mfma_f32_32x32x16_bf16 v[128:143], a[232:235], v[112:115], v[128:143]
    ds_read_b128 a[248:251], v15
    ds_read_b64_tr_b16 v[104:105], v16 offset:12288
    v_mfma_f32_32x32x16_bf16 v[144:159], a[236:239], v[112:115], v[144:159]
    ds_read_b64_tr_b16 v[106:107], v16 offset:12800
    buffer_load_dwordx4 v9, s[32:35], s70 offen offset:1024 lds
    s_waitcnt vmcnt(6)
    v_xor_b32 v80, s65, v45
    v_bitop3_b32 v80, v80, v25, s65 bitop3:0xf6
    v_bitop3_b32 v80, v80, v27, s65 bitop3:0xf6
    v_bitop3_b32 v80, v80, v29, s65 bitop3:0xf6
    v_bitop3_b32 v80, v80, v31, s65 bitop3:0xf6
    v_mfma_f32_32x32x16_bf16 v[160:175], a[232:235], v[116:119], v[160:175]
    ds_read_b128 a[252:255], v15 offset:4096
    ds_read_b64_tr_b16 v[108:109], v17 offset:12288
    v_bitop3_b32 v80, v80, v33, s65 bitop3:0xf6
    v_bitop3_b32 v80, v80, v35, s65 bitop3:0xf6
    v_bitop3_b32 v80, v80, v37, s65 bitop3:0xf6
    v_bitop3_b32 v80, v80, v39, s65 bitop3:0xf6
    v_bitop3_b32 v80, v80, v41, s65 bitop3:0xf6
    v_bitop3_b32 v80, v80, v43, s65 bitop3:0xf6
    v_mfma_f32_32x32x16_bf16 v[176:191], a[236:239], v[116:119], v[176:191]
    ds_read_b64_tr_b16 v[110:111], v17 offset:12800
    v_add_u32 v16, 0x1c000, v120
    v_xor_b32 v17, 32, v16
    s_add_u32 m0, s71, 133120
    s_nop 0
    buffer_load_dwordx4 v10, s[36:39], s70 offen offset:0 lds
    v_cmp_ne_u32 vcc, 0, v80
    s_cbranch_vccnz L_retry_Hg
L_back_Hg:
    s_waitcnt lgkmcnt(6)
    v_mfma_f32_32x32x16_bf16 v[128:143], a[240:243], v[96:99], v[128:143]
    s_waitcnt vmcnt(3)
    s_barrier
    ds_read_b64_tr_b16 v[112:113], v16 offset:0
    v_mov_b32 v46, v44
    v_mfma_f32_32x32x16_bf16 v[144:159], a[244:247], v[96:99], v[144:159]
    ds_read_b64_tr_b16 v[114:115], v16 offset:512
    buffer_load_dwordx4 v11, s[36:39], s70 offen offset:1024 lds
    s_mov_b32 s77, 0x01000100
    v_permlane32_swap_b32 v44, v46
    v_and_b32 v58, 0xffff0000, v44
    v_xor_b32 v44, 0x8000, v44
    v_rcp_f32 v56, v58
    v_mfma_f32_32x32x16_bf16 v[160:175], a[240:243], v[100:103], v[160:175]
    ds_read_b64_tr_b16 v[116:117], v17 offset:0
    s_add_u32 s70, s70, 229376
    s_add_u32 m0, s71, 0
    s_nop 0
    buffer_load_dwordx4 v8, s[32:35], s70 offen offset:0 lds
    v_perm_b32 v48, v44, v44, s77
    v_mov_b32 v49, 0
    v_mfma_f32_32x32x16_bf16 v[176:191], a[244:247], v[100:103], v[176:191]
    ds_read_b64_tr_b16 v[118:119], v17 offset:512
    v_mov_b32 v50, v48
    v_mov_b32 v51, 0
    v_mul_f32 v56, 0x3fb8aa3b, v56
    v_and_b32 v59, 0xffff0000, v46
    v_xor_b32 v46, 0x8000, v46
    v_rcp_f32 v57, v59
    s_waitcnt lgkmcnt(4)
    v_mfma_f32_32x32x16_bf16 v[128:143], a[248:251], v[104:107], v[128:143]
    ds_read_b64_tr_b16 v[96:97], v16 offset:4096
    v_perm_b32 v52, v46, v46, s77
    v_mov_b32 v53, 0
    v_mov_b32 v54, v52
    v_mov_b32 v55, 0
    v_mul_f32 v57, 0x3fb8aa3b, v57
    v_mfma_f32_32x32x16_bf16 v[128:143], v[48:51], v[24:27], v[128:143]
    v_mfma_f32_32x32x16_bf16 v[144:159], v[52:55], v[24:27], v[144:159]
    buffer_load_dwordx4 v9, s[32:35], s70 offen offset:1024 lds
    v_mfma_f32_32x32x16_bf16 v[160:175], v[48:51], v[28:31], v[160:175]
    v_mfma_f32_32x32x16_bf16 v[176:191], v[52:55], v[28:31], v[176:191]
    s_add_u32 s76, s71, 147456
    v_and_b32 v19, 31, v1
    v_lshl_add_u32 v19, v19, 2, s76
    v_lshrrev_b32 v20, 5, v1
    v_lshl_add_u32 v20, v20, 4, s76
    ds_write_b32 v19, v56
    ds_write_b32 v19, v57 offset:128
    ds_read_b128 v[64:67], v20 offset:0
    ds_read_b128 v[68:71], v20 offset:32
    v_mfma_f32_32x32x16_bf16 v[144:159], a[252:255], v[104:107], v[144:159]
    ds_read_b64_tr_b16 v[98:99], v16 offset:4608
    s_add_u32 m0, s71, 2048
    s_nop 0
    buffer_load_dwordx4 v10, s[36:39], s70 offen offset:0 lds
    ds_read_b128 v[72:75], v20 offset:64
    ds_read_b128 v[76:79], v20 offset:96
    ds_read_b128 v[80:83], v20 offset:128
    v_mfma_f32_32x32x16_bf16 v[160:175], a[248:251], v[108:111], v[160:175]
    ds_read_b64_tr_b16 v[100:101], v17 offset:4096
    ds_read_b128 v[84:87], v20 offset:160
    ds_read_b128 v[88:91], v20 offset:192
    ds_read_b128 v[92:95], v20 offset:224
    v_add_u32 v19, s76, v2
    v_xor_b32 v20, 0x2000, v19
    v_mfma_f32_32x32x16_bf16 v[176:191], a[252:255], v[108:111], v[176:191]
    ds_read_b64_tr_b16 v[102:103], v17 offset:4608
    s_waitcnt lgkmcnt(14)
    v_mfma_f32_32x32x16_bf16 v[192:207], v[112:115], a[0:3], 0
    ds_read_b64_tr_b16 v[104:105], v16 offset:8192
    buffer_load_dwordx4 v11, s[36:39], s70 offen offset:1024 lds
    v_mfma_f32_32x32x16_bf16 v[208:223], v[112:115], a[4:7], 0
    ds_read_b64_tr_b16 v[106:107], v16 offset:8704
    s_waitcnt lgkmcnt(3)
    v_mul_f32 v128, v64, v128
    v_mul_f32 v129, v65, v129
    v_mul_f32 v130, v66, v130
    v_mul_f32 v131, v67, v131
    v_exp_f32 v24, v128 clamp
    v_mfma_f32_32x32x16_bf16 v[224:239], v[116:119], a[0:3], 0
    ds_read_b64_tr_b16 v[108:109], v17 offset:8192
    s_add_u32 s70, s70, 229376
    s_add_u32 m0, s71, 16384
    s_nop 0
    buffer_load_dwordx4 v8, s[32:35], s70 offen offset:0 lds
    v_exp_f32 v25, v129 clamp
    v_exp_f32 v26, v130 clamp
    v_mfma_f32_32x32x16_bf16 v[240:255], v[116:119], a[4:7], 0
    ds_read_b64_tr_b16 v[110:111], v17 offset:8704
    v_exp_f32 v27, v131 clamp
    v_max_f32 v128, 0x35c1a2a0, v128
    v_max_f32 v129, 0x35c1a2a0, v129
    v_max_f32 v130, 0x35c1a2a0, v130
    v_max_f32 v131, 0x35c1a2a0, v131
    s_waitcnt lgkmcnt(4)
    v_mfma_f32_32x32x16_bf16 v[192:207], v[96:99], a[8:11], v[192:207]
    ds_read_b64_tr_b16 v[112:113], v16 offset:12288
    v_fmac_f32 v24, 0x3f317218, v128
    v_fmac_f32 v25, 0x3f317218, v129
    v_fmac_f32 v26, 0x3f317218, v130
    v_fmac_f32 v27, 0x3f317218, v131
    v_cvt_pk_bf16_f32 v128, v24, v25
    v_cvt_pk_bf16_f32 v129, v26, v27
    v_mul_f32 v132, v68, v132
    v_mul_f32 v133, v69, v133
    v_mfma_f32_32x32x16_bf16 v[208:223], v[96:99], a[12:15], v[208:223]
    ds_read_b64_tr_b16 v[114:115], v16 offset:12800
    v_add_u32 v16, 0x4000, v16
    buffer_load_dwordx4 v9, s[32:35], s70 offen offset:1024 lds
    v_mul_f32 v134, v70, v134
    v_mul_f32 v135, v71, v135
    v_exp_f32 v24, v132 clamp
    v_exp_f32 v25, v133 clamp
    v_mfma_f32_32x32x16_bf16 v[224:239], v[100:103], a[8:11], v[224:239]
    ds_read_b64_tr_b16 v[116:117], v17 offset:12288
    v_exp_f32 v26, v134 clamp
    v_exp_f32 v27, v135 clamp
    v_max_f32 v132, 0x35c1a2a0, v132
    v_max_f32 v133, 0x35c1a2a0, v133
    v_max_f32 v134, 0x35c1a2a0, v134
    v_mfma_f32_32x32x16_bf16 v[240:255], v[100:103], a[12:15], v[240:255]
    ds_read_b64_tr_b16 v[118:119], v17 offset:12800
    v_add_u32 v17, 0x4000, v17
    s_add_u32 m0, s71, 18432
    s_nop 0
    buffer_load_dwordx4 v10, s[36:39], s70 offen offset:0 lds
    v_max_f32 v135, 0x35c1a2a0, v135
    v_fmac_f32 v24, 0x3f317218, v132
    v_fmac_f32 v25, 0x3f317218, v133
    s_waitcnt lgkmcnt(4)
    v_mfma_f32_32x32x16_bf16 v[192:207], v[104:107], a[16:19], v[192:207]
    s_waitcnt vmcnt(7)
    s_barrier
    ds_read_b64_tr_b16 v[96:97], v16 offset:0
    v_fmac_f32 v26, 0x3f317218, v134
    v_fmac_f32 v27, 0x3f317218, v135
    v_mfma_f32_32x32x16_bf16 v[208:223], v[104:107], a[20:23], v[208:223]
    ds_read_b64_tr_b16 v[98:99], v16 offset:512
    v_cvt_pk_bf16_f32 v130, v24, v25
    v_cvt_pk_bf16_f32 v131, v26, v27
    v_mul_f32 v136, v72, v136
    v_mul_f32 v137, v73, v137
    v_mul_f32 v138, v74, v138
    v_mul_f32 v139, v75, v139
    v_exp_f32 v24, v136 clamp
    v_mfma_f32_32x32x16_bf16 v[224:239], v[108:111], a[16:19], v[224:239]
    ds_read_b64_tr_b16 v[100:101], v17 offset:0
    buffer_load_dwordx4 v11, s[36:39], s70 offen offset:1024 lds
    v_exp_f32 v25, v137 clamp
    v_exp_f32 v26, v138 clamp
    v_exp_f32 v27, v139 clamp
    v_mfma_f32_32x32x16_bf16 v[240:255], v[108:111], a[20:23], v[240:255]
    ds_read_b64_tr_b16 v[102:103], v17 offset:512
    v_max_f32 v136, 0x35c1a2a0, v136
    v_max_f32 v137, 0x35c1a2a0, v137
    v_max_f32 v138, 0x35c1a2a0, v138
    v_max_f32 v139, 0x35c1a2a0, v139
    v_fmac_f32 v24, 0x3f317218, v136
    v_fmac_f32 v25, 0x3f317218, v137
    v_fmac_f32 v26, 0x3f317218, v138
    v_fmac_f32 v27, 0x3f317218, v139
    s_waitcnt lgkmcnt(4)
    v_mfma_f32_32x32x16_bf16 v[192:207], v[112:115], a[24:27], v[192:207]
    ds_read_b64_tr_b16 v[104:105], v16 offset:4096
    s_add_u32 s70, s70, 229376
    s_mul_i32 s3, s1, 1835008
    s_sub_u32 s70, s70, s3
    s_add_u32 m0, s71, 32768
    s_nop 0
    buffer_load_dwordx4 v8, s[32:35], s70 offen offset:0 lds
    v_cvt_pk_bf16_f32 v132, v24, v25
    v_cvt_pk_bf16_f32 v133, v26, v27
    v_mfma_f32_32x32x16_bf16 v[208:223], v[112:115], a[28:31], v[208:223]
    ds_read_b64_tr_b16 v[106:107], v16 offset:4608
    v_mul_f32 v140, v76, v140
    v_mul_f32 v141, v77, v141
    v_mul_f32 v142, v78, v142
    v_mul_f32 v143, v79, v143
    v_exp_f32 v24, v140 clamp
    v_exp_f32 v25, v141 clamp
    v_mfma_f32_32x32x16_bf16 v[224:239], v[116:119], a[24:27], v[224:239]
    ds_read_b64_tr_b16 v[108:109], v17 offset:4096
    v_exp_f32 v26, v142 clamp
    v_exp_f32 v27, v143 clamp
    v_max_f32 v140, 0x35c1a2a0, v140
    v_max_f32 v141, 0x35c1a2a0, v141
    v_max_f32 v142, 0x35c1a2a0, v142
    v_max_f32 v143, 0x35c1a2a0, v143
    v_mfma_f32_32x32x16_bf16 v[240:255], v[116:119], a[28:31], v[240:255]
    ds_read_b64_tr_b16 v[110:111], v17 offset:4608
    buffer_load_dwordx4 v9, s[32:35], s70 offen offset:1024 lds
    v_fmac_f32 v24, 0x3f317218, v140
    v_fmac_f32 v25, 0x3f317218, v141
    v_fmac_f32 v26, 0x3f317218, v142
    v_fmac_f32 v27, 0x3f317218, v143
    v_cvt_pk_bf16_f32 v134, v24, v25
    v_cvt_pk_bf16_f32 v135, v26, v27
    s_waitcnt lgkmcnt(4)
    v_mfma_f32_32x32x16_bf16 v[192:207], v[96:99], a[32:35], v[192:207]
    ds_read_b64_tr_b16 v[112:113], v16 offset:8192
    v_mul_f32 v160, v64, v160
    v_mul_f32 v161, v65, v161
    v_mul_f32 v162, v66, v162
    v_mul_f32 v163, v67, v163
    v_mul_f32 v164, v68, v164
    v_mul_f32 v165, v69, v165
    v_mul_f32 v166, v70, v166
    v_mul_f32 v167, v71, v167
    v_mfma_f32_32x32x16_bf16 v[208:223], v[96:99], a[36:39], v[208:223]
    ds_read_b64_tr_b16 v[114:115], v16 offset:8704
    s_add_u32 m0, s71, 34816
    s_nop 0
    buffer_load_dwordx4 v10, s[36:39], s70 offen offset:0 lds
    s_cmp_eq_u32 s60, 0
    s_cselect_b32 s78, 31, 37
    s_cselect_b32 s0, 4, s60
    s_mul_i32 s0, s0, 304
    s_add_u32 s0, s0, 40656
    s_cmp_eq_u32 s60, 0
    s_cselect_b32 s0, 41856, s0
    v_mfma_f32_32x32x16_bf16 v[224:239], v[100:103], a[32:35], v[224:239]
    ds_read_b64_tr_b16 v[116:117], v17 offset:8192
    s_cmp_eq_u32 s60, 3
    s_cselect_b32 s78, 35, s78
    v_min_u32 v21, s78, v1
    v_lshlrev_b32 v21, 3, v21
    s_andn2_b32 s78, 1073741824, s97
    s_or_b32 s0, s0, s78
    s_and_b32 s78, s65, s97
    v_mov_b32 v22, s78
    s_cmp_eq_u32 s97, 0
    s_cbranch_scc1 L_sk_25
    buffer_load_dwordx2 v[4:5], v21, s[48:51], s0 offen sc1
L_sk_25:
    v_mfma_f32_32x32x16_bf16 v[240:255], v[100:103], a[36:39], v[240:255]
    ds_read_b64_tr_b16 v[118:119], v17 offset:8704
    v_mul_f32 v168, v72, v168
    v_mul_f32 v169, v73, v169
    v_mul_f32 v170, v74, v170
    v_mul_f32 v171, v75, v171
    v_mul_f32 v172, v76, v172
    v_mul_f32 v173, v77, v173
    s_waitcnt lgkmcnt(4)
    v_mfma_f32_32x32x16_bf16 v[192:207], v[104:107], a[40:43], v[192:207]
    ds_read_b64_tr_b16 v[96:97], v16 offset:12288
    buffer_load_dwordx4 v11, s[36:39], s70 offen offset:1024 lds
    v_mul_f32 v174, v78, v174
    v_mul_f32 v175, v79, v175
    v_cvt_pk_bf16_f32 v160, v160, v161
    v_cvt_pk_bf16_f32 v161, v162, v163
    v_cvt_pk_bf16_f32 v162, v164, v165
    v_cvt_pk_bf16_f32 v163, v166, v167
    v_mfma_f32_32x32x16_bf16 v[208:223], v[104:107], a[44:47], v[208:223]
    ds_read_b64_tr_b16 v[98:99], v16 offset:12800
    v_add_u32 v16, 0xfffe0000, v16
    v_cvt_pk_bf16_f32 v164, v168, v169
    v_cvt_pk_bf16_f32 v165, v170, v171
    v_cvt_pk_bf16_f32 v166, v172, v173
    v_cvt_pk_bf16_f32 v167, v174, v175
    v_mul_f32 v144, v80, v144
    v_mul_f32 v145, v81, v145
    v_mul_f32 v146, v82, v146
    v_mfma_f32_32x32x16_bf16 v[224:239], v[108:111], a[40:43], v[224:239]
    ds_read_b64_tr_b16 v[100:101], v17 offset:12288
    s_add_u32 s70, s70, 229376
    s_add_u32 m0, s71, 49152
    s_nop 0
    buffer_load_dwordx4 v8, s[32:35], s70 offen offset:0 lds
    v_mul_f32 v147, v83, v147
    v_exp_f32 v24, v144 clamp
    v_exp_f32 v25, v145 clamp
    v_mfma_f32_32x32x16_bf16 v[240:255], v[108:111], a[44:47], v[240:255]
    ds_read_b64_tr_b16 v[102:103], v17 offset:12800
    v_add_u32 v17, 0xfffe0000, v17
    v_exp_f32 v26, v146 clamp
    v_exp_f32 v27, v147 clamp
    v_max_f32 v144, 0x35c1a2a0, v144
    s_waitcnt lgkmcnt(4)
    v_mfma_f32_32x32x16_bf16 v[192:207], v[112:115], a[48:51], v[192:207]
    s_waitcnt vmcnt(9)
    s_barrier
    ds_read_b64_tr_b16 v[104:105], v16 offset:0
    v_max_f32 v145, 0x35c1a2a0, v145
    v_max_f32 v146, 0x35c1a2a0, v146
    v_max_f32 v147, 0x35c1a2a0, v147
    v_mfma_f32_32x32x16_bf16 v[208:223], v[112:115], a[52:55], v[208:223]
    ds_read_b64_tr_b16 v[106:107], v16 offset:512
    buffer_load_dwordx4 v9, s[32:35], s70 offen offset:1024 lds
    v_fmac_f32 v24, 0x3f317218, v144
    v_fmac_f32 v25, 0x3f317218, v145
    v_fmac_f32 v26, 0x3f317218, v146
    v_fmac_f32 v27, 0x3f317218, v147
    v_cvt_pk_bf16_f32 v144, v24, v25
    v_cvt_pk_bf16_f32 v145, v26, v27
    v_mfma_f32_32x32x16_bf16 v[224:239], v[116:119], a[48:51], v[224:239]
    ds_read_b64_tr_b16 v[108:109], v17 offset:0
    v_mul_f32 v148, v84, v148
    v_mul_f32 v149, v85, v149
    v_mul_f32 v150, v86, v150
    v_mul_f32 v151, v87, v151
    v_exp_f32 v24, v148 clamp
    v_exp_f32 v25, v149 clamp
    v_mfma_f32_32x32x16_bf16 v[240:255], v[116:119], a[52:55], v[240:255]
    ds_read_b64_tr_b16 v[110:111], v17 offset:512
    s_add_u32 m0, s71, 51200
    s_nop 0
    buffer_load_dwordx4 v10, s[36:39], s70 offen offset:0 lds
    v_exp_f32 v26, v150 clamp
    v_exp_f32 v27, v151 clamp
    s_waitcnt lgkmcnt(4)
    v_mfma_f32_32x32x16_bf16 v[192:207], v[96:99], a[56:59], v[192:207]
    ds_read_b64_tr_b16 v[112:113], v16 offset:4096
    v_max_f32 v148, 0x35c1a2a0, v148
    v_max_f32 v149, 0x35c1a2a0, v149
    v_max_f32 v150, 0x35c1a2a0, v150
    v_max_f32 v151, 0x35c1a2a0, v151
    v_fmac_f32 v24, 0x3f317218, v148
    v_fmac_f32 v25, 0x3f317218, v149
    v_fmac_f32 v26, 0x3f317218, v150
    v_fmac_f32 v27, 0x3f317218, v151
    v_mfma_f32_32x32x16_bf16 v[208:223], v[96:99], a[60:63], v[208:223]
    ds_read_b64_tr_b16 v[114:115], v16 offset:4608
    v_cvt_pk_bf16_f32 v146, v24, v25
    v_cvt_pk_bf16_f32 v147, v26, v27
    v_mul_f32 v152, v88, v152
    v_mul_f32 v153, v89, v153
    v_mul_f32 v154, v90, v154
    v_mul_f32 v155, v91, v155
    v_exp_f32 v24, v152 clamp
    v_mfma_f32_32x32x16_bf16 v[224:239], v[100:103], a[56:59], v[224:239]
    ds_read_b64_tr_b16 v[116:117], v17 offset:4096
    buffer_load_dwordx4 v11, s[36:39], s70 offen offset:1024 lds
    v_exp_f32 v25, v153 clamp
    v_exp_f32 v26, v154 clamp
    v_exp_f32 v27, v155 clamp
    v_mfma_f32_32x32x16_bf16 v[240:255], v[100:103], a[60:63], v[240:255]
    ds_read_b64_tr_b16 v[118:119], v17 offset:4608
    v_max_f32 v152, 0x35c1a2a0, v152
    v_max_f32 v153, 0x35c1a2a0, v153
    v_max_f32 v154, 0x35c1a2a0, v154
    v_max_f32 v155, 0x35c1a2a0, v155
    v_fmac_f32 v24, 0x3f317218, v152
    v_fmac_f32 v25, 0x3f317218, v153
    v_fmac_f32 v26, 0x3f317218, v154
    s_waitcnt lgkmcnt(4)
    v_mfma_f32_32x32x16_bf16 v[192:207], v[104:107], a[64:67], v[192:207]
    ds_read_b64_tr_b16 v[96:97], v16 offset:8192
    s_add_u32 s70, s70, 229376
    s_add_u32 m0, s71, 65536
    s_nop 0
    buffer_load_dwordx4 v8, s[32:35], s70 offen offset:0 lds
    v_fmac_f32 v27, 0x3f317218, v155
    v_cvt_pk_bf16_f32 v148, v24, v25
    v_cvt_pk_bf16_f32 v149, v26, v27
    v_mul_f32 v156, v92, v156
    v_mfma_f32_32x32x16_bf16 v[208:223], v[104:107], a[68:71], v[208:223]
    ds_read_b64_tr_b16 v[98:99], v16 offset:8704
    v_mul_f32 v157, v93, v157
    v_mul_f32 v158, v94, v158
    v_mul_f32 v159, v95, v159
    v_exp_f32 v24, v156 clamp
    v_exp_f32 v25, v157 clamp
    v_exp_f32 v26, v158 clamp
    v_mfma_f32_32x32x16_bf16 v[224:239], v[108:111], a[64:67], v[224:239]
    ds_read_b64_tr_b16 v[100:101], v17 offset:8192
    v_exp_f32 v27, v159 clamp
    v_max_f32 v156, 0x35c1a2a0, v156
    v_max_f32 v157, 0x35c1a2a0, v157
    v_max_f32 v158, 0x35c1a2a0, v158
    v_max_f32 v159, 0x35c1a2a0, v159
    v_fmac_f32 v24, 0x3f317218, v156
    v_mfma_f32_32x32x16_bf16 v[240:255], v[108:111], a[68:71], v[240:255]
    ds_read_b64_tr_b16 v[102:103], v17 offset:8704
    buffer_load_dwordx4 v9, s[32:35], s70 offen offset:1024 lds
    s_cmp_eq_u32 s97, 0
    s_cbranch_scc1 L_sk_26
    s_waitcnt vmcnt(7)
    v_xor_b32 v15, v22, v4
    v_bitop3_b32 v15, v15, v5, v22 bitop3:0xf6
    v_cmp_ne_u32 vcc, 0, v15
    s_cbranch_vccnz L_retry_cpH
L_back_cpH:
L_sk_26:
    s_waitcnt lgkmcnt(4)
    v_mfma_f32_32x32x16_bf16 v[192:207], v[112:115], a[72:75], v[192:207]
    ds_read_b64_tr_b16 v[104:105], v16 offset:12288
    v_fmac_f32 v25, 0x3f317218, v157
    v_fmac_f32 v26, 0x3f317218, v158
    v_fmac_f32 v27, 0x3f317218, v159
    v_cvt_pk_bf16_f32 v150, v24, v25
    v_cvt_pk_bf16_f32 v151, v26, v27
    v_mul_f32 v176, v80, v176
    v_mul_f32 v177, v81, v177
    v_mul_f32 v178, v82, v178
    v_mfma_f32_32x32x16_bf16 v[208:223], v[112:115], a[76:79], v[208:223]
    ds_read_b64_tr_b16 v[106:107], v16 offset:12800
    v_add_u32 v16, 0x4000, v16
    s_add_u32 m0, s71, 67584
    s_nop 0
    buffer_load_dwordx4 v10, s[36:39], s70 offen offset:0 lds
    v_mul_f32 v179, v83, v179
    v_mul_f32 v180, v84, v180
    v_mul_f32 v181, v85, v181
    v_mfma_f32_32x32x16_bf16 v[224:239], v[116:119], a[72:75], v[224:239]
    ds_read_b64_tr_b16 v[108:109], v17 offset:12288
    v_mul_f32 v182, v86, v182
    v_mul_f32 v183, v87, v183
    v_mul_f32 v184, v88, v184
    v_mul_f32 v185, v89, v185
    v_mul_f32 v186, v90, v186
    v_mul_f32 v187, v91, v187
    v_mul_f32 v188, v92, v188
    v_mul_f32 v189, v93, v189
    v_mfma_f32_32x32x16_bf16 v[240:255], v[116:119], a[76:79], v[240:255]
    ds_read_b64_tr_b16 v[110:111], v17 offset:12800
    v_add_u32 v17, 0x4000, v17
    v_mul_f32 v190, v94, v190
    v_mul_f32 v191, v95, v191
    v_cvt_pk_bf16_f32 v176, v176, v177
    v_cvt_pk_bf16_f32 v177, v178, v179
    v_cvt_pk_bf16_f32 v178, v180, v181
    v_cvt_pk_bf16_f32 v179, v182, v183
    v_cvt_pk_bf16_f32 v180, v184, v185
    s_waitcnt lgkmcnt(4)
    v_mfma_f32_32x32x16_bf16 v[192:207], v[96:99], a[80:83], v[192:207]
    s_waitcnt vmcnt(11)
    s_barrier
    ds_read_b64_tr_b16 v[112:113], v16 offset:0
    buffer_load_dwordx4 v11, s[36:39], s70 offen offset:1024 lds
    v_mfma_f32_32x32x16_bf16 v[208:223], v[96:99], a[84:87], v[208:223]
    ds_read_b64_tr_b16 v[114:115], v16 offset:512
    v_cvt_pk_bf16_f32 v181, v186, v187
    v_cvt_pk_bf16_f32 v182, v188, v189
    v_cvt_pk_bf16_f32 v183, v190, v191
    v_mfma_f32_32x32x16_bf16 v[64:79], v[128:131], v[160:163], 0
    s_add_u32 s70, s70, 229376
    s_add_u32 m0, s71, 81920
    s_nop 0
    buffer_load_dwordx4 v8, s[32:35], s70 offen offset:0 lds
    v_mfma_f32_32x32x16_bf16 v[80:95], v[128:131], v[60:63], 0
    v_mfma_f32_32x32x16_bf16 v[64:79], v[132:135], v[164:167], v[64:79]
    v_mfma_f32_32x32x16_bf16 v[80:95], v[132:135], v[60:63], v[80:95]
    buffer_load_dwordx4 v9, s[32:35], s70 offen offset:1024 lds
    v_mfma_f32_32x32x16_bf16 v[64:79], v[144:147], v[176:179], v[64:79]
    v_mfma_f32_32x32x16_bf16 v[80:95], v[144:147], v[60:63], v[80:95]
    v_mfma_f32_32x32x16_bf16 v[64:79], v[148:151], v[180:183], v[64:79]
    s_add_u32 m0, s71, 83968
    s_nop 0
    buffer_load_dwordx4 v10, s[36:39], s70 offen offset:0 lds
    v_mfma_f32_32x32x16_bf16 v[80:95], v[148:151], v[60:63], v[80:95]
    v_mfma_f32_32x32x16_bf16 v[192:207], v[32:35], v[48:51], v[192:207]
    v_mfma_f32_32x32x16_bf16 v[224:239], v[100:103], a[80:83], v[224:239]
    ds_read_b64_tr_b16 v[116:117], v17 offset:0
    buffer_load_dwordx4 v11, s[36:39], s70 offen offset:1024 lds
    s_nop 7
    v_cndmask_b32 v64, v64, v80, s[10:11]
    v_mfma_f32_32x32x16_bf16 v[240:255], v[100:103], a[84:87], v[240:255]
    ds_read_b64_tr_b16 v[118:119], v17 offset:512
    v_cndmask_b32 v65, v65, v81, s[10:11]
    v_cndmask_b32 v66, v66, v82, s[10:11]
    v_cndmask_b32 v67, v67, v83, s[10:11]
    v_cndmask_b32 v68, v68, v84, s[10:11]
    v_cndmask_b32 v69, v69, v85, s[10:11]
    s_waitcnt lgkmcnt(4)
    v_mfma_f32_32x32x16_bf16 v[192:207], v[104:107], a[88:91], v[192:207]
    ds_read_b64_tr_b16 v[96:97], v16 offset:4096
    v_cndmask_b32 v70, v70, v86, s[10:11]
    v_cndmask_b32 v71, v71, v87, s[10:11]
    v_cndmask_b32 v72, v88, v72, s[10:11]
    v_cndmask_b32 v73, v89, v73, s[10:11]
    v_cndmask_b32 v74, v90, v74, s[10:11]
    v_cndmask_b32 v75, v91, v75, s[10:11]
    v_cndmask_b32 v76, v92, v76, s[10:11]
    v_cndmask_b32 v77, v93, v77, s[10:11]
    v_mfma_f32_32x32x16_bf16 v[208:223], v[104:107], a[92:95], v[208:223]
    ds_read_b64_tr_b16 v[98:99], v16 offset:4608
    s_add_u32 s70, s70, 229376
    v_mov_b32 v8, v124
    v_add_u32 v9, 56320, v124
    v_xor_b32 v10, 32, v124
    v_add_u32 v11, 56320, v10
    s_mul_i32 s70, s64, 64
    s_mul_i32 s3, s60, 114688
    s_add_u32 s70, s70, s3
    s_mul_i32 s3, s1, 917504
    v_cndmask_b32 v78, v94, v78, s[10:11]
    v_mfma_f32_32x32x16_bf16 v[224:239], v[108:111], a[88:91], v[224:239]
    ds_read_b64_tr_b16 v[100:101], v17 offset:4096
    s_add_u32 s70, s70, s3
    s_add_u32 s70, s70, 3072
    s_add_u32 m0, s71, 98304
    s_nop 0
    buffer_load_dwordx4 v8, s[32:35], s70 offen offset:0 lds
    v_cndmask_b32 v79, v95, v79, s[10:11]
    ds_write_b128 v19, v[64:67] offset:0
    v_mfma_f32_32x32x16_bf16 v[240:255], v[108:111], a[92:95], v[240:255]
    ds_read_b64_tr_b16 v[102:103], v17 offset:4608
    ds_write_b128 v19, v[68:71] offset:1024
    ds_write_b128 v19, v[72:75] offset:2048
    ds_write_b128 v19, v[76:79] offset:3072
    s_waitcnt lgkmcnt(8)
    v_mfma_f32_32x32x16_bf16 v[192:207], v[112:115], a[96:99], v[192:207]
    ds_read_b64_tr_b16 v[104:105], v16 offset:8192
    v_mfma_f32_32x32x16_bf16 v[208:223], v[32:35], v[52:55], v[208:223]
    v_mfma_f32_32x32x16_bf16 v[208:223], v[112:115], a[100:103], v[208:223]
    ds_read_b64_tr_b16 v[106:107], v16 offset:8704
    s_waitcnt lgkmcnt(2)
    s_barrier
    ds_read_b128 v[80:83], v20 offset:0
    ds_read_b128 v[84:87], v20 offset:1024
    ds_read_b128 v[88:91], v20 offset:2048
    v_mfma_f32_32x32x16_bf16 v[224:239], v[116:119], a[96:99], v[224:239]
    ds_read_b64_tr_b16 v[108:109], v17 offset:8192
    buffer_load_dwordx4 v9, s[32:35], s70 offen offset:1024 lds
    ds_read_b128 v[92:95], v20 offset:3072
    v_mfma_f32_32x32x16_bf16 v[240:255], v[116:119], a[100:103], v[240:255]
    ds_read_b64_tr_b16 v[110:111], v17 offset:8704
    v_mfma_f32_32x32x16_bf16 v[224:239], v[36:39], v[48:51], v[224:239]
    s_waitcnt lgkmcnt(11)
    v_mfma_f32_32x32x16_bf16 v[192:207], v[96:99], a[104:107], v[192:207]
    ds_read_b64_tr_b16 v[112:113], v16 offset:12288
    s_waitcnt lgkmcnt(2)
    v_add_f32 v64, v64, v80
    v_add_f32 v65, v65, v81
    v_add_f32 v66, v66, v82
    v_add_f32 v67, v67, v83
    v_add_f32 v68, v68, v84
    v_add_f32 v69, v69, v85
    v_add_f32 v70, v70, v86
    v_add_f32 v71, v71, v87
    v_mfma_f32_32x32x16_bf16 v[208:223], v[96:99], a[108:111], v[208:223]
    ds_read_b64_tr_b16 v[114:115], v16 offset:12800
    v_add_u32 v16, 0x4000, v16
    v_add_f32 v72, v72, v88
    v_add_f32 v73, v73, v89
    v_add_f32 v74, v74, v90
    v_add_f32 v75, v75, v91
    v_add_f32 v76, v76, v92
    v_add_f32 v77, v77, v93
    v_add_f32 v78, v78, v94
    v_mfma_f32_32x32x16_bf16 v[224:239], v[100:103], a[104:107], v[224:239]
    ds_read_b64_tr_b16 v[116:117], v17 offset:12288
    s_add_u32 m0, s71, 100352
    s_nop 0
    buffer_load_dwordx4 v10, s[36:39], s70 offen offset:0 lds
    v_add_f32 v79, v79, v95
    v_cvt_pk_bf16_f32 v80, v64, v65
    v_cvt_pk_bf16_f32 v81, v66, v67
    v_cvt_pk_bf16_f32 v82, v68, v69
    v_mfma_f32_32x32x16_bf16 v[240:255], v[100:103], a[108:111], v[240:255]
    ds_read_b64_tr_b16 v[118:119], v17 offset:12800
    v_add_u32 v17, 0x4000, v17
    v_cvt_pk_bf16_f32 v83, v70, v71
    v_cvt_pk_bf16_f32 v84, v72, v73
    v_cvt_pk_bf16_f32 v85, v74, v75
    v_cvt_pk_bf16_f32 v86, v76, v77
    v_cvt_pk_bf16_f32 v87, v78, v79
    v_and_b32 v19, 15, v1
    v_lshrrev_b32 v20, 5, v1
    s_waitcnt lgkmcnt(4)
    v_mfma_f32_32x32x16_bf16 v[192:207], v[104:107], a[112:115], v[192:207]
    s_waitcnt vmcnt(15)
    s_barrier
    ds_read_b64_tr_b16 v[96:97], v16 offset:0
    v_lshl_add_u32 v19, v20, 4, v19
    v_lshlrev_b32 v19, 4, v19
    v_mfma_f32_32x32x16_bf16 v[208:223], v[104:107], a[116:119], v[208:223]
    ds_read_b64_tr_b16 v[98:99], v16 offset:512
    v_lshlrev_b32 v20, 4, v20
    v_add_u32 v20, 512, v20
    v_and_b32 v0, 15, v1
    v_lshl_add_u32 v20, v0, 26, v20
    v_bfe_u32 v0, v1, 4, 1
    v_cmp_eq_u32 vcc, s61, v0
    s_nop 1
    v_cndmask_b32 v19, v20, v19, vcc
    v_mfma_f32_32x32x16_bf16 v[224:239], v[108:111], a[112:115], v[224:239]
    ds_read_b64_tr_b16 v[100:101], v17 offset:0
    s_cmp_eq_u32 s61, 0
    s_cselect_b64 vcc, 0, -1
    v_cndmask_b32 v80, v80, v84, vcc
    v_cndmask_b32 v81, v81, v85, vcc
    v_cndmask_b32 v82, v82, v86, vcc
    v_cndmask_b32 v83, v83, v87, vcc
    buffer_store_dwordx4 v[80:83], v19, s[48:51], s91 offen sc1
    v_mfma_f32_32x32x16_bf16 v[240:255], v[108:111], a[116:119], v[240:255]
    ds_read_b64_tr_b16 v[102:103], v17 offset:512
    v_mfma_f32_32x32x16_bf16 v[240:255], v[36:39], v[52:55], v[240:255]
    buffer_load_dwordx4 v11, s[36:39], s70 offen offset:1024 lds
    s_waitcnt lgkmcnt(4)
    v_mfma_f32_32x32x16_bf16 v[192:207], v[112:115], a[120:123], v[192:207]
    ds_read_b64_tr_b16 v[104:105], v16 offset:4096
    v_mfma_f32_32x32x16_bf16 v[208:223], v[112:115], a[124:127], v[208:223]
    ds_read_b64_tr_b16 v[106:107], v16 offset:4608
    v_mfma_f32_32x32x16_bf16 v[224:239], v[116:119], a[120:123], v[224:239]
    ds_read_b64_tr_b16 v[108:109], v17 offset:4096
    v_mfma_f32_32x32x16_bf16 v[240:255], v[116:119], a[124:127], v[240:255]
    ds_read_b64_tr_b16 v[110:111], v17 offset:4608
    s_waitcnt lgkmcnt(4)
    v_mfma_f32_32x32x16_bf16 v[192:207], v[96:99], a[128:131], v[192:207]
    ds_read_b64_tr_b16 v[112:113], v16 offset:8192
    s_add_u32 s70, s70, 458752
    s_add_u32 m0, s71, 114688
    s_nop 0
    buffer_load_dwordx4 v8, s[32:35], s70 offen offset:0 lds
    v_mfma_f32_32x32x16_bf16 v[208:223], v[96:99], a[132:135], v[208:223]
    ds_read_b64_tr_b16 v[114:115], v16 offset:8704
    v_mfma_f32_32x32x16_bf16 v[224:239], v[100:103], a[128:131], v[224:239]
    ds_read_b64_tr_b16 v[116:117], v17 offset:8192
    v_mfma_f32_32x32x16_bf16 v[240:255], v[100:103], a[132:135], v[240:255]
    ds_read_b64_tr_b16 v[118:119], v17 offset:8704
    s_waitcnt lgkmcnt(4)
    v_mfma_f32_32x32x16_bf16 v[192:207], v[104:107], a[136:139], v[192:207]
    ds_read_b64_tr_b16 v[96:97], v16 offset:12288
    v_mfma_f32_32x32x16_bf16 v[208:223], v[104:107], a[140:143], v[208:223]
    ds_read_b64_tr_b16 v[98:99], v16 offset:12800
    v_add_u32 v16, 0x4000, v16
    buffer_load_dwordx4 v9, s[32:35], s70 offen offset:1024 lds
    v_mfma_f32_32x32x16_bf16 v[224:239], v[108:111], a[136:139], v[224:239]
    ds_read_b64_tr_b16 v[100:101], v17 offset:12288
    v_mfma_f32_32x32x16_bf16 v[240:255], v[108:111], a[140:143], v[240:255]
    ds_read_b64_tr_b16 v[102:103], v17 offset:12800
    v_add_u32 v17, 0x4000, v17
    s_waitcnt lgkmcnt(4)
    v_mfma_f32_32x32x16_bf16 v[192:207], v[112:115], a[144:147], v[192:207]
    s_waitcnt vmcnt(15)
    s_barrier
    ds_read_b64_tr_b16 v[104:105], v16 offset:0
    v_mfma_f32_32x32x16_bf16 v[208:223], v[112:115], a[148:151], v[208:223]
    ds_read_b64_tr_b16 v[106:107], v16 offset:512
    v_mov_b32 v44, s65
    v_mov_b32 v45, s66
    s_waitcnt vmcnt(3)
    s_mov_b64 exec, 1
    buffer_store_dwordx2 v[44:45], off, s[48:51], s92 sc1
    s_mov_b64 exec, -1
    v_mfma_f32_32x32x16_bf16 v[224:239], v[116:119], a[144:147], v[224:239]
    ds_read_b64_tr_b16 v[108:109], v17 offset:0
    s_add_u32 m0, s71, 116736
    s_nop 0
    buffer_load_dwordx4 v10, s[36:39], s70 offen offset:0 lds
    v_mfma_f32_32x32x16_bf16 v[240:255], v[116:119], a[148:151], v[240:255]
    ds_read_b64_tr_b16 v[110:111], v17 offset:512
    s_waitcnt lgkmcnt(4)
    v_mfma_f32_32x32x16_bf16 v[192:207], v[96:99], a[152:155], v[192:207]
    ds_read_b64_tr_b16 v[112:113], v16 offset:4096
    v_mfma_f32_32x32x16_bf16 v[208:223], v[96:99], a[156:159], v[208:223]
    ds_read_b64_tr_b16 v[114:115], v16 offset:4608
    v_mfma_f32_32x32x16_bf16 v[224:239], v[100:103], a[152:155], v[224:239]
    ds_read_b64_tr_b16 v[116:117], v17 offset:4096
    v_mfma_f32_32x32x16_bf16 v[240:255], v[100:103], a[156:159], v[240:255]
    ds_read_b64_tr_b16 v[118:119], v17 offset:4608
    buffer_load_dwordx4 v11, s[36:39], s70 offen offset:1024 lds
    s_waitcnt lgkmcnt(4)
    v_mfma_f32_32x32x16_bf16 v[192:207], v[104:107], a[160:163], v[192:207]
    ds_read_b64_tr_b16 v[96:97], v16 offset:8192
    v_mfma_f32_32x32x16_bf16 v[208:223], v[104:107], a[164:167], v[208:223]
    ds_read_b64_tr_b16 v[98:99], v16 offset:8704
    v_mfma_f32_32x32x16_bf16 v[224:239], v[108:111], a[160:163], v[224:239]
    ds_read_b64_tr_b16 v[100:101], v17 offset:8192
    v_mfma_f32_32x32x16_bf16 v[240:255], v[108:111], a[164:167], v[240:255]
    ds_read_b64_tr_b16 v[102:103], v17 offset:8704
    s_waitcnt lgkmcnt(4)
    v_mfma_f32_32x32x16_bf16 v[192:207], v[112:115], a[168:171], v[192:207]
    ds_read_b64_tr_b16 v[104:105], v16 offset:12288
    s_add_u32 s70, s70, 458752
    s_mul_i32 s3, s1, 1835008
    s_sub_u32 s70, s70, s3
    s_add_u32 m0, s71, 131072
    s_nop 0
    buffer_load_dwordx4 v8, s[32:35], s70 offen offset:0 lds
    v_mfma_f32_32x32x16_bf16 v[208:223], v[112:115], a[172:175], v[208:223]
    ds_read_b64_tr_b16 v[106:107], v16 offset:12800
    v_add_u32 v16, 0x4000, v16
    v_mfma_f32_32x32x16_bf16 v[224:239], v[116:119], a[168:171], v[224:239]
    ds_read_b64_tr_b16 v[108:109], v17 offset:12288
    v_mfma_f32_32x32x16_bf16 v[240:255], v[116:119], a[172:175], v[240:255]
    ds_read_b64_tr_b16 v[110:111], v17 offset:12800
    v_add_u32 v17, 0x4000, v17
    s_waitcnt lgkmcnt(4)
    v_mfma_f32_32x32x16_bf16 v[192:207], v[96:99], a[176:179], v[192:207]
    s_waitcnt vmcnt(15)
    s_barrier
    ds_read_b64_tr_b16 v[112:113], v16 offset:0
    v_mfma_f32_32x32x16_bf16 v[208:223], v[96:99], a[180:183], v[208:223]
    ds_read_b64_tr_b16 v[114:115], v16 offset:512
    buffer_load_dwordx4 v9, s[32:35], s70 offen offset:1024 lds
    v_mfma_f32_32x32x16_bf16 v[224:239], v[100:103], a[176:179], v[224:239]
    ds_read_b64_tr_b16 v[116:117], v17 offset:0
    v_mfma_f32_32x32x16_bf16 v[240:255], v[100:103], a[180:183], v[240:255]
    ds_read_b64_tr_b16 v[118:119], v17 offset:512
    s_waitcnt lgkmcnt(4)
    v_mfma_f32_32x32x16_bf16 v[192:207], v[104:107], a[184:187], v[192:207]
    ds_read_b64_tr_b16 v[96:97], v16 offset:4096
    v_mfma_f32_32x32x16_bf16 v[208:223], v[104:107], a[188:191], v[208:223]
    ds_read_b64_tr_b16 v[98:99], v16 offset:4608
    v_mfma_f32_32x32x16_bf16 v[224:239], v[108:111], a[184:187], v[224:239]
    ds_read_b64_tr_b16 v[100:101], v17 offset:4096
    s_add_u32 m0, s71, 133120
    s_nop 0
    buffer_load_dwordx4 v10, s[36:39], s70 offen offset:0 lds
    v_mfma_f32_32x32x16_bf16 v[240:255], v[108:111], a[188:191], v[240:255]
    ds_read_b64_tr_b16 v[102:103], v17 offset:4608
    s_waitcnt lgkmcnt(4)
    v_mfma_f32_32x32x16_bf16 v[192:207], v[112:115], a[192:195], v[192:207]
    ds_read_b64_tr_b16 v[104:105], v16 offset:8192
    v_mfma_f32_32x32x16_bf16 v[208:223], v[112:115], a[196:199], v[208:223]
    ds_read_b64_tr_b16 v[106:107], v16 offset:8704
    v_mfma_f32_32x32x16_bf16 v[224:239], v[116:119], a[192:195], v[224:239]
    ds_read_b64_tr_b16 v[108:109], v17 offset:8192
    v_mfma_f32_32x32x16_bf16 v[240:255], v[116:119], a[196:199], v[240:255]
    ds_read_b64_tr_b16 v[110:111], v17 offset:8704
    buffer_load_dwordx4 v11, s[36:39], s70 offen offset:1024 lds
    s_waitcnt lgkmcnt(4)
    v_mfma_f32_32x32x16_bf16 v[192:207], v[96:99], a[200:203], v[192:207]
    ds_read_b64_tr_b16 v[112:113], v16 offset:12288
    v_mfma_f32_32x32x16_bf16 v[208:223], v[96:99], a[204:207], v[208:223]
    ds_read_b64_tr_b16 v[114:115], v16 offset:12800
    v_add_u32 v16, 0x4000, v16
    v_mfma_f32_32x32x16_bf16 v[224:239], v[100:103], a[200:203], v[224:239]
    ds_read_b64_tr_b16 v[116:117], v17 offset:12288
    v_mfma_f32_32x32x16_bf16 v[240:255], v[100:103], a[204:207], v[240:255]
    ds_read_b64_tr_b16 v[118:119], v17 offset:12800
    v_add_u32 v17, 0x4000, v17
    s_waitcnt lgkmcnt(4)
    v_mfma_f32_32x32x16_bf16 v[192:207], v[104:107], a[208:211], v[192:207]
    s_waitcnt vmcnt(14)
    s_barrier
    ds_read_b64_tr_b16 v[96:97], v16 offset:0
    v_mfma_f32_32x32x16_bf16 v[208:223], v[104:107], a[212:215], v[208:223]
    ds_read_b64_tr_b16 v[98:99], v16 offset:512
    s_add_u32 s70, s70, 458752
    s_add_u32 m0, s71, 0
    s_nop 0
    buffer_load_dwordx4 v8, s[32:35], s70 offen offset:0 lds
    v_mfma_f32_32x32x16_bf16 v[224:239], v[108:111], a[208:211], v[224:239]
    ds_read_b64_tr_b16 v[100:101], v17 offset:0
    v_mfma_f32_32x32x16_bf16 v[240:255], v[108:111], a[212:215], v[240:255]
    ds_read_b64_tr_b16 v[102:103], v17 offset:512
    s_waitcnt lgkmcnt(4)
    v_mfma_f32_32x32x16_bf16 v[192:207], v[112:115], a[216:219], v[192:207]
    ds_read_b64_tr_b16 v[104:105], v16 offset:4096
    v_mfma_f32_32x32x16_bf16 v[208:223], v[112:115], a[220:223], v[208:223]
    ds_read_b64_tr_b16 v[106:107], v16 offset:4608
    v_mfma_f32_32x32x16_bf16 v[224:239], v[116:119], a[216:219], v[224:239]
    ds_read_b64_tr_b16 v[108:109], v17 offset:4096
    buffer_load_dwordx4 v9, s[32:35], s70 offen offset:1024 lds
    v_mfma_f32_32x32x16_bf16 v[240:255], v[116:119], a[220:223], v[240:255]
    ds_read_b64_tr_b16 v[110:111], v17 offset:4608
    s_waitcnt lgkmcnt(4)
    v_mfma_f32_32x32x16_bf16 v[192:207], v[96:99], a[224:227], v[192:207]
    ds_read_b64_tr_b16 v[112:113], v16 offset:8192
    v_mfma_f32_32x32x16_bf16 v[208:223], v[96:99], a[228:231], v[208:223]
    ds_read_b64_tr_b16 v[114:115], v16 offset:8704
    v_mfma_f32_32x32x16_bf16 v[224:239], v[100:103], a[224:227], v[224:239]
    ds_read_b64_tr_b16 v[116:117], v17 offset:8192
    v_mfma_f32_32x32x16_bf16 v[240:255], v[100:103], a[228:231], v[240:255]
    ds_read_b64_tr_b16 v[118:119], v17 offset:8704
    s_add_u32 m0, s71, 2048
    s_nop 0
    buffer_load_dwordx4 v10, s[36:39], s70 offen offset:0 lds
    s_waitcnt lgkmcnt(4)
    v_mfma_f32_32x32x16_bf16 v[192:207], v[104:107], a[232:235], v[192:207]
    ds_read_b64_tr_b16 v[96:97], v16 offset:12288
    v_mfma_f32_32x32x16_bf16 v[208:223], v[104:107], a[236:239], v[208:223]
    ds_read_b64_tr_b16 v[98:99], v16 offset:12800
    v_mfma_f32_32x32x16_bf16 v[224:239], v[108:111], a[232:235], v[224:239]
    ds_read_b64_tr_b16 v[100:101], v17 offset:12288
    v_mfma_f32_32x32x16_bf16 v[240:255], v[108:111], a[236:239], v[240:255]
    ds_read_b64_tr_b16 v[102:103], v17 offset:12800
    v_add_u32 v16, 0x18000, v121
    s_waitcnt lgkmcnt(4)
    v_mfma_f32_32x32x16_bf16 v[192:207], v[112:115], a[240:243], v[192:207]
    s_waitcnt vmcnt(12)
    s_barrier
    ds_read_b64_tr_b16 v[104:105], v16 offset:0
    v_mfma_f32_32x32x16_bf16 v[208:223], v[112:115], a[244:247], v[208:223]
    ds_read_b64_tr_b16 v[106:107], v16 offset:256
    buffer_load_dwordx4 v11, s[36:39], s70 offen offset:1024 lds
    v_mfma_f32_32x32x16_bf16 v[224:239], v[116:119], a[240:243], v[224:239]
    ds_read_b64_tr_b16 v[108:109], v16 offset:1024
    v_mfma_f32_32x32x16_bf16 v[240:255], v[116:119], a[244:247], v[240:255]
    ds_read_b64_tr_b16 v[110:111], v16 offset:1280
    s_waitcnt lgkmcnt(4)
    v_mfma_f32_32x32x16_bf16 v[192:207], v[96:99], a[248:251], v[192:207]
    ds_read_b64_tr_b16 v[112:113], v16 offset:4096
    v_mfma_f32_32x32x16_bf16 v[208:223], v[96:99], a[252:255], v[208:223]
    ds_read_b64_tr_b16 v[114:115], v16 offset:4352
    v_mfma_f32_32x32x16_bf16 v[224:239], v[100:103], a[248:251], v[224:239]
    ds_read_b64_tr_b16 v[116:117], v16 offset:5120
    s_add_u32 s70, s70, 458752
    v_mov_b32 v4, v125
    v_add_u32 v5, s14, v4
    v_add_u32 v6, s14, v5
    v_add_u32 v7, s14, v6
    v_mfma_f32_32x32x16_bf16 v[240:255], v[100:103], a[252:255], v[240:255]
    ds_read_b64_tr_b16 v[118:119], v16 offset:5376
    s_add_u32 m0, s71, 16384
    s_nop 0
    buffer_load_dwordx4 v4, s[56:59], s87 offen offset:0 sc1 lds
    s_waitcnt lgkmcnt(4)
    v_mfma_f32_32x32x16_bf16 v[128:143], v[104:107], a[0:3], 0
    ds_read_b64_tr_b16 v[96:97], v16 offset:8192
    v_mfma_f32_32x32x16_bf16 v[144:159], v[104:107], a[4:7], 0
    ds_read_b64_tr_b16 v[98:99], v16 offset:8448
    buffer_load_dwordx4 v5, s[56:59], s87 offen offset:1024 sc1 lds
    v_mfma_f32_32x32x16_bf16 v[128:143], v[108:111], a[8:11], v[128:143]
    ds_read_b64_tr_b16 v[100:101], v16 offset:9216
    v_mfma_f32_32x32x16_bf16 v[144:159], v[108:111], a[12:15], v[144:159]
    ds_read_b64_tr_b16 v[102:103], v16 offset:9472
    v_mfma_f32_32x32x16_bf16 v[128:143], v[40:43], v[48:51], v[128:143]
    buffer_load_dwordx4 v6, s[56:59], s87 offen offset:2048 sc1 lds
    s_mul_i32 s76, s64, 6
    s_add_u32 s76, s76, s62
    s_lshl_b32 s76, s76, 1
    s_add_u32 s76, s76, 8
    s_lshl_b32 s76, s76, 11
    s_add_u32 s76, s76, s73
    v_mul_f32 v192, v56, v192
    s_waitcnt lgkmcnt(4)
    v_mfma_f32_32x32x16_bf16 v[128:143], v[112:115], a[16:19], v[128:143]
    ds_read_b64_tr_b16 v[104:105], v16 offset:12288
    v_mul_f32 v193, v56, v193
    v_mul_f32 v194, v56, v194
    v_mul_f32 v195, v56, v195
    v_mul_f32 v196, v56, v196
    v_mul_f32 v197, v56, v197
    v_mfma_f32_32x32x16_bf16 v[144:159], v[112:115], a[20:23], v[144:159]
    ds_read_b64_tr_b16 v[106:107], v16 offset:12544
    buffer_load_dwordx4 v7, s[56:59], s87 offen offset:3072 sc1 lds
    v_mul_f32 v198, v56, v198
    v_mul_f32 v199, v56, v199
    v_exp_f32 v192, -v192
    v_mfma_f32_32x32x16_bf16 v[128:143], v[116:119], a[24:27], v[128:143]
    ds_read_b64_tr_b16 v[108:109], v16 offset:13312
    v_mfma_f32_32x32x16_bf16 v[144:159], v[40:43], v[52:55], v[144:159]
    v_exp_f32 v193, -v193
    v_exp_f32 v194, -v194
    v_exp_f32 v195, -v195
    v_mfma_f32_32x32x16_bf16 v[144:159], v[116:119], a[28:31], v[144:159]
    ds_read_b64_tr_b16 v[110:111], v16 offset:13568
    v_add_u32 v16, 0x4000, v16
    s_add_u32 s87, s87, s7
    s_add_u32 m0, s71, 32768
    s_nop 0
    buffer_load_dwordx4 v4, s[56:59], s87 offen offset:0 sc1 lds
    s_waitcnt lgkmcnt(4)
    v_mfma_f32_32x32x16_bf16 v[128:143], v[96:99], a[32:35], v[128:143]
    s_waitcnt vmcnt(13)
    s_barrier
    ds_read_b64_tr_b16 v[112:113], v16 offset:0
    v_mfma_f32_32x32x16_bf16 v[144:159], v[96:99], a[36:39], v[144:159]
    ds_read_b64_tr_b16 v[114:115], v16 offset:256
    buffer_load_dwordx4 v5, s[56:59], s87 offen offset:1024 sc1 lds
    v_exp_f32 v196, -v196
    v_mfma_f32_32x32x16_bf16 v[128:143], v[100:103], a[40:43], v[128:143]
    ds_read_b64_tr_b16 v[116:117], v16 offset:1024
    v_exp_f32 v197, -v197
    v_exp_f32 v198, -v198
    v_exp_f32 v199, -v199
    v_mfma_f32_32x32x16_bf16 v[144:159], v[100:103], a[44:47], v[144:159]
    ds_read_b64_tr_b16 v[118:119], v16 offset:1280
    v_fma_f32 v192, v192, v58, v58
    v_fma_f32 v193, v193, v58, v58
    v_fma_f32 v194, v194, v58, v58
    v_fma_f32 v195, v195, v58, v58
    s_waitcnt lgkmcnt(4)
    v_mfma_f32_32x32x16_bf16 v[128:143], v[104:107], a[48:51], v[128:143]
    ds_read_b64_tr_b16 v[96:97], v16 offset:4096
    buffer_load_dwordx4 v6, s[56:59], s87 offen offset:2048 sc1 lds
    v_fma_f32 v196, v196, v58, v58
    v_fma_f32 v197, v197, v58, v58
    v_fma_f32 v198, v198, v58, v58
    v_mfma_f32_32x32x16_bf16 v[144:159], v[104:107], a[52:55], v[144:159]
    ds_read_b64_tr_b16 v[98:99], v16 offset:4352
    v_fma_f32 v199, v199, v58, v58
    v_rcp_f32 v192, v192
    v_rcp_f32 v193, v193
    v_mfma_f32_32x32x16_bf16 v[128:143], v[108:111], a[56:59], v[128:143]
    ds_read_b64_tr_b16 v[100:101], v16 offset:5120
    buffer_load_dwordx4 v7, s[56:59], s87 offen offset:3072 sc1 lds
    v_rcp_f32 v194, v194
    v_rcp_f32 v195, v195
    v_mfma_f32_32x32x16_bf16 v[144:159], v[108:111], a[60:63], v[144:159]
    ds_read_b64_tr_b16 v[102:103], v16 offset:5376
    v_rcp_f32 v196, v196
    v_rcp_f32 v197, v197
    s_waitcnt lgkmcnt(4)
    v_mfma_f32_32x32x16_bf16 v[128:143], v[112:115], a[64:67], v[128:143]
    ds_read_b64_tr_b16 v[104:105], v16 offset:8192
    v_rcp_f32 v198, v198
    v_rcp_f32 v199, v199
    v_mfma_f32_32x32x16_bf16 v[144:159], v[112:115], a[68:71], v[144:159]
    ds_read_b64_tr_b16 v[106:107], v16 offset:8448
    s_add_u32 s87, s87, s7
    s_add_u32 m0, s71, 49152
    s_nop 0
    buffer_load_dwordx4 v4, s[56:59], s87 offen offset:0 sc1 lds
    v_mul_f32 v200, v200, v192
    v_mfma_f32_32x32x16_bf16 v[128:143], v[116:119], a[72:75], v[128:143]
    ds_read_b64_tr_b16 v[108:109], v16 offset:9216
    v_mul_f32 v201, v201, v193
    v_mul_f32 v202, v202, v194
    v_mul_f32 v203, v203, v195
    v_mul_f32 v204, v204, v196
    v_mul_f32 v205, v205, v197
    v_mfma_f32_32x32x16_bf16 v[144:159], v[116:119], a[76:79], v[144:159]
    ds_read_b64_tr_b16 v[110:111], v16 offset:9472
    buffer_load_dwordx4 v5, s[56:59], s87 offen offset:1024 sc1 lds
    v_mul_f32 v206, v206, v198
    v_mul_f32 v207, v207, v199
    s_waitcnt lgkmcnt(4)
    v_mfma_f32_32x32x16_bf16 v[128:143], v[96:99], a[80:83], v[128:143]
    ds_read_b64_tr_b16 v[112:113], v16 offset:12288
    v_cvt_pk_bf16_f32 v192, v200, v201
    v_cvt_pk_bf16_f32 v193, v202, v203
    v_cvt_pk_bf16_f32 v194, v204, v205
    v_cvt_pk_bf16_f32 v195, v206, v207
    buffer_store_dwordx4 v[192:195], v2, s[52:55], s76 offen offset:0 sc1
    v_mfma_f32_32x32x16_bf16 v[144:159], v[96:99], a[84:87], v[144:159]
    ds_read_b64_tr_b16 v[114:115], v16 offset:12544
    v_mul_f32 v208, v57, v208
    v_mul_f32 v209, v57, v209
    v_mul_f32 v210, v57, v210
    v_mul_f32 v211, v57, v211
    v_mfma_f32_32x32x16_bf16 v[128:143], v[100:103], a[88:91], v[128:143]
    ds_read_b64_tr_b16 v[116:117], v16 offset:13312
    v_mul_f32 v212, v57, v212
    v_mul_f32 v213, v57, v213
    v_mul_f32 v214, v57, v214
    v_mul_f32 v215, v57, v215
    v_exp_f32 v208, -v208
    v_mfma_f32_32x32x16_bf16 v[144:159], v[100:103], a[92:95], v[144:159]
    ds_read_b64_tr_b16 v[118:119], v16 offset:13568
    v_add_u32 v16, 0x4000, v16
    v_exp_f32 v209, -v209
    v_exp_f32 v210, -v210
    s_waitcnt lgkmcnt(4)
    v_mfma_f32_32x32x16_bf16 v[128:143], v[104:107], a[96:99], v[128:143]
    s_waitcnt vmcnt(15)
    s_barrier
    ds_read_b64_tr_b16 v[96:97], v16 offset:0
    v_mfma_f32_32x32x16_bf16 v[144:159], v[104:107], a[100:103], v[144:159]
    ds_read_b64_tr_b16 v[98:99], v16 offset:256
    buffer_load_dwordx4 v6, s[56:59], s87 offen offset:2048 sc1 lds
    v_exp_f32 v211, -v211
    v_mfma_f32_32x32x16_bf16 v[128:143], v[108:111], a[104:107], v[128:143]
    ds_read_b64_tr_b16 v[100:101], v16 offset:1024
    v_exp_f32 v212, -v212
    v_exp_f32 v213, -v213
    v_mfma_f32_32x32x16_bf16 v[144:159], v[108:111], a[108:111], v[144:159]
    ds_read_b64_tr_b16 v[102:103], v16 offset:1280
    buffer_load_dwordx4 v7, s[56:59], s87 offen offset:3072 sc1 lds
    v_exp_f32 v214, -v214
    s_waitcnt lgkmcnt(4)
    v_mfma_f32_32x32x16_bf16 v[128:143], v[112:115], a[112:115], v[128:143]
    ds_read_b64_tr_b16 v[104:105], v16 offset:4096
    v_exp_f32 v215, -v215
    v_fma_f32 v208, v208, v59, v59
    v_fma_f32 v209, v209, v59, v59
    v_fma_f32 v210, v210, v59, v59
    v_mfma_f32_32x32x16_bf16 v[144:159], v[112:115], a[116:119], v[144:159]
    ds_read_b64_tr_b16 v[106:107], v16 offset:4352
    v_fma_f32 v211, v211, v59, v59
    v_fma_f32 v212, v212, v59, v59
    v_fma_f32 v213, v213, v59, v59
    v_fma_f32 v214, v214, v59, v59
    v_fma_f32 v215, v215, v59, v59
    v_mfma_f32_32x32x16_bf16 v[128:143], v[116:119], a[120:123], v[128:143]
    ds_read_b64_tr_b16 v[108:109], v16 offset:5120
    s_add_u32 s87, s87, s7
    s_add_u32 m0, s71, 65536
    s_nop 0
    buffer_load_dwordx4 v4, s[56:59], s87 offen offset:0 sc1 lds
    v_rcp_f32 v208, v208
    v_mfma_f32_32x32x16_bf16 v[144:159], v[116:119], a[124:127], v[144:159]
    ds_read_b64_tr_b16 v[110:111], v16 offset:5376
    v_rcp_f32 v209, v209
    v_rcp_f32 v210, v210
    s_waitcnt lgkmcnt(4)
    v_mfma_f32_32x32x16_bf16 v[128:143], v[96:99], a[128:131], v[128:143]
    ds_read_b64_tr_b16 v[112:113], v16 offset:8192
    buffer_load_dwordx4 v5, s[56:59], s87 offen offset:1024 sc1 lds
    v_rcp_f32 v211, v211
    v_rcp_f32 v212, v212
    v_mfma_f32_32x32x16_bf16 v[144:159], v[96:99], a[132:135], v[144:159]
    ds_read_b64_tr_b16 v[114:115], v16 offset:8448
    v_rcp_f32 v213, v213
    v_rcp_f32 v214, v214
    v_mfma_f32_32x32x16_bf16 v[128:143], v[100:103], a[136:139], v[128:143]
    ds_read_b64_tr_b16 v[116:117], v16 offset:9216
    v_rcp_f32 v215, v215
    v_mul_f32 v216, v216, v208
    v_mul_f32 v217, v217, v209
    v_mul_f32 v218, v218, v210
    v_mfma_f32_32x32x16_bf16 v[144:159], v[100:103], a[140:143], v[144:159]
    ds_read_b64_tr_b16 v[118:119], v16 offset:9472
    buffer_load_dwordx4 v6, s[56:59], s87 offen offset:2048 sc1 lds
    v_mul_f32 v219, v219, v211
    v_mul_f32 v220, v220, v212
    s_waitcnt lgkmcnt(4)
    v_mfma_f32_32x32x16_bf16 v[128:143], v[104:107], a[144:147], v[128:143]
    ds_read_b64_tr_b16 v[96:97], v16 offset:12288
    v_mul_f32 v221, v221, v213
    v_mul_f32 v222, v222, v214
    v_mul_f32 v223, v223, v215
    v_cvt_pk_bf16_f32 v208, v216, v217
    v_cvt_pk_bf16_f32 v209, v218, v219
    v_mfma_f32_32x32x16_bf16 v[144:159], v[104:107], a[148:151], v[144:159]
    ds_read_b64_tr_b16 v[98:99], v16 offset:12544
    buffer_load_dwordx4 v7, s[56:59], s87 offen offset:3072 sc1 lds
    v_cvt_pk_bf16_f32 v210, v220, v221
    v_cvt_pk_bf16_f32 v211, v222, v223
    buffer_store_dwordx4 v[208:211], v2, s[52:55], s76 offen offset:1024 sc1
    v_mfma_f32_32x32x16_bf16 v[128:143], v[108:111], a[152:155], v[128:143]
    ds_read_b64_tr_b16 v[100:101], v16 offset:13312
    v_mul_f32 v224, v56, v224
    v_mul_f32 v225, v56, v225
    v_mul_f32 v226, v56, v226
    v_mul_f32 v227, v56, v227
    v_mfma_f32_32x32x16_bf16 v[144:159], v[108:111], a[156:159], v[144:159]
    ds_read_b64_tr_b16 v[102:103], v16 offset:13568
    v_add_u32 v16, 0xfffe0000, v16
    v_mul_f32 v228, v56, v228
    v_mul_f32 v229, v56, v229
    v_mul_f32 v230, v56, v230
    s_waitcnt lgkmcnt(4)
    v_mfma_f32_32x32x16_bf16 v[128:143], v[112:115], a[160:163], v[128:143]
    s_waitcnt vmcnt(18)
    s_barrier
    ds_read_b64_tr_b16 v[104:105], v16 offset:0
    v_mfma_f32_32x32x16_bf16 v[144:159], v[112:115], a[164:167], v[144:159]
    ds_read_b64_tr_b16 v[106:107], v16 offset:256
    v_mul_f32 v231, v56, v231
    v_exp_f32 v224, -v224
    v_exp_f32 v225, -v225
    v_mfma_f32_32x32x16_bf16 v[128:143], v[116:119], a[168:171], v[128:143]
    ds_read_b64_tr_b16 v[108:109], v16 offset:1024
    s_add_u32 s87, s87, s7
    s_add_u32 m0, s71, 81920
    s_nop 0
    buffer_load_dwordx4 v4, s[56:59], s87 offen offset:0 sc1 lds
    v_exp_f32 v226, -v226
    v_mfma_f32_32x32x16_bf16 v[144:159], v[116:119], a[172:175], v[144:159]
    ds_read_b64_tr_b16 v[110:111], v16 offset:1280
    v_exp_f32 v227, -v227
    v_exp_f32 v228, -v228
    s_waitcnt lgkmcnt(4)
    v_mfma_f32_32x32x16_bf16 v[128:143], v[96:99], a[176:179], v[128:143]
    ds_read_b64_tr_b16 v[112:113], v16 offset:4096
    buffer_load_dwordx4 v5, s[56:59], s87 offen offset:1024 sc1 lds
    v_exp_f32 v229, -v229
    v_mfma_f32_32x32x16_bf16 v[144:159], v[96:99], a[180:183], v[144:159]
    ds_read_b64_tr_b16 v[114:115], v16 offset:4352
    v_exp_f32 v230, -v230
    v_exp_f32 v231, -v231
    v_fma_f32 v224, v224, v58, v58
    v_mfma_f32_32x32x16_bf16 v[128:143], v[100:103], a[184:187], v[128:143]
    ds_read_b64_tr_b16 v[116:117], v16 offset:5120
    v_fma_f32 v225, v225, v58, v58
    v_fma_f32 v226, v226, v58, v58
    v_fma_f32 v227, v227, v58, v58
    v_fma_f32 v228, v228, v58, v58
    v_fma_f32 v229, v229, v58, v58
    v_mfma_f32_32x32x16_bf16 v[144:159], v[100:103], a[188:191], v[144:159]
    ds_read_b64_tr_b16 v[118:119], v16 offset:5376
    buffer_load_dwordx4 v6, s[56:59], s87 offen offset:2048 sc1 lds
    v_fma_f32 v230, v230, v58, v58
    v_fma_f32 v231, v231, v58, v58
    s_waitcnt lgkmcnt(4)
    v_mfma_f32_32x32x16_bf16 v[128:143], v[104:107], a[192:195], v[128:143]
    ds_read_b64_tr_b16 v[96:97], v16 offset:8192
    v_rcp_f32 v224, v224
    v_rcp_f32 v225, v225
    v_rcp_f32 v226, v226
    v_mfma_f32_32x32x16_bf16 v[144:159], v[104:107], a[196:199], v[144:159]
    ds_read_b64_tr_b16 v[98:99], v16 offset:8448
    buffer_load_dwordx4 v7, s[56:59], s87 offen offset:3072 sc1 lds
    v_rcp_f32 v227, v227
    v_mfma_f32_32x32x16_bf16 v[128:143], v[108:111], a[200:203], v[128:143]
    ds_read_b64_tr_b16 v[100:101], v16 offset:9216
    v_rcp_f32 v228, v228
    v_rcp_f32 v229, v229
    v_rcp_f32 v230, v230
    v_mfma_f32_32x32x16_bf16 v[144:159], v[108:111], a[204:207], v[144:159]
    ds_read_b64_tr_b16 v[102:103], v16 offset:9472
    v_rcp_f32 v231, v231
    v_mul_f32 v232, v232, v224
    v_mul_f32 v233, v233, v225
    s_waitcnt lgkmcnt(4)
    v_mfma_f32_32x32x16_bf16 v[128:143], v[112:115], a[208:211], v[128:143]
    ds_read_b64_tr_b16 v[104:105], v16 offset:12288
    s_add_u32 s87, s87, s7
    s_add_u32 m0, s71, 98304
    s_nop 0
    buffer_load_dwordx4 v4, s[56:59], s87 offen offset:0 sc1 lds
    v_mul_f32 v234, v234, v226
    v_mfma_f32_32x32x16_bf16 v[144:159], v[112:115], a[212:215], v[144:159]
    ds_read_b64_tr_b16 v[106:107], v16 offset:12544
    v_mul_f32 v235, v235, v227
    v_mul_f32 v236, v236, v228
    v_mul_f32 v237, v237, v229
    v_mul_f32 v238, v238, v230
    v_mul_f32 v239, v239, v231
    v_mfma_f32_32x32x16_bf16 v[128:143], v[116:119], a[216:219], v[128:143]
    ds_read_b64_tr_b16 v[108:109], v16 offset:13312
    buffer_load_dwordx4 v5, s[56:59], s87 offen offset:1024 sc1 lds
    v_cvt_pk_bf16_f32 v224, v232, v233
    v_cvt_pk_bf16_f32 v225, v234, v235
    v_cvt_pk_bf16_f32 v226, v236, v237
    v_mfma_f32_32x32x16_bf16 v[144:159], v[116:119], a[220:223], v[144:159]
    ds_read_b64_tr_b16 v[110:111], v16 offset:13568
    v_cvt_pk_bf16_f32 v227, v238, v239
    buffer_store_dwordx4 v[224:227], v2, s[52:55], s76 offen offset:2048 sc1
    v_mul_f32 v240, v57, v240
    s_waitcnt lgkmcnt(4)
    v_mfma_f32_32x32x16_bf16 v[128:143], v[96:99], a[224:227], v[128:143]
    s_barrier
    v_mul_f32 v241, v57, v241
    v_mfma_f32_32x32x16_bf16 v[144:159], v[96:99], a[228:231], v[144:159]
    v_mul_f32 v242, v57, v242
    v_mul_f32 v243, v57, v243
    v_mul_f32 v244, v57, v244
    v_mul_f32 v245, v57, v245
    v_mul_f32 v246, v57, v246
    v_mul_f32 v247, v57, v247
    v_mfma_f32_32x32x16_bf16 v[128:143], v[100:103], a[232:235], v[128:143]
    v_exp_f32 v240, -v240
    v_exp_f32 v241, -v241
    v_exp_f32 v242, -v242
    v_mfma_f32_32x32x16_bf16 v[144:159], v[100:103], a[236:239], v[144:159]
    buffer_load_dwordx4 v6, s[56:59], s87 offen offset:2048 sc1 lds
    v_exp_f32 v243, -v243
    v_exp_f32 v244, -v244
    s_waitcnt lgkmcnt(0)
    v_mfma_f32_32x32x16_bf16 v[128:143], v[104:107], a[240:243], v[128:143]
    s_barrier
    v_mfma_f32_32x32x16_bf16 v[144:159], v[104:107], a[244:247], v[144:159]
    buffer_load_dwordx4 v7, s[56:59], s87 offen offset:3072 sc1 lds
    v_exp_f32 v245, -v245
    v_exp_f32 v246, -v246
    v_mfma_f32_32x32x16_bf16 v[128:143], v[108:111], a[248:251], v[128:143]
    v_exp_f32 v247, -v247
    v_fma_f32 v240, v240, v59, v59
    v_fma_f32 v241, v241, v59, v59
    v_fma_f32 v242, v242, v59, v59
    v_fma_f32 v243, v243, v59, v59
    v_mfma_f32_32x32x16_bf16 v[144:159], v[108:111], a[252:255], v[144:159]
    v_fma_f32 v244, v244, v59, v59
    v_fma_f32 v245, v245, v59, v59
    v_fma_f32 v246, v246, v59, v59
    v_fma_f32 v247, v247, v59, v59
    v_rcp_f32 v240, v240
    s_add_u32 s87, s87, s7
    s_add_u32 m0, s71, 114688
    s_nop 0
    buffer_load_dwordx4 v4, s[56:59], s87 offen offset:0 sc1 lds
    v_xor_b32 v16, 0, v122
    v_xor_b32 v17, 32, v122
    v_rcp_f32 v241, v241
    v_rcp_f32 v242, v242
    v_rcp_f32 v243, v243
    v_rcp_f32 v244, v244
    v_rcp_f32 v245, v245
    v_rcp_f32 v246, v246
    buffer_load_dwordx4 v5, s[56:59], s87 offen offset:1024 sc1 lds
    v_xor_b32 v12, 64, v122
    v_xor_b32 v13, 96, v122
    v_rcp_f32 v247, v247
    v_mul_f32 v248, v248, v240
    v_mul_f32 v249, v249, v241
    v_mul_f32 v250, v250, v242
    v_mul_f32 v251, v251, v243
    v_mul_f32 v252, v252, v244
    buffer_load_dwordx4 v6, s[56:59], s87 offen offset:2048 sc1 lds
    v_add_u32 v16, 0x4000, v16
    v_add_u32 v17, 0x4000, v17
    v_mul_f32 v253, v253, v245
    v_mul_f32 v254, v254, v246
    v_mul_f32 v255, v255, v247
    v_cvt_pk_bf16_f32 v240, v248, v249
    v_cvt_pk_bf16_f32 v241, v250, v251
    v_cvt_pk_bf16_f32 v242, v252, v253
    buffer_load_dwordx4 v7, s[56:59], s87 offen offset:3072 sc1 lds
    v_add_u32 v12, 0x4000, v12
    v_add_u32 v13, 0x4000, v13
    v_cvt_pk_bf16_f32 v243, v254, v255
    buffer_store_dwordx4 v[240:243], v2, s[52:55], s76 offen offset:3072 sc1
    s_lshl_b32 s85, s64, 1
    s_add_u32 s85, s85, s62
    s_add_u32 s85, s85, 96
    s_lshl_b32 s85, s85, 11
    s_waitcnt vmcnt(28)
    ds_read_b64_tr_b16 a[0:1], v16 offset:0
    s_add_u32 s85, s85, s73
    v_mul_f32 v128, v56, v128
    v_mul_f32 v129, v56, v129
    v_mul_f32 v130, v56, v130
    v_mul_f32 v131, v56, v131
    v_mul_f32 v132, v56, v132
    ds_read_b64_tr_b16 a[2:3], v16 offset:1024
    ds_read_b64_tr_b16 a[4:5], v17 offset:0
    v_mul_f32 v133, v56, v133
    v_mul_f32 v134, v56, v134
    v_mul_f32 v135, v56, v135
    v_exp_f32 v128, -v128
    v_exp_f32 v129, -v129
    v_exp_f32 v130, -v130
    s_add_u32 s87, s87, s7
    s_add_u32 m0, s71, 131072
    s_nop 0
    buffer_load_dwordx4 v4, s[56:59], s87 offen offset:0 sc1 lds
    ds_read_b64_tr_b16 a[6:7], v17 offset:1024
    ds_read_b64_tr_b16 a[8:9], v12 offset:0
    v_exp_f32 v131, -v131
    v_exp_f32 v132, -v132
    v_exp_f32 v133, -v133
    v_exp_f32 v134, -v134
    v_exp_f32 v135, -v135
    v_fma_f32 v128, v128, v58, v58
    buffer_load_dwordx4 v5, s[56:59], s87 offen offset:1024 sc1 lds
    ds_read_b64_tr_b16 a[10:11], v12 offset:1024
    ds_read_b64_tr_b16 a[12:13], v13 offset:0
    v_fma_f32 v129, v129, v58, v58
    v_fma_f32 v130, v130, v58, v58
    v_fma_f32 v131, v131, v58, v58
    v_fma_f32 v132, v132, v58, v58
    v_fma_f32 v133, v133, v58, v58
    v_fma_f32 v134, v134, v58, v58
    ds_read_b64_tr_b16 a[14:15], v13 offset:1024
    v_add_u32 v16, 0x4000, v16
    v_fma_f32 v135, v135, v58, v58
    v_rcp_f32 v128, v128
    v_rcp_f32 v129, v129
    v_rcp_f32 v130, v130
    v_rcp_f32 v131, v131
    v_rcp_f32 v132, v132
    buffer_load_dwordx4 v6, s[56:59], s87 offen offset:2048 sc1 lds
    v_add_u32 v17, 0x4000, v17
    v_add_u32 v12, 0x4000, v12
    v_rcp_f32 v133, v133
    v_rcp_f32 v134, v134
    v_rcp_f32 v135, v135
    v_mul_f32 v136, v136, v128
    v_mul_f32 v137, v137, v129
    v_mul_f32 v138, v138, v130
    buffer_load_dwordx4 v7, s[56:59], s87 offen offset:3072 sc1 lds
    v_add_u32 v13, 0x4000, v13
    s_waitcnt vmcnt(28)
    v_mul_f32 v139, v139, v131
    v_mul_f32 v140, v140, v132
    v_mul_f32 v141, v141, v133
    v_mul_f32 v142, v142, v134
    v_mul_f32 v143, v143, v135
    v_cvt_pk_bf16_f32 v128, v136, v137
    ds_read_b64_tr_b16 a[16:17], v16 offset:0
    ds_read_b64_tr_b16 a[18:19], v16 offset:1024
    v_cvt_pk_bf16_f32 v129, v138, v139
    v_cvt_pk_bf16_f32 v130, v140, v141
    v_cvt_pk_bf16_f32 v131, v142, v143
    buffer_store_dwordx4 v[128:131], v2, s[52:55], s85 offen offset:0 sc1
    v_mul_f32 v144, v57, v144
    v_mul_f32 v145, v57, v145
    ds_read_b64_tr_b16 a[20:21], v17 offset:0
    ds_read_b64_tr_b16 a[22:23], v17 offset:1024
    v_mul_f32 v146, v57, v146
    v_mul_f32 v147, v57, v147
    v_mul_f32 v148, v57, v148
    v_mul_f32 v149, v57, v149
    v_mul_f32 v150, v57, v150
    v_mul_f32 v151, v57, v151
    ds_read_b64_tr_b16 a[24:25], v12 offset:0
    ds_read_b64_tr_b16 a[26:27], v12 offset:1024
    v_exp_f32 v144, -v144
    v_exp_f32 v145, -v145
    v_exp_f32 v146, -v146
    v_exp_f32 v147, -v147
    v_exp_f32 v148, -v148
    v_exp_f32 v149, -v149
    s_add_u32 s87, s87, s7
    s_add_u32 m0, s71, 0
    s_nop 0
    buffer_load_dwordx4 v4, s[56:59], s87 offen offset:0 sc1 lds
    ds_read_b64_tr_b16 a[28:29], v13 offset:0
    ds_read_b64_tr_b16 a[30:31], v13 offset:1024
    v_exp_f32 v150, -v150
    v_exp_f32 v151, -v151
    v_fma_f32 v144, v144, v59, v59
    v_fma_f32 v145, v145, v59, v59
    v_fma_f32 v146, v146, v59, v59
    v_fma_f32 v147, v147, v59, v59
    buffer_load_dwordx4 v5, s[56:59], s87 offen offset:1024 sc1 lds
    s_waitcnt lgkmcnt(8)
    v_add_u32 v16, 0x4000, v16
    v_fma_f32 v148, v148, v59, v59
    v_fma_f32 v149, v149, v59, v59
    v_fma_f32 v150, v150, v59, v59
    v_fma_f32 v151, v151, v59, v59
    v_rcp_f32 v144, v144
    v_rcp_f32 v145, v145
    v_add_u32 v17, 0x4000, v17
    v_add_u32 v12, 0x4000, v12
    v_rcp_f32 v146, v146
    v_rcp_f32 v147, v147
    v_rcp_f32 v148, v148
    v_rcp_f32 v149, v149
    v_rcp_f32 v150, v150
    v_rcp_f32 v151, v151
    buffer_load_dwordx4 v6, s[56:59], s87 offen offset:2048 sc1 lds
    v_add_u32 v13, 0x4000, v13
    s_waitcnt vmcnt(27)
    v_mul_f32 v152, v152, v144
    v_mul_f32 v153, v153, v145
    v_mul_f32 v154, v154, v146
    v_mul_f32 v155, v155, v147
    v_mul_f32 v156, v156, v148
    v_mul_f32 v157, v157, v149
    buffer_load_dwordx4 v7, s[56:59], s87 offen offset:3072 sc1 lds
    ds_read_b64_tr_b16 a[32:33], v16 offset:0
    ds_read_b64_tr_b16 a[34:35], v16 offset:1024
    v_mul_f32 v158, v158, v150
    v_mul_f32 v159, v159, v151
    v_cvt_pk_bf16_f32 v144, v152, v153
    v_cvt_pk_bf16_f32 v145, v154, v155
    v_cvt_pk_bf16_f32 v146, v156, v157
    v_cvt_pk_bf16_f32 v147, v158, v159
    ds_read_b64_tr_b16 a[36:37], v17 offset:0
    ds_read_b64_tr_b16 a[38:39], v17 offset:1024
    buffer_store_dwordx4 v[144:147], v2, s[52:55], s85 offen offset:1024 sc1
    ds_read_b64_tr_b16 a[40:41], v12 offset:0
    ds_read_b64_tr_b16 a[42:43], v12 offset:1024
    ds_read_b64_tr_b16 a[44:45], v13 offset:0
    ds_read_b64_tr_b16 a[46:47], v13 offset:1024
    s_waitcnt lgkmcnt(8)
    v_add_u32 v16, 0x4000, v16
    v_add_u32 v17, 0x4000, v17
    v_add_u32 v12, 0x4000, v12
    v_add_u32 v13, 0x4000, v13
    s_waitcnt vmcnt(25)
    ds_read_b64_tr_b16 a[48:49], v16 offset:0
    ds_read_b64_tr_b16 a[50:51], v16 offset:1024
    ds_read_b64_tr_b16 a[52:53], v17 offset:0
    ds_read_b64_tr_b16 a[54:55], v17 offset:1024
    ds_read_b64_tr_b16 a[56:57], v12 offset:0
    ds_read_b64_tr_b16 a[58:59], v12 offset:1024
    ds_read_b64_tr_b16 a[60:61], v13 offset:0
    ds_read_b64_tr_b16 a[62:63], v13 offset:1024
    s_waitcnt lgkmcnt(8)
    v_add_u32 v16, 0x4000, v16
    v_add_u32 v17, 0x4000, v17
    v_add_u32 v12, 0x4000, v12
    s_add_u32 s87, s87, s7
    s_sub_u32 s87, s87, s8
    s_add_u32 m0, s71, 16384
    s_nop 0
    buffer_load_dwordx4 v4, s[56:59], s87 offen offset:0 sc1 lds
    v_add_u32 v13, 0x4000, v13
    s_waitcnt vmcnt(21)
    ds_read_b64_tr_b16 a[64:65], v16 offset:0
    ds_read_b64_tr_b16 a[66:67], v16 offset:1024
    ds_read_b64_tr_b16 a[68:69], v17 offset:0
    ds_read_b64_tr_b16 a[70:71], v17 offset:1024
    ds_read_b64_tr_b16 a[72:73], v12 offset:0
    ds_read_b64_tr_b16 a[74:75], v12 offset:1024
    ds_read_b64_tr_b16 a[76:77], v13 offset:0
    ds_read_b64_tr_b16 a[78:79], v13 offset:1024
    s_waitcnt lgkmcnt(8)
    v_add_u32 v16, 0x4000, v16
    v_add_u32 v17, 0x4000, v17
    v_add_u32 v12, 0x4000, v12
    buffer_load_dwordx4 v5, s[56:59], s87 offen offset:1024 sc1 lds
    v_add_u32 v13, 0x4000, v13
    s_waitcnt vmcnt(17)
    ds_read_b64_tr_b16 a[80:81], v16 offset:0
    ds_read_b64_tr_b16 a[82:83], v16 offset:1024
    ds_read_b64_tr_b16 a[84:85], v17 offset:0
    ds_read_b64_tr_b16 a[86:87], v17 offset:1024
    ds_read_b64_tr_b16 a[88:89], v12 offset:0
    ds_read_b64_tr_b16 a[90:91], v12 offset:1024
    ds_read_b64_tr_b16 a[92:93], v13 offset:0
    ds_read_b64_tr_b16 a[94:95], v13 offset:1024
    s_waitcnt lgkmcnt(8)
    v_add_u32 v16, 0x4000, v16
    v_add_u32 v17, 0x4000, v17
    v_add_u32 v12, 0x4000, v12
    v_add_u32 v13, 0x4000, v13
    s_waitcnt vmcnt(13)
    ds_read_b64_tr_b16 a[96:97], v16 offset:0
    ds_read_b64_tr_b16 a[98:99], v16 offset:1024
    buffer_load_dwordx4 v6, s[56:59], s87 offen offset:2048 sc1 lds
    ds_read_b64_tr_b16 a[100:101], v17 offset:0
    ds_read_b64_tr_b16 a[102:103], v17 offset:1024
    ds_read_b64_tr_b16 a[104:105], v12 offset:0
    ds_read_b64_tr_b16 a[106:107], v12 offset:1024
    ds_read_b64_tr_b16 a[108:109], v13 offset:0
    ds_read_b64_tr_b16 a[110:111], v13 offset:1024
    s_waitcnt lgkmcnt(8)
    buffer_load_dwordx4 v7, s[56:59], s87 offen offset:3072 sc1 lds
    v_add_u32 v16, 0x4000, v16
    v_add_u32 v17, 0x4000, v17
    v_mov_b32 v44, s65
    v_mov_b32 v45, s66
    s_add_u32 s78, s74, 28672
    s_waitcnt vmcnt(4)
    s_mov_b64 exec, 1
    buffer_store_dwordx2 v[44:45], off, s[48:51], s78 sc1
    s_mov_b64 exec, -1
    v_add_u32 v12, 0x4000, v12
    v_add_u32 v13, 0x4000, v13
    s_waitcnt vmcnt(11)
    ds_read_b64_tr_b16 a[112:113], v16 offset:0
    ds_read_b64_tr_b16 a[114:115], v16 offset:1024
    ds_read_b64_tr_b16 a[116:117], v17 offset:0
    ds_read_b64_tr_b16 a[118:119], v17 offset:1024
    ds_read_b64_tr_b16 a[120:121], v12 offset:0
    s_add_u32 s87, s87, s7
    s_add_u32 m0, s71, 32768
    s_nop 0
    buffer_load_dwordx4 v4, s[56:59], s87 offen offset:0 sc1 lds
    ds_read_b64_tr_b16 a[122:123], v12 offset:1024
    ds_read_b64_tr_b16 a[124:125], v13 offset:0
    ds_read_b64_tr_b16 a[126:127], v13 offset:1024
    s_waitcnt lgkmcnt(8)
    buffer_load_dwordx4 v5, s[56:59], s87 offen offset:1024 sc1 lds
    buffer_load_dwordx4 v6, s[56:59], s87 offen offset:2048 sc1 lds
    buffer_load_dwordx4 v7, s[56:59], s87 offen offset:3072 sc1 lds
    v_add_u32 v16, 0xfffe0000, v16
    v_add_u32 v17, 0xfffe0000, v17
    s_add_u32 s87, s87, s7
    s_add_u32 m0, s71, 49152
    s_nop 0
    buffer_load_dwordx4 v4, s[56:59], s87 offen offset:0 sc1 lds
    v_add_u32 v12, 0xfffe0000, v12
    v_add_u32 v13, 0xfffe0000, v13
    s_waitcnt vmcnt(11)
    ds_read_b64_tr_b16 a[128:129], v16 offset:0
    ds_read_b64_tr_b16 a[130:131], v16 offset:1024
    ds_read_b64_tr_b16 a[132:133], v17 offset:0
    ds_read_b64_tr_b16 a[134:135], v17 offset:1024
    ds_read_b64_tr_b16 a[136:137], v12 offset:0
    ds_read_b64_tr_b16 a[138:139], v12 offset:1024
    ds_read_b64_tr_b16 a[140:141], v13 offset:0
    ds_read_b64_tr_b16 a[142:143], v13 offset:1024
    s_waitcnt lgkmcnt(8)
    buffer_load_dwordx4 v5, s[56:59], s87 offen offset:1024 sc1 lds
    buffer_load_dwordx4 v6, s[56:59], s87 offen offset:2048 sc1 lds
    buffer_load_dwordx4 v7, s[56:59], s87 offen offset:3072 sc1 lds
    s_add_u32 s87, s87, s7
    s_add_u32 m0, s71, 65536
    s_nop 0
    buffer_load_dwordx4 v4, s[56:59], s87 offen offset:0 sc1 lds
    buffer_load_dwordx4 v5, s[56:59], s87 offen offset:1024 sc1 lds
    v_add_u32 v16, 0x4000, v16
    v_add_u32 v17, 0x4000, v17
    v_add_u32 v12, 0x4000, v12
    v_add_u32 v13, 0x4000, v13
    s_waitcnt vmcnt(11)
    ds_read_b64_tr_b16 a[144:145], v16 offset:0
    ds_read_b64_tr_b16 a[146:147], v16 offset:1024
    ds_read_b64_tr_b16 a[148:149], v17 offset:0
    ds_read_b64_tr_b16 a[150:151], v17 offset:1024
    ds_read_b64_tr_b16 a[152:153], v12 offset:0
    ds_read_b64_tr_b16 a[154:155], v12 offset:1024
    ds_read_b64_tr_b16 a[156:157], v13 offset:0
    ds_read_b64_tr_b16 a[158:159], v13 offset:1024
    s_waitcnt lgkmcnt(8)
    buffer_load_dwordx4 v6, s[56:59], s87 offen offset:2048 sc1 lds
    buffer_load_dwordx4 v7, s[56:59], s87 offen offset:3072 sc1 lds
    s_add_u32 s87, s87, s7
    s_add_u32 m0, s71, 81920
    s_nop 0
    buffer_load_dwordx4 v4, s[56:59], s87 offen offset:0 sc1 lds
    buffer_load_dwordx4 v5, s[56:59], s87 offen offset:1024 sc1 lds
    v_add_u32 v16, 0x4000, v16
    v_add_u32 v17, 0x4000, v17
    v_add_u32 v12, 0x4000, v12
    v_add_u32 v13, 0x4000, v13
    s_waitcnt vmcnt(10)
    ds_read_b64_tr_b16 a[160:161], v16 offset:0
    ds_read_b64_tr_b16 a[162:163], v16 offset:1024
    ds_read_b64_tr_b16 a[164:165], v17 offset:0
    ds_read_b64_tr_b16 a[166:167], v17 offset:1024
    ds_read_b64_tr_b16 a[168:169], v12 offset:0
    ds_read_b64_tr_b16 a[170:171], v12 offset:1024
    ds_read_b64_tr_b16 a[172:173], v13 offset:0
    ds_read_b64_tr_b16 a[174:175], v13 offset:1024
    s_waitcnt lgkmcnt(8)
    buffer_load_dwordx4 v6, s[56:59], s87 offen offset:2048 sc1 lds
    buffer_load_dwordx4 v7, s[56:59], s87 offen offset:3072 sc1 lds
    s_add_u32 s87, s87, s7
    s_add_u32 m0, s71, 98304
    s_nop 0
    buffer_load_dwordx4 v4, s[56:59], s87 offen offset:0 sc1 lds
    buffer_load_dwordx4 v5, s[56:59], s87 offen offset:1024 sc1 lds
    v_add_u32 v16, 0x4000, v16
    v_add_u32 v17, 0x4000, v17
    v_add_u32 v12, 0x4000, v12
    v_add_u32 v13, 0x4000, v13
    s_waitcnt vmcnt(10)
    ds_read_b64_tr_b16 a[176:177], v16 offset:0
    ds_read_b64_tr_b16 a[178:179], v16 offset:1024
    ds_read_b64_tr_b16 a[180:181], v17 offset:0
    ds_read_b64_tr_b16 a[182:183], v17 offset:1024
    ds_read_b64_tr_b16 a[184:185], v12 offset:0
    ds_read_b64_tr_b16 a[186:187], v12 offset:1024
    ds_read_b64_tr_b16 a[188:189], v13 offset:0
    ds_read_b64_tr_b16 a[190:191], v13 offset:1024
    s_waitcnt lgkmcnt(8)
    buffer_load_dwordx4 v6, s[56:59], s87 offen offset:2048 sc1 lds
    buffer_load_dwordx4 v7, s[56:59], s87 offen offset:3072 sc1 lds
    s_add_u32 s87, s87, s7
    s_add_u32 m0, s71, 114688
    s_nop 0
    buffer_load_dwordx4 v4, s[56:59], s87 offen offset:0 sc1 lds
    buffer_load_dwordx4 v5, s[56:59], s87 offen offset:1024 sc1 lds
    v_add_u32 v16, 0x4000, v16
    v_add_u32 v17, 0x4000, v17
    v_add_u32 v12, 0x4000, v12
    v_add_u32 v13, 0x4000, v13
    s_waitcnt vmcnt(10)
    ds_read_b64_tr_b16 a[192:193], v16 offset:0
    ds_read_b64_tr_b16 a[194:195], v16 offset:1024
    ds_read_b64_tr_b16 a[196:197], v17 offset:0
    ds_read_b64_tr_b16 a[198:199], v17 offset:1024
    ds_read_b64_tr_b16 a[200:201], v12 offset:0
    ds_read_b64_tr_b16 a[202:203], v12 offset:1024
    ds_read_b64_tr_b16 a[204:205], v13 offset:0
    ds_read_b64_tr_b16 a[206:207], v13 offset:1024
    s_waitcnt lgkmcnt(8)
    buffer_load_dwordx4 v6, s[56:59], s87 offen offset:2048 sc1 lds
    buffer_load_dwordx4 v7, s[56:59], s87 offen offset:3072 sc1 lds
    s_add_u32 s87, s87, s7
    s_cmp_lg_u32 s12, 0
    s_cbranch_scc1 L_sk_27
    s_add_u32 m0, s71, 131072
    s_nop 0
    buffer_load_dwordx4 v4, s[56:59], s87 offen offset:0 sc1 lds
    buffer_load_dwordx4 v5, s[56:59], s87 offen offset:1024 sc1 lds
    buffer_load_dwordx4 v6, s[56:59], s87 offen offset:2048 sc1 lds
    buffer_load_dwordx4 v7, s[56:59], s87 offen offset:3072 sc1 lds
    s_add_u32 s87, s87, s7
L_sk_27:
    v_add_u32 v16, 0x4000, v16
    v_add_u32 v17, 0x4000, v17
    v_add_u32 v12, 0x4000, v12
    v_add_u32 v13, 0x4000, v13
    s_cmp_lg_u32 s12, 0
    s_cbranch_scc1 L_wc_29
    s_waitcnt vmcnt(12)
    s_branch L_we_28
L_wc_29:
    s_waitcnt vmcnt(8)
L_we_28:
    ds_read_b64_tr_b16 a[208:209], v16 offset:0
    ds_read_b64_tr_b16 a[210:211], v16 offset:1024
    ds_read_b64_tr_b16 a[212:213], v17 offset:0
    ds_read_b64_tr_b16 a[214:215], v17 offset:1024
    ds_read_b64_tr_b16 a[216:217], v12 offset:0
    ds_read_b64_tr_b16 a[218:219], v12 offset:1024
    ds_read_b64_tr_b16 a[220:221], v13 offset:0
    ds_read_b64_tr_b16 a[222:223], v13 offset:1024
    s_waitcnt lgkmcnt(8)
    s_cmp_lg_u32 s12, 0
    s_cbranch_scc1 L_sk_30
    s_add_u32 m0, s71, 0
    s_nop 0
    buffer_load_dwordx4 v4, s[56:59], s87 offen offset:0 sc1 lds
    buffer_load_dwordx4 v5, s[56:59], s87 offen offset:1024 sc1 lds
    buffer_load_dwordx4 v6, s[56:59], s87 offen offset:2048 sc1 lds
    buffer_load_dwordx4 v7, s[56:59], s87 offen offset:3072 sc1 lds
    s_add_u32 s87, s87, s7
L_sk_30:
    s_cmp_eq_u32 s60, 0
    s_cselect_b32 s77, 15, 31
    v_and_b32 v21, s77, v1
    v_lshlrev_b32 v21, 3, v21
    v_and_b32 v22, 15, v1
    v_lshlrev_b32 v22, 4, v22
    v_bfe_u32 v23, v1, 4, 1
    v_lshl_add_u32 v22, v23, 9, v22
    v_lshrrev_b32 v23, 5, v1
    v_lshl_add_u32 v22, v23, 11, v22
    v_add_u32 v16, 0x4000, v16
    v_add_u32 v17, 0x4000, v17
    v_add_u32 v12, 0x4000, v12
    v_add_u32 v13, 0x4000, v13
    s_cmp_lg_u32 s12, 0
    s_cbranch_scc1 L_wc_32
    s_waitcnt vmcnt(12)
    s_branch L_we_31
L_wc_32:
    s_waitcnt vmcnt(4)
L_we_31:
    ds_read_b64_tr_b16 a[224:225], v16 offset:0
    ds_read_b64_tr_b16 a[226:227], v16 offset:1024
    ds_read_b64_tr_b16 a[228:229], v17 offset:0
    ds_read_b64_tr_b16 a[230:231], v17 offset:1024
    ds_read_b64_tr_b16 a[232:233], v12 offset:0
    ds_read_b64_tr_b16 a[234:235], v12 offset:1024
    ds_read_b64_tr_b16 a[236:237], v13 offset:0
    ds_read_b64_tr_b16 a[238:239], v13 offset:1024
    s_waitcnt lgkmcnt(8)
    buffer_load_dwordx2 v[48:49], v21, s[48:51], s90 offen sc1
    s_cmp_lg_u32 s13, 0
    s_cbranch_scc1 L_sk_33
    s_add_u32 m0, s71, 16384
    s_nop 0
    buffer_load_dwordx4 v4, s[56:59], s87 offen offset:0 sc1 lds
    buffer_load_dwordx4 v5, s[56:59], s87 offen offset:1024 sc1 lds
    buffer_load_dwordx4 v6, s[56:59], s87 offen offset:2048 sc1 lds
    buffer_load_dwordx4 v7, s[56:59], s87 offen offset:3072 sc1 lds
    s_add_u32 s87, s87, s7
L_sk_33:
    v_add_u32 v16, 0x4000, v16
    v_add_u32 v17, 0x4000, v17
    v_add_u32 v12, 0x4000, v12
    v_add_u32 v13, 0x4000, v13
    s_cmp_lg_u32 s12, 0
    s_cbranch_scc1 L_wc_35
    s_cmp_lg_u32 s13, 0
    s_cbranch_scc1 L_wc_36
    s_waitcnt vmcnt(13)
    s_branch L_we_34
L_wc_36:
    s_waitcnt vmcnt(9)
    s_branch L_we_34
L_wc_35:
    s_cmp_lg_u32 s13, 0
    s_cbranch_scc1 L_wc_37
    s_waitcnt vmcnt(5)
    s_branch L_we_34
L_wc_37:
    s_waitcnt vmcnt(1)
L_we_34:
    ds_read_b64_tr_b16 a[240:241], v16 offset:0
    ds_read_b64_tr_b16 a[242:243], v16 offset:1024
    ds_read_b64_tr_b16 a[244:245], v17 offset:0
    ds_read_b64_tr_b16 a[246:247], v17 offset:1024
    ds_read_b64_tr_b16 a[248:249], v12 offset:0
    ds_read_b64_tr_b16 a[250:251], v12 offset:1024
    ds_read_b64_tr_b16 a[252:253], v13 offset:0
    ds_read_b64_tr_b16 a[254:255], v13 offset:1024
    s_waitcnt lgkmcnt(8)
    v_add_u32 v16, 0x4000, v16
    v_add_u32 v17, 0x4000, v17
    v_add_u32 v12, 0x4000, v12
    v_add_u32 v13, 0x4000, v13
    s_cmp_lg_u32 s13, 0
    s_cbranch_scc1 L_wc_39
    s_waitcnt vmcnt(9)
    s_branch L_we_38
L_wc_39:
    s_waitcnt vmcnt(5)
L_we_38:
    ds_read_b64_tr_b16 v[72:73], v16 offset:0
    ds_read_b64_tr_b16 v[74:75], v16 offset:1024
    ds_read_b64_tr_b16 v[76:77], v17 offset:0
    ds_read_b64_tr_b16 v[78:79], v17 offset:1024
    ds_read_b64_tr_b16 v[80:81], v12 offset:0
    ds_read_b64_tr_b16 v[82:83], v12 offset:1024
    ds_read_b64_tr_b16 v[84:85], v13 offset:0
    ds_read_b64_tr_b16 v[86:87], v13 offset:1024
    s_waitcnt lgkmcnt(8)
    v_add_u32 v16, 0xfffe0000, v16
    v_add_u32 v17, 0xfffe0000, v17
    v_add_u32 v12, 0xfffe0000, v12
    v_add_u32 v13, 0xfffe0000, v13
    s_cmp_lg_u32 s13, 0
    s_cbranch_scc1 L_wc_41
    s_waitcnt vmcnt(5)
    s_branch L_we_40
L_wc_41:
    s_waitcnt vmcnt(1)
L_we_40:
    ds_read_b64_tr_b16 v[88:89], v16 offset:0
    ds_read_b64_tr_b16 v[90:91], v16 offset:1024
    ds_read_b64_tr_b16 v[92:93], v17 offset:0
    ds_read_b64_tr_b16 v[94:95], v17 offset:1024
    ds_read_b64_tr_b16 v[96:97], v12 offset:0
    ds_read_b64_tr_b16 v[98:99], v12 offset:1024
    ds_read_b64_tr_b16 v[100:101], v13 offset:0
    ds_read_b64_tr_b16 v[102:103], v13 offset:1024
    s_waitcnt lgkmcnt(8)
    s_cmp_lg_u32 s13, 0
    s_cbranch_scc1 L_wc_43
    s_waitcnt vmcnt(4)
    s_branch L_we_42
L_wc_43:
    s_waitcnt vmcnt(0)
L_we_42:
    v_xor_b32 v15, s65, v48
    v_bitop3_b32 v15, v15, v49, s66 bitop3:0xf6
    v_cmp_ne_u32 vcc, 0, v15
    s_cbranch_vccnz L_retry_paH
L_back_paH:
    buffer_load_dwordx4 v[192:195], v22, s[52:55], s88 offen offset:0 sc1
    buffer_load_dwordx4 v[196:199], v22, s[52:55], s88 offen offset:256 sc1
    buffer_load_dwordx4 v[200:203], v22, s[52:55], s88 offen offset:1024 sc1
    buffer_load_dwordx4 v[204:207], v22, s[52:55], s88 offen offset:1280 sc1
    s_add_u32 s88, s88, 4096
    buffer_load_dwordx4 v[208:211], v22, s[52:55], s88 offen offset:0 sc1
    buffer_load_dwordx4 v[212:215], v22, s[52:55], s88 offen offset:256 sc1
    buffer_load_dwordx4 v[216:219], v22, s[52:55], s88 offen offset:1024 sc1
    buffer_load_dwordx4 v[220:223], v22, s[52:55], s88 offen offset:1280 sc1
    s_add_u32 s88, s88, 4096
    buffer_load_dwordx4 v[224:227], v22, s[52:55], s88 offen offset:0 sc1
    buffer_load_dwordx4 v[228:231], v22, s[52:55], s88 offen offset:256 sc1
    buffer_load_dwordx4 v[232:235], v22, s[52:55], s88 offen offset:1024 sc1
    buffer_load_dwordx4 v[236:239], v22, s[52:55], s88 offen offset:1280 sc1
    s_add_u32 s88, s88, 4096
    v_add_u32 v16, 0x4000, v16
    v_add_u32 v17, 0x4000, v17
    v_add_u32 v12, 0x4000, v12
    v_add_u32 v13, 0x4000, v13
    s_waitcnt vmcnt(12)
    ds_read_b64_tr_b16 v[104:105], v16 offset:0
    ds_read_b64_tr_b16 v[106:107], v16 offset:1024
    ds_read_b64_tr_b16 v[108:109], v17 offset:0
    ds_read_b64_tr_b16 v[110:111], v17 offset:1024
    ds_read_b64_tr_b16 v[112:113], v12 offset:0
    ds_read_b64_tr_b16 v[114:115], v12 offset:1024
    ds_read_b64_tr_b16 v[116:117], v13 offset:0
    ds_read_b64_tr_b16 v[118:119], v13 offset:1024
    s_waitcnt lgkmcnt(8)
    s_waitcnt lgkmcnt(0)
    s_branch L_p2
L_typeQ:
    s_mul_i32 s79, s64, 6144
    s_lshl_b32 s76, s62, 10
    s_add_u32 s79, s79, s76
    s_add_u32 s79, s79, 114688
    s_add_u32 s80, s79, 512
    s_add_u32 s81, s79, 2048
    s_add_u32 s82, s79, 2560
    s_lshl_b32 s83, s64, 11
    s_add_u32 s83, s83, s76
    s_add_u32 s83, s83, 65536
    s_lshl_b32 s92, s91, 7
    s_add_u32 s92, s92, 36864
    s_mul_i32 s91, s91, 10240
    s_add_u32 s91, s91, 262144
    s_movk_i32 s10, 640
    s_or_b32 s78, s63, s64
    s_or_b32 s78, s78, s60
    s_cmp_eq_u32 s78, 0
    s_cselect_b32 s93, 0, 1073741824
    v_mov_b32 v124, v8
    v_mul_u32_u24 v123, 3072, v64
    v_add_u32 v123, v123, v66
    v_add_u32 v16, 16384, v120
    v_xor_b32 v17, 32, v16
    v_bfe_u32 v0, v1, 2, 2
    v_lshrrev_b32 v3, 5, v1
    v_lshl_add_u32 v0, v3, 3, v0
    v_lshlrev_b32 v121, 7, v0
    v_and_b32 v0, 2, v0
    v_bfe_u32 v3, v1, 4, 1
    v_xor_b32 v0, v0, v3
    s_lshl_b32 s0, s62, 1
    v_xor_b32 v0, s0, v0
    v_lshl_add_u32 v121, v0, 5, v121
    v_and_b32 v0, 3, v1
    v_lshl_add_u32 v121, v0, 3, v121
    v_mov_b32 v60, 0x3f80
    v_and_b32 v80, 1, v1
    v_lshlrev_b32 v80, 4, v80
    v_lshlrev_b32 v80, v80, v60
    v_lshrrev_b32 v60, 1, v1
    v_xor_b32 v61, v60, v1
    v_and_b32 v61, 8, v61
    v_and_b32 v60, 3, v60
    v_or_b32 v63, v60, v61
    v_cmp_eq_u32 vcc, 0, v63
    s_nop 1
    v_cndmask_b32 v60, 0, v80, vcc
    v_cmp_eq_u32 vcc, 1, v63
    s_nop 1
    v_cndmask_b32 v61, 0, v80, vcc
    v_cmp_eq_u32 vcc, 2, v63
    s_nop 1
    v_cndmask_b32 v62, 0, v80, vcc
    v_cmp_eq_u32 vcc, 3, v63
    s_nop 1
    v_cndmask_b32 v63, 0, v80, vcc
    s_add_u32 m0, s71, 32768
    s_nop 0
    buffer_load_dwordx4 v4, s[24:27], s69 offen offset:0 lds
    buffer_load_dwordx4 v5, s[24:27], s69 offen offset:1024 lds
    buffer_load_dwordx4 v6, s[24:27], s69 offen offset:2048 lds
    buffer_load_dwordx4 v7, s[24:27], s69 offen offset:3072 lds
    s_add_u32 s69, s69, 128
    v_mov_b32 v64, 0
    v_mov_b32 v65, 0
    v_mov_b32 v66, 0x3f803f80
    s_bitcmp1_b32 s72, 0
    s_cbranch_scc1 L_wc_45
    s_bitcmp1_b32 s72, 1
    s_cbranch_scc1 L_wc_46
    s_waitcnt vmcnt(19)
    s_branch L_we_44
L_wc_46:
    s_waitcnt vmcnt(13)
    s_branch L_we_44
L_wc_45:
    s_bitcmp1_b32 s72, 1
    s_cbranch_scc1 L_wc_47
    s_waitcnt vmcnt(18)
    s_branch L_we_44
L_wc_47:
    s_waitcnt vmcnt(12)
L_we_44:
    v_dot2c_f32_bf16 v64, v72, v66
    v_dot2c_f32_bf16 v65, v72, v72
    v_dot2c_f32_bf16 v64, v73, v66
    v_dot2c_f32_bf16 v65, v73, v73
    v_dot2c_f32_bf16 v64, v74, v66
    v_dot2c_f32_bf16 v65, v74, v74
    v_dot2c_f32_bf16 v64, v75, v66
    v_dot2c_f32_bf16 v65, v75, v75
    v_dot2c_f32_bf16 v64, v76, v66
    v_dot2c_f32_bf16 v65, v76, v76
    v_dot2c_f32_bf16 v64, v77, v66
    v_dot2c_f32_bf16 v65, v77, v77
    v_dot2c_f32_bf16 v64, v78, v66
    v_dot2c_f32_bf16 v65, v78, v78
    v_dot2c_f32_bf16 v64, v79, v66
    v_dot2c_f32_bf16 v65, v79, v79
    s_nop 1
    v_add_f32 v64, v64, v64 row_shr:1 row_mask:0xf bank_mask:0xf bound_ctrl:1
    v_add_f32 v65, v65, v65 row_shr:1 row_mask:0xf bank_mask:0xf bound_ctrl:1
    s_nop 0
    v_add_f32 v64, v64, v64 row_shr:2 row_mask:0xf bank_mask:0xf bound_ctrl:1
    v_add_f32 v65, v65, v65 row_shr:2 row_mask:0xf bank_mask:0xf bound_ctrl:1
    s_nop 0
    v_add_f32 v64, v64, v64 row_shr:4 row_mask:0xf bank_mask:0xf bound_ctrl:1
    v_add_f32 v65, v65, v65 row_shr:4 row_mask:0xf bank_mask:0xf bound_ctrl:1
    s_nop 0
    v_add_f32 v64, v64, v64 row_shr:8 row_mask:0xf bank_mask:0xf bound_ctrl:1
    v_add_f32 v65, v65, v65 row_shr:8 row_mask:0xf bank_mask:0xf bound_ctrl:1
    s_nop 0
    v_add_f32 v64, v64, v64 row_bcast:15 row_mask:0xa bank_mask:0xf
    v_add_f32 v65, v65, v65 row_bcast:15 row_mask:0xa bank_mask:0xf
    v_mul_f32 v64, 0x3b000000, v64
    v_mul_f32 v65, 0x3b000000, v65
    v_fma_f32 v65, -v64, v64, v65
    v_max_f32 v65, 0, v65
    v_cvt_pk_bf16_f32 v66, v64, v65
    v_and_b32 v65, 0xffff0000, v66
    v_add_f32 v65, 0x3727c5ac, v65
    v_cvt_pk_bf16_f32 v65, v65, v65
    v_and_b32 v65, 0xffff0000, v65
    v_sqrt_f32 v65, v65
    s_mov_b32 s78, 0xffff
    v_cvt_pk_bf16_f32 v65, v65, v65
    v_lshlrev_b32 v68, 3, v68
    v_bfi_b32 v66, s78, v66, v65
    s_waitcnt lgkmcnt(0)
    s_mul_i32 s66, s66, 0x9E3779B1
    s_add_u32 s66, s66, 0x7F4A7C15
    s_and_b32 s65, s66, 0xBFFFBFFF
    v_mov_b32 v67, s65
    s_mov_b32 exec_lo, 0x80000000
    s_mov_b32 exec_hi, 0x80000000
    buffer_store_dwordx2 v[66:67], v68, s[48:51], s3 offen sc1
    s_mov_b64 exec, -1
    s_add_u32 m0, s71, 49152
    s_nop 0
    buffer_load_dwordx4 v8, s[32:35], s70 offen offset:0 lds
    buffer_load_dwordx4 v9, s[32:35], s70 offen offset:1024 lds
    s_add_u32 m0, s71, 51200
    s_nop 0
    buffer_load_dwordx4 v10, s[36:39], s70 offen offset:0 lds
    buffer_load_dwordx4 v11, s[36:39], s70 offen offset:1024 lds
    s_add_u32 s70, s70, 229376
    s_bitcmp1_b32 s72, 2
    s_cbranch_scc1 L_sk_48
    buffer_load_dwordx4 v[24:27], v83, s[44:47], s94 offen
    s_add_u32 s94, s94, s85
    buffer_load_dwordx4 v[28:31], v83, s[44:47], s94 offen
    s_add_u32 s94, s94, s85
    buffer_load_dwordx4 v[32:35], v83, s[44:47], s94 offen
    s_add_u32 s94, s94, s85
    buffer_load_dwordx4 v[36:39], v83, s[44:47], s94 offen
    s_add_u32 s94, s94, s85
    buffer_load_dwordx4 v[40:43], v83, s[44:47], s94 offen
    s_add_u32 s94, s94, s85
    buffer_load_dwordx4 v[44:47], v83, s[44:47], s94 offen
L_sk_48:
    s_mov_b64 s[44:45], s[18:19]
    s_mov_b32 s46, 0x200000
    s_bitcmp1_b32 s72, 0
    s_cbranch_scc1 L_wc_50
    s_bitcmp1_b32 s72, 1
    s_cbranch_scc1 L_wc_51
    s_bitcmp1_b32 s72, 2
    s_cbranch_scc1 L_wc_52
    s_waitcnt vmcnt(22)
    s_branch L_we_49
L_wc_52:
    s_waitcnt vmcnt(16)
    s_branch L_we_49
L_wc_51:
    s_bitcmp1_b32 s72, 2
    s_cbranch_scc1 L_wc_53
    s_waitcnt vmcnt(16)
    s_branch L_we_49
L_wc_53:
    s_waitcnt vmcnt(10)
    s_branch L_we_49
L_wc_50:
    s_bitcmp1_b32 s72, 1
    s_cbranch_scc1 L_wc_54
    s_bitcmp1_b32 s72, 2
    s_cbranch_scc1 L_wc_55
    s_waitcnt vmcnt(21)
    s_branch L_we_49
L_wc_55:
    s_waitcnt vmcnt(15)
    s_branch L_we_49
L_wc_54:
    s_bitcmp1_b32 s72, 2
    s_cbranch_scc1 L_wc_56
    s_waitcnt vmcnt(15)
    s_branch L_we_49
L_wc_56:
    s_waitcnt vmcnt(9)
L_we_49:
    s_barrier
    ds_read_b128 a[0:3], v12
    ds_read_b64_tr_b16 v[96:97], v16 offset:0
    ds_read_b64_tr_b16 v[98:99], v16 offset:512
    ds_read_b128 a[4:7], v12 offset:4096
    v_add_u32 v12, 0x8000, v12
    ds_read_b64_tr_b16 v[100:101], v17 offset:0
    ds_read_b64_tr_b16 v[102:103], v17 offset:512
    ds_read_b128 a[8:11], v13
    ds_read_b64_tr_b16 v[104:105], v16 offset:4096
    ds_read_b64_tr_b16 v[106:107], v16 offset:4608
    ds_read_b128 a[12:15], v13 offset:4096
    v_add_u32 v13, 0x8000, v13
    ds_read_b64_tr_b16 v[108:109], v17 offset:4096
    ds_read_b64_tr_b16 v[110:111], v17 offset:4608
    s_add_u32 m0, s71, 65536
    s_nop 0
    buffer_load_dwordx4 v4, s[24:27], s69 offen offset:0 lds
    buffer_load_dwordx4 v5, s[24:27], s69 offen offset:1024 lds
    buffer_load_dwordx4 v6, s[24:27], s69 offen offset:2048 lds
    buffer_load_dwordx4 v7, s[24:27], s69 offen offset:3072 lds
    s_add_u32 s69, s69, 128
    s_add_u32 m0, s71, 81920
    s_nop 0
    buffer_load_dwordx4 v8, s[32:35], s70 offen offset:0 lds
    buffer_load_dwordx4 v9, s[32:35], s70 offen offset:1024 lds
    s_add_u32 m0, s71, 83968
    s_nop 0
    buffer_load_dwordx4 v10, s[36:39], s70 offen offset:0 lds
    buffer_load_dwordx4 v11, s[36:39], s70 offen offset:1024 lds
    s_add_u32 s70, s70, 229376
    s_waitcnt lgkmcnt(6)
    v_mfma_f32_32x32x16_bf16 v[128:143], v[96:99], a[0:3], 0
    ds_read_b128 a[16:19], v14
    ds_read_b64_tr_b16 v[112:113], v16 offset:8192
    s_add_u32 m0, s71, 98304
    s_nop 0
    buffer_load_dwordx4 v4, s[24:27], s69 offen offset:0 lds
    v_mfma_f32_32x32x16_bf16 v[144:159], v[96:99], a[4:7], 0
    ds_read_b64_tr_b16 v[114:115], v16 offset:8704
    buffer_load_dwordx4 v5, s[24:27], s69 offen offset:1024 lds
    v_mfma_f32_32x32x16_bf16 v[160:175], v[100:103], a[0:3], 0
    ds_read_b128 a[20:23], v14 offset:4096
    v_add_u32 v14, 0x8000, v14
    ds_read_b64_tr_b16 v[116:117], v17 offset:8192
    buffer_load_dwordx4 v6, s[24:27], s69 offen offset:2048 lds
    v_mfma_f32_32x32x16_bf16 v[176:191], v[100:103], a[4:7], 0
    ds_read_b64_tr_b16 v[118:119], v17 offset:8704
    buffer_load_dwordx4 v7, s[24:27], s69 offen offset:3072 lds
    s_waitcnt lgkmcnt(6)
    v_mfma_f32_32x32x16_bf16 v[128:143], v[104:107], a[8:11], v[128:143]
    ds_read_b128 a[24:27], v15
    ds_read_b64_tr_b16 v[96:97], v16 offset:12288
    s_add_u32 s69, s69, 128
    s_add_u32 m0, s71, 114688
    s_nop 0
    buffer_load_dwordx4 v8, s[32:35], s70 offen offset:0 lds
    v_mfma_f32_32x32x16_bf16 v[144:159], v[104:107], a[12:15], v[144:159]
    ds_read_b64_tr_b16 v[98:99], v16 offset:12800
    v_add_u32 v16, 0x8000, v16
    buffer_load_dwordx4 v9, s[32:35], s70 offen offset:1024 lds
    v_mfma_f32_32x32x16_bf16 v[160:175], v[108:111], a[8:11], v[160:175]
    ds_read_b128 a[28:31], v15 offset:4096
    v_add_u32 v15, 0x8000, v15
    ds_read_b64_tr_b16 v[100:101], v17 offset:12288
    s_add_u32 m0, s71, 116736
    s_nop 0
    buffer_load_dwordx4 v10, s[36:39], s70 offen offset:0 lds
    s_bitcmp1_b32 s72, 0
    s_cbranch_scc1 L_sk_57
    s_bitcmp1_b32 s72, 2
    s_cbranch_scc1 L_wc_59
    s_waitcnt vmcnt(30)
    s_branch L_we_58
L_wc_59:
    s_waitcnt vmcnt(24)
L_we_58:
    buffer_store_dwordx4 v[84:87], v2, s[48:51], s6 offen sc1
L_sk_57:
    v_mfma_f32_32x32x16_bf16 v[176:191], v[108:111], a[12:15], v[176:191]
    ds_read_b64_tr_b16 v[102:103], v17 offset:12800
    v_add_u32 v17, 0x8000, v17
    buffer_load_dwordx4 v11, s[36:39], s70 offen offset:1024 lds
    s_waitcnt lgkmcnt(6)
    v_mfma_f32_32x32x16_bf16 v[128:143], v[112:115], a[16:19], v[128:143]
    s_bitcmp1_b32 s72, 2
    s_cbranch_scc1 L_wc_61
    s_waitcnt vmcnt(22)
    s_branch L_we_60
L_wc_61:
    s_waitcnt vmcnt(16)
L_we_60:
    s_barrier
    ds_read_b128 a[32:35], v12
    ds_read_b64_tr_b16 v[104:105], v16 offset:0
    v_mfma_f32_32x32x16_bf16 v[144:159], v[112:115], a[20:23], v[144:159]
    ds_read_b64_tr_b16 v[106:107], v16 offset:512
    s_add_u32 s70, s70, 229376
    s_lshl_b32 s3, s1, 10
    s_sub_u32 s69, s69, s3
    s_add_u32 m0, s71, 131072
    s_nop 0
    buffer_load_dwordx4 v4, s[24:27], s69 offen offset:0 lds
    v_mfma_f32_32x32x16_bf16 v[160:175], v[116:119], a[16:19], v[160:175]
    ds_read_b128 a[36:39], v12 offset:4096
    v_add_u32 v12, 0x8000, v12
    ds_read_b64_tr_b16 v[108:109], v17 offset:0
    v_mfma_f32_32x32x16_bf16 v[176:191], v[116:119], a[20:23], v[176:191]
    ds_read_b64_tr_b16 v[110:111], v17 offset:512
    buffer_load_dwordx4 v5, s[24:27], s69 offen offset:1024 lds
    s_waitcnt lgkmcnt(6)
    v_mfma_f32_32x32x16_bf16 v[128:143], v[96:99], a[24:27], v[128:143]
    ds_read_b128 a[40:43], v13
    ds_read_b64_tr_b16 v[112:113], v16 offset:4096
    v_mfma_f32_32x32x16_bf16 v[144:159], v[96:99], a[28:31], v[144:159]
    ds_read_b64_tr_b16 v[114:115], v16 offset:4608
    buffer_load_dwordx4 v6, s[24:27], s69 offen offset:2048 lds
    s_waitcnt vmcnt(15)
    v_lshlrev_b32 v88, 16, v24
    v_and_b32 v89, 0xffff0000, v24
    v_lshlrev_b32 v90, 16, v25
    v_and_b32 v91, 0xffff0000, v25
    v_lshlrev_b32 v92, 16, v26
    v_mfma_f32_32x32x16_bf16 v[160:175], v[100:103], a[24:27], v[160:175]
    ds_read_b128 a[44:47], v13 offset:4096
    v_add_u32 v13, 0x8000, v13
    ds_read_b64_tr_b16 v[116:117], v17 offset:4096
    v_and_b32 v93, 0xffff0000, v26
    v_lshlrev_b32 v94, 16, v27
    v_and_b32 v95, 0xffff0000, v27
    v_lshlrev_b32 v64, 16, v28
    v_and_b32 v28, 0xffff0000, v28
    v_mfma_f32_32x32x16_bf16 v[176:191], v[100:103], a[28:31], v[176:191]
    ds_read_b64_tr_b16 v[118:119], v17 offset:4608
    buffer_load_dwordx4 v7, s[24:27], s69 offen offset:3072 lds
    v_add_f32 v88, v88, v64
    v_add_f32 v89, v89, v28
    v_lshlrev_b32 v65, 16, v29
    v_and_b32 v29, 0xffff0000, v29
    s_waitcnt lgkmcnt(6)
    v_mfma_f32_32x32x16_bf16 v[128:143], v[104:107], a[32:35], v[128:143]
    ds_read_b128 a[48:51], v14
    ds_read_b64_tr_b16 v[96:97], v16 offset:8192
    v_add_f32 v90, v90, v65
    v_add_f32 v91, v91, v29
    v_lshlrev_b32 v66, 16, v30
    v_and_b32 v30, 0xffff0000, v30
    v_add_f32 v92, v92, v66
    v_add_f32 v93, v93, v30
    v_mfma_f32_32x32x16_bf16 v[144:159], v[104:107], a[36:39], v[144:159]
    ds_read_b64_tr_b16 v[98:99], v16 offset:8704
    v_lshlrev_b32 v67, 16, v31
    v_and_b32 v31, 0xffff0000, v31
    v_add_f32 v94, v94, v67
    v_add_f32 v95, v95, v31
    v_lshlrev_b32 v64, 16, v32
    v_and_b32 v32, 0xffff0000, v32
    v_add_f32 v88, v88, v64
    v_mfma_f32_32x32x16_bf16 v[160:175], v[108:111], a[32:35], v[160:175]
    ds_read_b128 a[52:55], v14 offset:4096
    v_add_u32 v14, 0x8000, v14
    ds_read_b64_tr_b16 v[100:101], v17 offset:8192
    s_add_u32 s69, s69, 128
    s_mul_i32 s3, s1, 1835008
    s_sub_u32 s70, s70, s3
    v_add_f32 v89, v89, v32
    v_lshlrev_b32 v65, 16, v33
    v_and_b32 v33, 0xffff0000, v33
    v_add_f32 v90, v90, v65
    v_mfma_f32_32x32x16_bf16 v[176:191], v[108:111], a[36:39], v[176:191]
    ds_read_b64_tr_b16 v[102:103], v17 offset:8704
    v_add_f32 v91, v91, v33
    v_lshlrev_b32 v66, 16, v34
    v_and_b32 v34, 0xffff0000, v34
    v_add_f32 v92, v92, v66
    v_add_f32 v93, v93, v34
    v_lshlrev_b32 v67, 16, v35
    s_waitcnt lgkmcnt(6)
    v_mfma_f32_32x32x16_bf16 v[128:143], v[112:115], a[40:43], v[128:143]
    ds_read_b128 a[56:59], v15
    ds_read_b64_tr_b16 v[104:105], v16 offset:12288
    v_and_b32 v35, 0xffff0000, v35
    v_add_f32 v94, v94, v67
    v_add_f32 v95, v95, v35
    v_lshlrev_b32 v64, 16, v36
    v_and_b32 v36, 0xffff0000, v36
    v_add_f32 v88, v88, v64
    v_mfma_f32_32x32x16_bf16 v[144:159], v[112:115], a[44:47], v[144:159]
    ds_read_b64_tr_b16 v[106:107], v16 offset:12800
    v_add_u32 v16, 0x8000, v16
    v_add_f32 v89, v89, v36
    v_lshlrev_b32 v65, 16, v37
    v_and_b32 v37, 0xffff0000, v37
    v_add_f32 v90, v90, v65
    v_add_f32 v91, v91, v37
    v_lshlrev_b32 v66, 16, v38
    v_mfma_f32_32x32x16_bf16 v[160:175], v[116:119], a[40:43], v[160:175]
    ds_read_b128 a[60:63], v15 offset:4096
    v_add_u32 v15, 0x8000, v15
    ds_read_b64_tr_b16 v[108:109], v17 offset:12288
    v_and_b32 v38, 0xffff0000, v38
    v_add_f32 v92, v92, v66
    v_add_f32 v93, v93, v38
    v_lshlrev_b32 v67, 16, v39
    v_and_b32 v39, 0xffff0000, v39
    v_mfma_f32_32x32x16_bf16 v[176:191], v[116:119], a[44:47], v[176:191]
    ds_read_b64_tr_b16 v[110:111], v17 offset:12800
    v_add_u32 v17, 0x8000, v17
    v_add_f32 v94, v94, v67
    v_add_f32 v95, v95, v39
    v_lshlrev_b32 v64, 16, v40
    v_and_b32 v40, 0xffff0000, v40
    v_add_f32 v88, v88, v64
    s_waitcnt lgkmcnt(6)
    v_mfma_f32_32x32x16_bf16 v[128:143], v[96:99], a[48:51], v[128:143]
    s_waitcnt vmcnt(12)
    s_barrier
    ds_read_b128 a[64:67], v12
    ds_read_b64_tr_b16 v[112:113], v16 offset:0
    s_add_u32 m0, s71, 0
    s_nop 0
    buffer_load_dwordx4 v8, s[32:35], s70 offen offset:0 lds
    v_mfma_f32_32x32x16_bf16 v[144:159], v[96:99], a[52:55], v[144:159]
    ds_read_b64_tr_b16 v[114:115], v16 offset:512
    v_add_f32 v89, v89, v40
    v_lshlrev_b32 v65, 16, v41
    v_and_b32 v41, 0xffff0000, v41
    v_add_f32 v90, v90, v65
    v_mfma_f32_32x32x16_bf16 v[160:175], v[100:103], a[48:51], v[160:175]
    ds_read_b128 a[68:71], v12 offset:4096
    v_add_u32 v12, 0x8000, v12
    ds_read_b64_tr_b16 v[116:117], v17 offset:0
    buffer_load_dwordx4 v9, s[32:35], s70 offen offset:1024 lds
    v_add_f32 v91, v91, v41
    v_lshlrev_b32 v66, 16, v42
    v_and_b32 v42, 0xffff0000, v42
    v_mfma_f32_32x32x16_bf16 v[176:191], v[100:103], a[52:55], v[176:191]
    ds_read_b64_tr_b16 v[118:119], v17 offset:512
    v_add_f32 v92, v92, v66
    v_add_f32 v93, v93, v42
    v_lshlrev_b32 v67, 16, v43
    v_and_b32 v43, 0xffff0000, v43
    v_add_f32 v94, v94, v67
    v_add_f32 v95, v95, v43
    v_lshlrev_b32 v64, 16, v44
    s_waitcnt lgkmcnt(6)
    v_mfma_f32_32x32x16_bf16 v[128:143], v[104:107], a[56:59], v[128:143]
    ds_read_b128 a[72:75], v13
    ds_read_b64_tr_b16 v[96:97], v16 offset:4096
    s_add_u32 m0, s71, 2048
    s_nop 0
    buffer_load_dwordx4 v10, s[36:39], s70 offen offset:0 lds
    v_and_b32 v44, 0xffff0000, v44
    v_add_f32 v88, v88, v64
    v_mfma_f32_32x32x16_bf16 v[144:159], v[104:107], a[60:63], v[144:159]
    ds_read_b64_tr_b16 v[98:99], v16 offset:4608
    v_add_f32 v89, v89, v44
    v_lshlrev_b32 v65, 16, v45
    v_and_b32 v45, 0xffff0000, v45
    v_add_f32 v90, v90, v65
    v_add_f32 v91, v91, v45
    v_lshlrev_b32 v66, 16, v46
    v_and_b32 v46, 0xffff0000, v46
    v_mfma_f32_32x32x16_bf16 v[160:175], v[108:111], a[56:59], v[160:175]
    ds_read_b128 a[76:79], v13 offset:4096
    v_add_u32 v13, 0x8000, v13
    ds_read_b64_tr_b16 v[100:101], v17 offset:4096
    buffer_load_dwordx4 v11, s[36:39], s70 offen offset:1024 lds
    v_add_f32 v92, v92, v66
    v_add_f32 v93, v93, v46
    v_lshlrev_b32 v67, 16, v47
    v_mfma_f32_32x32x16_bf16 v[176:191], v[108:111], a[60:63], v[176:191]
    ds_read_b64_tr_b16 v[102:103], v17 offset:4608
    v_and_b32 v47, 0xffff0000, v47
    v_add_f32 v94, v94, v67
    v_add_f32 v95, v95, v47
    v_permlane32_swap_b32 v88, v92
    v_permlane32_swap_b32 v89, v93
    v_permlane32_swap_b32 v90, v94
    s_waitcnt lgkmcnt(6)
    v_mfma_f32_32x32x16_bf16 v[128:143], v[112:115], a[64:67], v[128:143]
    ds_read_b128 a[80:83], v14
    ds_read_b64_tr_b16 v[104:105], v16 offset:8192
    v_permlane32_swap_b32 v91, v95
    v_and_b32 v64, 7, v1
    v_lshlrev_b32 v64, 3, v64
    v_add_f32 v88, v88, v92
    v_add_f32 v89, v89, v93
    v_add_f32 v90, v90, v94
    v_mfma_f32_32x32x16_bf16 v[144:159], v[112:115], a[68:71], v[144:159]
    ds_read_b64_tr_b16 v[106:107], v16 offset:8704
    s_add_u32 s70, s70, 229376
    s_add_u32 m0, s71, 16384
    s_nop 0
    buffer_load_dwordx4 v4, s[24:27], s69 offen offset:0 lds
    v_add_f32 v91, v91, v95
    v_lshrrev_b32 v65, 3, v1
    v_or_b32 v64, v64, v65
    v_mfma_f32_32x32x16_bf16 v[160:175], v[116:119], a[64:67], v[160:175]
    ds_read_b128 a[84:87], v14 offset:4096
    v_add_u32 v14, 0x8000, v14
    ds_read_b64_tr_b16 v[108:109], v17 offset:8192
    v_permlane16_swap_b32 v88, v90
    v_permlane16_swap_b32 v89, v91
    s_lshl_b32 s85, s60, 2
    s_add_u32 s85, s85, 149504
    v_add_f32 v88, v88, v90
    v_add_f32 v89, v89, v91
    v_mfma_f32_32x32x16_bf16 v[176:191], v[116:119], a[68:71], v[176:191]
    ds_read_b64_tr_b16 v[110:111], v17 offset:8704
    buffer_load_dwordx4 v5, s[24:27], s69 offen offset:1024 lds
    v_lshl_add_u32 v64, v64, 4, s85
    v_add_u32 v65, 149504, v2
    v_add_f32 v90, v88, v88 row_ror:8 row_mask:0xf bank_mask:0x3
    v_lshlrev_b32 v74, 1, v2
    s_waitcnt lgkmcnt(6)
    v_mfma_f32_32x32x16_bf16 v[128:143], v[96:99], a[72:75], v[128:143]
    ds_read_b128 a[88:91], v15
    ds_read_b64_tr_b16 v[112:113], v16 offset:12288
    v_mov_b32 v73, s65
    v_add_f32 v90, v89, v89 row_ror:8 row_mask:0xf bank_mask:0xc
    ds_write_b32 v64, v90
    v_mfma_f32_32x32x16_bf16 v[144:159], v[96:99], a[76:79], v[144:159]
    ds_read_b64_tr_b16 v[114:115], v16 offset:12800
    v_add_u32 v16, 0x8000, v16
    buffer_load_dwordx4 v6, s[24:27], s69 offen offset:2048 lds
    v_mfma_f32_32x32x16_bf16 v[160:175], v[100:103], a[72:75], v[160:175]
    ds_read_b128 a[92:95], v15 offset:4096
    v_add_u32 v15, 0x8000, v15
    ds_read_b64_tr_b16 v[116:117], v17 offset:12288
    v_mfma_f32_32x32x16_bf16 v[176:191], v[100:103], a[76:79], v[176:191]
    ds_read_b64_tr_b16 v[118:119], v17 offset:12800
    v_add_u32 v17, 0x8000, v17
    buffer_load_dwordx4 v7, s[24:27], s69 offen offset:3072 lds
    s_waitcnt lgkmcnt(7)
    v_mfma_f32_32x32x16_bf16 v[128:143], v[104:107], a[80:83], v[128:143]
    s_waitcnt vmcnt(12) lgkmcnt(4)
    s_barrier
    ds_read_b128 a[96:99], v12
    ds_read_b64_tr_b16 v[96:97], v16 offset:0
    ds_read_b128 v[68:71], v65
    v_mfma_f32_32x32x16_bf16 v[144:159], v[104:107], a[84:87], v[144:159]
    ds_read_b64_tr_b16 v[98:99], v16 offset:512
    v_mfma_f32_32x32x16_bf16 v[160:175], v[108:111], a[80:83], v[160:175]
    ds_read_b128 a[100:103], v12 offset:4096
    v_add_u32 v12, 0x8000, v12
    ds_read_b64_tr_b16 v[100:101], v17 offset:0
    s_add_u32 s69, s69, 128
    s_add_u32 m0, s71, 32768
    s_nop 0
    buffer_load_dwordx4 v8, s[32:35], s70 offen offset:0 lds
    v_mfma_f32_32x32x16_bf16 v[176:191], v[108:111], a[84:87], v[176:191]
    ds_read_b64_tr_b16 v[102:103], v17 offset:512
    s_waitcnt lgkmcnt(7)
    v_mfma_f32_32x32x16_bf16 v[128:143], v[112:115], a[88:91], v[128:143]
    ds_read_b128 a[104:107], v13
    ds_read_b64_tr_b16 v[104:105], v16 offset:4096
    buffer_load_dwordx4 v9, s[32:35], s70 offen offset:1024 lds
    s_waitcnt lgkmcnt(6)
    v_add_f32 v68, v68, v69
    v_add_f32 v70, v70, v71
    v_mov_b32 v71, v73
    v_add_f32 v68, v68, v70
    v_mfma_f32_32x32x16_bf16 v[144:159], v[112:115], a[92:95], v[144:159]
    ds_read_b64_tr_b16 v[106:107], v16 offset:4608
    v_cvt_pk_bf16_f32 v69, v68, v68
    v_lshlrev_b32 v69, 16, v69
    v_sub_f32 v69, v68, v69
    v_cvt_pk_bf16_f32 v70, v68, v69
    v_mov_b32 v72, 0
    s_cmp_ge_u32 s86, 1073741824
    s_cbranch_scc1 L_sk_62
    s_bitcmp1_b32 s86, 4
    s_cbranch_scc1 L_sk_63
    buffer_store_dwordx2 v[70:71], v74, s[48:51], s86 offen sc1
L_sk_63:
    s_bitcmp0_b32 s86, 4
    s_cbranch_scc1 L_sk_64
    buffer_store_dwordx4 v[70:73], v74, s[48:51], s86 offen sc1
L_sk_64:
L_sk_62:
    s_cmp_ge_u32 s6, 1073741824
    s_cbranch_scc1 L_sk_65
    s_waitcnt vmcnt(15)
    s_mov_b64 exec, 1
    buffer_store_dword v71, off, s[48:51], s96 sc1
    s_mov_b64 exec, -1
L_sk_65:
    v_mfma_f32_32x32x16_bf16 v[160:175], v[116:119], a[88:91], v[160:175]
    ds_read_b128 a[108:111], v13 offset:4096
    v_add_u32 v13, 0x8000, v13
    ds_read_b64_tr_b16 v[108:109], v17 offset:4096
    v_mfma_f32_32x32x16_bf16 v[176:191], v[116:119], a[92:95], v[176:191]
    ds_read_b64_tr_b16 v[110:111], v17 offset:4608
    s_add_u32 m0, s71, 34816
    s_nop 0
    buffer_load_dwordx4 v10, s[36:39], s70 offen offset:0 lds
    s_waitcnt lgkmcnt(6)
    v_mfma_f32_32x32x16_bf16 v[128:143], v[96:99], a[96:99], v[128:143]
    ds_read_b128 a[112:115], v14
    ds_read_b64_tr_b16 v[112:113], v16 offset:8192
    v_mfma_f32_32x32x16_bf16 v[144:159], v[96:99], a[100:103], v[144:159]
    ds_read_b64_tr_b16 v[114:115], v16 offset:8704
    buffer_load_dwordx4 v11, s[36:39], s70 offen offset:1024 lds
    v_mfma_f32_32x32x16_bf16 v[160:175], v[100:103], a[96:99], v[160:175]
    ds_read_b128 a[116:119], v14 offset:4096
    v_add_u32 v14, 0x8000, v14
    ds_read_b64_tr_b16 v[116:117], v17 offset:8192
    v_mfma_f32_32x32x16_bf16 v[176:191], v[100:103], a[100:103], v[176:191]
    ds_read_b64_tr_b16 v[118:119], v17 offset:8704
    s_add_u32 s70, s70, 229376
    buffer_load_dword v3, v23, s[40:43], 0 offen
    s_waitcnt lgkmcnt(6)
    v_mfma_f32_32x32x16_bf16 v[128:143], v[104:107], a[104:107], v[128:143]
    ds_read_b128 a[120:123], v15
    ds_read_b64_tr_b16 v[96:97], v16 offset:12288
    v_mfma_f32_32x32x16_bf16 v[144:159], v[104:107], a[108:111], v[144:159]
    ds_read_b64_tr_b16 v[98:99], v16 offset:12800
    v_add_u32 v16, 0xfffe4000, v16
    v_mfma_f32_32x32x16_bf16 v[160:175], v[108:111], a[104:107], v[160:175]
    ds_read_b128 a[124:127], v15 offset:4096
    v_add_u32 v15, 0x8000, v15
    ds_read_b64_tr_b16 v[100:101], v17 offset:12288
    v_mfma_f32_32x32x16_bf16 v[176:191], v[108:111], a[108:111], v[176:191]
    ds_read_b64_tr_b16 v[102:103], v17 offset:12800
    v_add_u32 v17, 0xfffe4000, v17
    s_waitcnt lgkmcnt(6)
    v_mfma_f32_32x32x16_bf16 v[128:143], v[112:115], a[112:115], v[128:143]
    s_waitcnt vmcnt(9)
    s_barrier
    ds_read_b128 a[128:131], v12
    ds_read_b64_tr_b16 v[104:105], v16 offset:0
    s_add_u32 m0, s71, 49152
    s_nop 0
    buffer_load_dwordx4 v4, s[24:27], s69 offen offset:0 lds
    v_mfma_f32_32x32x16_bf16 v[144:159], v[112:115], a[116:119], v[144:159]
    ds_read_b64_tr_b16 v[106:107], v16 offset:512
    v_mfma_f32_32x32x16_bf16 v[160:175], v[116:119], a[112:115], v[160:175]
    ds_read_b128 a[132:135], v12 offset:4096
    v_add_u32 v12, 0xfffe4000, v12
    ds_read_b64_tr_b16 v[108:109], v17 offset:0
    buffer_load_dwordx4 v5, s[24:27], s69 offen offset:1024 lds
    v_mfma_f32_32x32x16_bf16 v[176:191], v[116:119], a[116:119], v[176:191]
    ds_read_b64_tr_b16 v[110:111], v17 offset:512
    s_waitcnt lgkmcnt(6)
    v_mfma_f32_32x32x16_bf16 v[128:143], v[96:99], a[120:123], v[128:143]
    ds_read_b128 a[136:139], v13
    ds_read_b64_tr_b16 v[112:113], v16 offset:4096
    v_mfma_f32_32x32x16_bf16 v[144:159], v[96:99], a[124:127], v[144:159]
    ds_read_b64_tr_b16 v[114:115], v16 offset:4608
    buffer_load_dwordx4 v6, s[24:27], s69 offen offset:2048 lds
    v_mfma_f32_32x32x16_bf16 v[160:175], v[100:103], a[120:123], v[160:175]
    ds_read_b128 a[140:143], v13 offset:4096
    v_add_u32 v13, 0xfffe4000, v13
    ds_read_b64_tr_b16 v[116:117], v17 offset:4096
    v_mfma_f32_32x32x16_bf16 v[176:191], v[100:103], a[124:127], v[176:191]
    ds_read_b64_tr_b16 v[118:119], v17 offset:4608
    buffer_load_dwordx4 v7, s[24:27], s69 offen offset:3072 lds
    s_waitcnt lgkmcnt(6)
    v_mfma_f32_32x32x16_bf16 v[128:143], v[104:107], a[128:131], v[128:143]
    ds_read_b128 a[144:147], v14
    ds_read_b64_tr_b16 v[96:97], v16 offset:8192
    v_mfma_f32_32x32x16_bf16 v[144:159], v[104:107], a[132:135], v[144:159]
    ds_read_b64_tr_b16 v[98:99], v16 offset:8704
    s_add_u32 s69, s69, 128
    s_add_u32 m0, s71, 65536
    s_nop 0
    buffer_load_dwordx4 v8, s[32:35], s70 offen offset:0 lds
    v_mfma_f32_32x32x16_bf16 v[160:175], v[108:111], a[128:131], v[160:175]
    ds_read_b128 a[148:151], v14 offset:4096
    v_add_u32 v14, 0xfffe4000, v14
    ds_read_b64_tr_b16 v[100:101], v17 offset:8192
    v_mfma_f32_32x32x16_bf16 v[176:191], v[108:111], a[132:135], v[176:191]
    ds_read_b64_tr_b16 v[102:103], v17 offset:8704
    buffer_load_dwordx4 v9, s[32:35], s70 offen offset:1024 lds
    s_waitcnt lgkmcnt(6)
    v_mfma_f32_32x32x16_bf16 v[128:143], v[112:115], a[136:139], v[128:143]
    ds_read_b128 a[152:155], v15
    ds_read_b64_tr_b16 v[104:105], v16 offset:12288
    v_mfma_f32_32x32x16_bf16 v[144:159], v[112:115], a[140:143], v[144:159]
    ds_read_b64_tr_b16 v[106:107], v16 offset:12800
    v_add_u32 v16, 0x8000, v16
    v_mfma_f32_32x32x16_bf16 v[160:175], v[116:119], a[136:139], v[160:175]
    ds_read_b128 a[156:159], v15 offset:4096
    v_add_u32 v15, 0xfffe4000, v15
    ds_read_b64_tr_b16 v[108:109], v17 offset:12288
    s_add_u32 m0, s71, 67584
    s_nop 0
    buffer_load_dwordx4 v10, s[36:39], s70 offen offset:0 lds
    v_mfma_f32_32x32x16_bf16 v[176:191], v[116:119], a[140:143], v[176:191]
    ds_read_b64_tr_b16 v[110:111], v17 offset:12800
    v_add_u32 v17, 0x8000, v17
    s_waitcnt lgkmcnt(6)
    v_mfma_f32_32x32x16_bf16 v[128:143], v[96:99], a[144:147], v[128:143]
    s_waitcnt vmcnt(8)
    s_barrier
    ds_read_b128 a[160:163], v12
    ds_read_b64_tr_b16 v[112:113], v16 offset:0
    buffer_load_dwordx4 v11, s[36:39], s70 offen offset:1024 lds
    v_mfma_f32_32x32x16_bf16 v[144:159], v[96:99], a[148:151], v[144:159]
    ds_read_b64_tr_b16 v[114:115], v16 offset:512
    s_add_u32 s70, s70, 229376
    s_add_u32 m0, s71, 81920
    s_nop 0
    buffer_load_dwordx4 v4, s[24:27], s69 offen offset:0 lds
    v_mfma_f32_32x32x16_bf16 v[160:175], v[100:103], a[144:147], v[160:175]
    ds_read_b128 a[164:167], v12 offset:4096
    v_add_u32 v12, 0x8000, v12
    ds_read_b64_tr_b16 v[116:117], v17 offset:0
    v_mfma_f32_32x32x16_bf16 v[176:191], v[100:103], a[148:151], v[176:191]
    ds_read_b64_tr_b16 v[118:119], v17 offset:512
    s_waitcnt lgkmcnt(6)
    v_mfma_f32_32x32x16_bf16 v[128:143], v[104:107], a[152:155], v[128:143]
    ds_read_b128 a[168:171], v13
    ds_read_b64_tr_b16 v[96:97], v16 offset:4096
    buffer_load_dwordx4 v5, s[24:27], s69 offen offset:1024 lds
    v_mfma_f32_32x32x16_bf16 v[144:159], v[104:107], a[156:159], v[144:159]
    ds_read_b64_tr_b16 v[98:99], v16 offset:4608
    v_mfma_f32_32x32x16_bf16 v[160:175], v[108:111], a[152:155], v[160:175]
    ds_read_b128 a[172:175], v13 offset:4096
    v_add_u32 v13, 0x8000, v13
    ds_read_b64_tr_b16 v[100:101], v17 offset:4096
    v_mfma_f32_32x32x16_bf16 v[176:191], v[108:111], a[156:159], v[176:191]
    ds_read_b64_tr_b16 v[102:103], v17 offset:4608
    buffer_load_dwordx4 v6, s[24:27], s69 offen offset:2048 lds
    s_waitcnt lgkmcnt(6)
    v_mfma_f32_32x32x16_bf16 v[128:143], v[112:115], a[160:163], v[128:143]
    ds_read_b128 a[176:179], v14
    ds_read_b64_tr_b16 v[104:105], v16 offset:8192
    v_mfma_f32_32x32x16_bf16 v[144:159], v[112:115], a[164:167], v[144:159]
    ds_read_b64_tr_b16 v[106:107], v16 offset:8704
    buffer_load_dwordx4 v7, s[24:27], s69 offen offset:3072 lds
    v_mfma_f32_32x32x16_bf16 v[160:175], v[116:119], a[160:163], v[160:175]
    ds_read_b128 a[180:183], v14 offset:4096
    v_add_u32 v14, 0x8000, v14
    ds_read_b64_tr_b16 v[108:109], v17 offset:8192
    v_mfma_f32_32x32x16_bf16 v[176:191], v[116:119], a[164:167], v[176:191]
    ds_read_b64_tr_b16 v[110:111], v17 offset:8704
    s_add_u32 s69, s69, 128
    s_add_u32 m0, s71, 98304
    s_nop 0
    buffer_load_dwordx4 v8, s[32:35], s70 offen offset:0 lds
    s_waitcnt lgkmcnt(6)
    v_mfma_f32_32x32x16_bf16 v[128:143], v[96:99], a[168:171], v[128:143]
    ds_read_b128 a[184:187], v15
    ds_read_b64_tr_b16 v[112:113], v16 offset:12288
    v_mfma_f32_32x32x16_bf16 v[144:159], v[96:99], a[172:175], v[144:159]
    ds_read_b64_tr_b16 v[114:115], v16 offset:12800
    v_add_u32 v16, 0x8000, v16
    buffer_load_dwordx4 v9, s[32:35], s70 offen offset:1024 lds
    v_mfma_f32_32x32x16_bf16 v[160:175], v[100:103], a[168:171], v[160:175]
    ds_read_b128 a[188:191], v15 offset:4096
    v_add_u32 v15, 0x8000, v15
    ds_read_b64_tr_b16 v[116:117], v17 offset:12288
    v_mfma_f32_32x32x16_bf16 v[176:191], v[100:103], a[172:175], v[176:191]
    ds_read_b64_tr_b16 v[118:119], v17 offset:12800
    v_add_u32 v17, 0x8000, v17
    s_waitcnt lgkmcnt(6)
    v_mfma_f32_32x32x16_bf16 v[128:143], v[104:107], a[176:179], v[128:143]
    s_waitcnt vmcnt(6)
    s_barrier
    ds_read_b128 a[192:195], v12
    ds_read_b64_tr_b16 v[96:97], v16 offset:0
    s_add_u32 m0, s71, 100352
    s_nop 0
    buffer_load_dwordx4 v10, s[36:39], s70 offen offset:0 lds
    v_mfma_f32_32x32x16_bf16 v[144:159], v[104:107], a[180:183], v[144:159]
    ds_read_b64_tr_b16 v[98:99], v16 offset:512
    buffer_load_dwordx4 v11, s[36:39], s70 offen offset:1024 lds
    v_mfma_f32_32x32x16_bf16 v[160:175], v[108:111], a[176:179], v[160:175]
    ds_read_b128 a[196:199], v12 offset:4096
    v_add_u32 v12, 0x8000, v12
    ds_read_b64_tr_b16 v[100:101], v17 offset:0
    s_add_u32 s70, s70, 229376
    buffer_load_dwordx2 v[44:45], v18, s[48:51], 0 offen sc1
    v_mfma_f32_32x32x16_bf16 v[176:191], v[108:111], a[180:183], v[176:191]
    ds_read_b64_tr_b16 v[102:103], v17 offset:512
    s_waitcnt lgkmcnt(6)
    v_mfma_f32_32x32x16_bf16 v[128:143], v[112:115], a[184:187], v[128:143]
    ds_read_b128 a[200:203], v13
    ds_read_b64_tr_b16 v[104:105], v16 offset:4096
    v_mfma_f32_32x32x16_bf16 v[144:159], v[112:115], a[188:191], v[144:159]
    ds_read_b64_tr_b16 v[106:107], v16 offset:4608
    v_mfma_f32_32x32x16_bf16 v[160:175], v[116:119], a[184:187], v[160:175]
    ds_read_b128 a[204:207], v13 offset:4096
    v_add_u32 v13, 0x8000, v13
    ds_read_b64_tr_b16 v[108:109], v17 offset:4096
    buffer_load_dwordx4 v[24:27], v19, s[48:51], s79 offen sc1
    v_mfma_f32_32x32x16_bf16 v[176:191], v[116:119], a[188:191], v[176:191]
    ds_read_b64_tr_b16 v[110:111], v17 offset:4608
    s_waitcnt lgkmcnt(6)
    v_mfma_f32_32x32x16_bf16 v[128:143], v[96:99], a[192:195], v[128:143]
    ds_read_b128 a[208:211], v14
    ds_read_b64_tr_b16 v[112:113], v16 offset:8192
    v_mfma_f32_32x32x16_bf16 v[144:159], v[96:99], a[196:199], v[144:159]
    ds_read_b64_tr_b16 v[114:115], v16 offset:8704
    buffer_load_dwordx4 v[28:31], v19, s[48:51], s80 offen sc1
    v_mfma_f32_32x32x16_bf16 v[160:175], v[100:103], a[192:195], v[160:175]
    ds_read_b128 a[212:215], v14 offset:4096
    v_add_u32 v14, 0x8000, v14
    ds_read_b64_tr_b16 v[116:117], v17 offset:8192
    v_mfma_f32_32x32x16_bf16 v[176:191], v[100:103], a[196:199], v[176:191]
    ds_read_b64_tr_b16 v[118:119], v17 offset:8704
    buffer_load_dwordx4 v[32:35], v19, s[48:51], s81 offen sc1
    s_waitcnt lgkmcnt(6)
    v_mfma_f32_32x32x16_bf16 v[128:143], v[104:107], a[200:203], v[128:143]
    ds_read_b128 a[216:219], v15
    ds_read_b64_tr_b16 v[96:97], v16 offset:12288
    v_mfma_f32_32x32x16_bf16 v[144:159], v[104:107], a[204:207], v[144:159]
    ds_read_b64_tr_b16 v[98:99], v16 offset:12800
    v_add_u32 v16, 0x8000, v16
    buffer_load_dwordx4 v[36:39], v19, s[48:51], s82 offen sc1
    v_mfma_f32_32x32x16_bf16 v[160:175], v[108:111], a[200:203], v[160:175]
    ds_read_b128 a[220:223], v15 offset:4096
    v_add_u32 v15, 0x8000, v15
    ds_read_b64_tr_b16 v[100:101], v17 offset:12288
    v_mfma_f32_32x32x16_bf16 v[176:191], v[108:111], a[204:207], v[176:191]
    ds_read_b64_tr_b16 v[102:103], v17 offset:12800
    v_add_u32 v17, 0x8000, v17
    buffer_load_dwordx4 v[40:43], v21, s[48:51], s83 offen sc1
    s_waitcnt lgkmcnt(6)
    v_mfma_f32_32x32x16_bf16 v[128:143], v[112:115], a[208:211], v[128:143]
    s_waitcnt vmcnt(6)
    s_barrier
    ds_read_b128 a[224:227], v12
    ds_read_b64_tr_b16 v[104:105], v16 offset:0
    v_mov_b32 v8, v123
    v_add_u32 v9, 23552, v123
    v_mfma_f32_32x32x16_bf16 v[144:159], v[112:115], a[212:215], v[144:159]
    ds_read_b64_tr_b16 v[106:107], v16 offset:512
    v_add_u32 v10, 47104, v123
    v_add_u32 v11, 70656, v123
    s_mul_i32 s70, s64, 128
    s_mul_i32 s3, s60, 98304
    s_add_u32 s70, s70, s3
    s_mul_i32 s3, s1, 786432
    s_add_u32 s70, s70, s3
    v_mfma_f32_32x32x16_bf16 v[160:175], v[116:119], a[208:211], v[160:175]
    ds_read_b128 a[228:231], v12 offset:4096
    ds_read_b64_tr_b16 v[108:109], v17 offset:0
    s_add_u32 m0, s71, 114688
    s_nop 0
    buffer_load_dwordx4 v8, s[28:31], s70 offen offset:0 lds
    v_mfma_f32_32x32x16_bf16 v[176:191], v[116:119], a[212:215], v[176:191]
    ds_read_b64_tr_b16 v[110:111], v17 offset:512
    buffer_load_dwordx4 v9, s[28:31], s70 offen offset:1024 lds
    s_waitcnt lgkmcnt(6)
    v_mfma_f32_32x32x16_bf16 v[128:143], v[96:99], a[216:219], v[128:143]
    ds_read_b128 a[232:235], v13
    ds_read_b64_tr_b16 v[112:113], v16 offset:4096
    buffer_load_dwordx4 v10, s[28:31], s70 offen offset:2048 lds
    v_mfma_f32_32x32x16_bf16 v[144:159], v[96:99], a[220:223], v[144:159]
    ds_read_b64_tr_b16 v[114:115], v16 offset:4608
    buffer_load_dwordx4 v11, s[28:31], s70 offen offset:3072 lds
    v_mfma_f32_32x32x16_bf16 v[160:175], v[100:103], a[216:219], v[160:175]
    ds_read_b128 a[236:239], v13 offset:4096
    ds_read_b64_tr_b16 v[116:117], v17 offset:4096
    s_add_u32 s70, s70, 393216
    s_add_u32 m0, s71, 131072
    s_nop 0
    buffer_load_dwordx4 v8, s[28:31], s70 offen offset:0 lds
    v_mfma_f32_32x32x16_bf16 v[176:191], v[100:103], a[220:223], v[176:191]
    ds_read_b64_tr_b16 v[118:119], v17 offset:4608
    s_waitcnt lgkmcnt(6)
    v_mfma_f32_32x32x16_bf16 v[128:143], v[104:107], a[224:227], v[128:143]
    ds_read_b128 a[240:243], v14
    ds_read_b64_tr_b16 v[96:97], v16 offset:8192
    v_mfma_f32_32x32x16_bf16 v[144:159], v[104:107], a[228:231], v[144:159]
    ds_read_b64_tr_b16 v[98:99], v16 offset:8704
    v_mfma_f32_32x32x16_bf16 v[160:175], v[108:111], a[224:227], v[160:175]
    ds_read_b128 a[244:247], v14 offset:4096
    ds_read_b64_tr_b16 v[100:101], v17 offset:8192
    v_mfma_f32_32x32x16_bf16 v[176:191], v[108:111], a[228:231], v[176:191]
    ds_read_b64_tr_b16 v[102:103], v17 offset:8704
    s_waitcnt lgkmcnt(6)
    v_mfma_f32_32x32x16_bf16 v[128:143], v[112:115], a[232:235], v[128:143]
    ds_read_b128 a[248:251], v15
    ds_read_b64_tr_b16 v[104:105], v16 offset:12288
    v_mfma_f32_32x32x16_bf16 v[144:159], v[112:115], a[236:239], v[144:159]
    ds_read_b64_tr_b16 v[106:107], v16 offset:12800
    buffer_load_dwordx4 v9, s[28:31], s70 offen offset:1024 lds
    s_waitcnt vmcnt(6)
    v_xor_b32 v80, s65, v45
    v_bitop3_b32 v80, v80, v25, s65 bitop3:0xf6
    v_bitop3_b32 v80, v80, v27, s65 bitop3:0xf6
    v_bitop3_b32 v80, v80, v29, s65 bitop3:0xf6
    v_bitop3_b32 v80, v80, v31, s65 bitop3:0xf6
    v_mfma_f32_32x32x16_bf16 v[160:175], v[116:119], a[232:235], v[160:175]
    ds_read_b128 a[252:255], v15 offset:4096
    ds_read_b64_tr_b16 v[108:109], v17 offset:12288
    v_bitop3_b32 v80, v80, v33, s65 bitop3:0xf6
    v_bitop3_b32 v80, v80, v35, s65 bitop3:0xf6
    v_bitop3_b32 v80, v80, v37, s65 bitop3:0xf6
    v_bitop3_b32 v80, v80, v39, s65 bitop3:0xf6
    v_bitop3_b32 v80, v80, v41, s65 bitop3:0xf6
    v_bitop3_b32 v80, v80, v43, s65 bitop3:0xf6
    v_mfma_f32_32x32x16_bf16 v[176:191], v[116:119], a[236:239], v[176:191]
    ds_read_b64_tr_b16 v[110:111], v17 offset:12800
    v_add_u32 v16, 0x1c000, v121
    buffer_load_dwordx4 v10, s[28:31], s70 offen offset:2048 lds
    v_cmp_ne_u32 vcc, 0, v80
    s_cbranch_vccnz L_retry_Qg
L_back_Qg:
    v_mov_b32 v46, v44
    s_mov_b32 s77, 0x01000100
    s_waitcnt lgkmcnt(6)
    v_mfma_f32_32x32x16_bf16 v[128:143], v[96:99], a[240:243], v[128:143]
    s_waitcnt vmcnt(3)
    s_barrier
    ds_read_b64_tr_b16 v[112:113], v16 offset:0
    v_permlane32_swap_b32 v44, v46
    v_and_b32 v58, 0xffff0000, v44
    v_mfma_f32_32x32x16_bf16 v[144:159], v[96:99], a[244:247], v[144:159]
    ds_read_b64_tr_b16 v[114:115], v16 offset:512
    buffer_load_dwordx4 v11, s[28:31], s70 offen offset:3072 lds
    v_xor_b32 v44, 0x8000, v44
    v_rcp_f32 v56, v58
    v_perm_b32 v48, v44, v44, s77
    v_mov_b32 v49, 0
    v_mfma_f32_32x32x16_bf16 v[160:175], v[100:103], a[240:243], v[160:175]
    ds_read_b64_tr_b16 v[116:117], v16 offset:2048
    s_add_u32 s70, s70, 393216
    s_mul_i32 s3, s1, 1572864
    s_sub_u32 s70, s70, s3
    s_add_u32 m0, s71, 0
    s_nop 0
    buffer_load_dwordx4 v8, s[28:31], s70 offen offset:0 lds
    v_mov_b32 v50, v48
    v_mfma_f32_32x32x16_bf16 v[176:191], v[100:103], a[244:247], v[176:191]
    ds_read_b64_tr_b16 v[118:119], v16 offset:2560
    v_mov_b32 v51, 0
    v_mul_f32 v56, 0x3fb8aa3b, v56
    v_and_b32 v59, 0xffff0000, v46
    v_xor_b32 v46, 0x8000, v46
    v_rcp_f32 v57, v59
    s_waitcnt lgkmcnt(4)
    v_mfma_f32_32x32x16_bf16 v[128:143], v[104:107], a[248:251], v[128:143]
    ds_read_b64_tr_b16 v[96:97], v16 offset:4096
    v_perm_b32 v52, v46, v46, s77
    v_mov_b32 v53, 0
    v_mov_b32 v54, v52
    v_mov_b32 v55, 0
    v_mul_f32 v57, 0x3fb8aa3b, v57
    v_mfma_f32_32x32x16_bf16 v[128:143], v[24:27], v[48:51], v[128:143]
    v_mfma_f32_32x32x16_bf16 v[144:159], v[24:27], v[52:55], v[144:159]
    buffer_load_dwordx4 v9, s[28:31], s70 offen offset:1024 lds
    v_mfma_f32_32x32x16_bf16 v[160:175], v[28:31], v[48:51], v[160:175]
    v_mfma_f32_32x32x16_bf16 v[176:191], v[28:31], v[52:55], v[176:191]
    v_mfma_f32_32x32x16_bf16 v[144:159], v[104:107], a[252:255], v[144:159]
    ds_read_b64_tr_b16 v[98:99], v16 offset:4608
    buffer_load_dwordx4 v10, s[28:31], s70 offen offset:2048 lds
    v_mfma_f32_32x32x16_bf16 v[160:175], v[108:111], a[248:251], v[160:175]
    ds_read_b64_tr_b16 v[100:101], v16 offset:6144
    v_mfma_f32_32x32x16_bf16 v[176:191], v[108:111], a[252:255], v[176:191]
    ds_read_b64_tr_b16 v[102:103], v16 offset:6656
    s_waitcnt lgkmcnt(4)
    v_mfma_f32_32x32x16_bf16 v[192:207], v[112:115], a[0:3], 0
    ds_read_b64_tr_b16 v[104:105], v16 offset:8192
    buffer_load_dwordx4 v11, s[28:31], s70 offen offset:3072 lds
    v_mfma_f32_32x32x16_bf16 v[208:223], v[112:115], a[4:7], 0
    ds_read_b64_tr_b16 v[106:107], v16 offset:8704
    s_mul_i32 s76, s64, 6
    s_add_u32 s76, s76, s62
    s_lshl_b32 s76, s76, 1
    s_lshl_b32 s76, s76, 11
    s_add_u32 s76, s76, s73
    v_mul_f32 v128, v56, v128
    v_mul_f32 v129, v56, v129
    v_mfma_f32_32x32x16_bf16 v[192:207], v[116:119], a[8:11], v[192:207]
    ds_read_b64_tr_b16 v[108:109], v16 offset:10240
    s_add_u32 s70, s70, 393216
    s_add_u32 m0, s71, 16384
    s_nop 0
    buffer_load_dwordx4 v8, s[28:31], s70 offen offset:0 lds
    v_mul_f32 v130, v56, v130
    v_mfma_f32_32x32x16_bf16 v[208:223], v[116:119], a[12:15], v[208:223]
    ds_read_b64_tr_b16 v[110:111], v16 offset:10752
    v_mfma_f32_32x32x16_bf16 v[192:207], v[40:43], v[48:51], v[192:207]
    v_mul_f32 v131, v56, v131
    v_mul_f32 v132, v56, v132
    v_mul_f32 v133, v56, v133
    v_mul_f32 v134, v56, v134
    v_mul_f32 v135, v56, v135
    v_exp_f32 v128, -v128
    s_waitcnt lgkmcnt(4)
    v_mfma_f32_32x32x16_bf16 v[192:207], v[96:99], a[16:19], v[192:207]
    ds_read_b64_tr_b16 v[112:113], v16 offset:12288
    buffer_load_dwordx4 v9, s[28:31], s70 offen offset:1024 lds
    v_exp_f32 v129, -v129
    v_mfma_f32_32x32x16_bf16 v[208:223], v[96:99], a[20:23], v[208:223]
    ds_read_b64_tr_b16 v[114:115], v16 offset:12800
    v_exp_f32 v130, -v130
    v_exp_f32 v131, -v131
    v_exp_f32 v132, -v132
    v_mfma_f32_32x32x16_bf16 v[192:207], v[100:103], a[24:27], v[192:207]
    ds_read_b64_tr_b16 v[116:117], v16 offset:14336
    buffer_load_dwordx4 v10, s[28:31], s70 offen offset:2048 lds
    v_mfma_f32_32x32x16_bf16 v[208:223], v[40:43], v[52:55], v[208:223]
    v_exp_f32 v133, -v133
    v_exp_f32 v134, -v134
    v_exp_f32 v135, -v135
    v_mfma_f32_32x32x16_bf16 v[208:223], v[100:103], a[28:31], v[208:223]
    ds_read_b64_tr_b16 v[118:119], v16 offset:14848
    v_add_u32 v16, 0x4000, v16
    v_fma_f32 v128, v128, v58, v58
    v_fma_f32 v129, v129, v58, v58
    v_fma_f32 v130, v130, v58, v58
    v_fma_f32 v131, v131, v58, v58
    s_waitcnt lgkmcnt(4)
    v_mfma_f32_32x32x16_bf16 v[192:207], v[104:107], a[32:35], v[192:207]
    s_waitcnt vmcnt(7)
    s_barrier
    ds_read_b64_tr_b16 v[96:97], v16 offset:0
    v_mfma_f32_32x32x16_bf16 v[208:223], v[104:107], a[36:39], v[208:223]
    ds_read_b64_tr_b16 v[98:99], v16 offset:512
    buffer_load_dwordx4 v11, s[28:31], s70 offen offset:3072 lds
    v_fma_f32 v132, v132, v58, v58
    v_fma_f32 v133, v133, v58, v58
    v_mfma_f32_32x32x16_bf16 v[192:207], v[108:111], a[40:43], v[192:207]
    ds_read_b64_tr_b16 v[100:101], v16 offset:2048
    v_fma_f32 v134, v134, v58, v58
    v_fma_f32 v135, v135, v58, v58
    v_rcp_f32 v128, v128
    v_rcp_f32 v129, v129
    v_mfma_f32_32x32x16_bf16 v[208:223], v[108:111], a[44:47], v[208:223]
    ds_read_b64_tr_b16 v[102:103], v16 offset:2560
    s_add_u32 s70, s70, 393216
    v_mov_b32 v8, v124
    v_add_u32 v9, 27648, v124
    v_rcp_f32 v130, v130
    s_waitcnt lgkmcnt(4)
    v_mfma_f32_32x32x16_bf16 v[192:207], v[112:115], a[48:51], v[192:207]
    ds_read_b64_tr_b16 v[104:105], v16 offset:4096
    v_xor_b32 v10, 32, v124
    v_add_u32 v11, 27648, v10
    s_mul_i32 s70, s64, 384
    v_rcp_f32 v131, v131
    v_mfma_f32_32x32x16_bf16 v[208:223], v[112:115], a[52:55], v[208:223]
    ds_read_b64_tr_b16 v[106:107], v16 offset:4608
    s_mul_i32 s3, s60, 57344
    s_add_u32 s70, s70, s3
    s_mul_i32 s3, s1, 917504
    s_add_u32 s70, s70, s3
    s_add_u32 s70, s70, 128
    v_rcp_f32 v132, v132
    v_mfma_f32_32x32x16_bf16 v[192:207], v[116:119], a[56:59], v[192:207]
    ds_read_b64_tr_b16 v[108:109], v16 offset:6144
    s_add_u32 m0, s71, 32768
    s_nop 0
    buffer_load_dwordx4 v8, s[32:35], s70 offen offset:0 lds
    v_rcp_f32 v133, v133
    v_mfma_f32_32x32x16_bf16 v[208:223], v[116:119], a[60:63], v[208:223]
    ds_read_b64_tr_b16 v[110:111], v16 offset:6656
    s_cmp_eq_u32 s60, 0
    s_cselect_b32 s78, 31, 37
    s_cselect_b32 s0, 4, s60
    s_mul_i32 s0, s0, 304
    s_add_u32 s0, s0, 40656
    s_waitcnt lgkmcnt(4)
    v_mfma_f32_32x32x16_bf16 v[192:207], v[96:99], a[64:67], v[192:207]
    ds_read_b64_tr_b16 v[112:113], v16 offset:8192
    buffer_load_dwordx4 v9, s[32:35], s70 offen offset:1024 lds
    s_cmp_eq_u32 s60, 0
    s_cselect_b32 s0, 41856, s0
    s_cmp_eq_u32 s60, 3
    s_cselect_b32 s78, 35, s78
    v_min_u32 v21, s78, v1
    v_mfma_f32_32x32x16_bf16 v[208:223], v[96:99], a[68:71], v[208:223]
    ds_read_b64_tr_b16 v[114:115], v16 offset:8704
    v_lshlrev_b32 v21, 3, v21
    s_andn2_b32 s78, 1073741824, s97
    s_or_b32 s0, s0, s78
    s_and_b32 s78, s65, s97
    v_mov_b32 v22, s78
    s_cmp_eq_u32 s97, 0
    s_cbranch_scc1 L_sk_66
    buffer_load_dwordx2 v[4:5], v21, s[48:51], s0 offen sc1
L_sk_66:
    v_mfma_f32_32x32x16_bf16 v[192:207], v[100:103], a[72:75], v[192:207]
    ds_read_b64_tr_b16 v[116:117], v16 offset:10240
    v_rcp_f32 v134, v134
    v_rcp_f32 v135, v135
    v_mfma_f32_32x32x16_bf16 v[208:223], v[100:103], a[76:79], v[208:223]
    ds_read_b64_tr_b16 v[118:119], v16 offset:10752
    s_add_u32 m0, s71, 34816
    s_nop 0
    buffer_load_dwordx4 v10, s[36:39], s70 offen offset:0 lds
    s_waitcnt lgkmcnt(4)
    v_mfma_f32_32x32x16_bf16 v[192:207], v[104:107], a[80:83], v[192:207]
    ds_read_b64_tr_b16 v[96:97], v16 offset:12288
    v_mul_f32 v136, v136, v128
    v_mul_f32 v137, v137, v129
    v_mul_f32 v138, v138, v130
    v_mul_f32 v139, v139, v131
    v_mul_f32 v140, v140, v132
    v_mfma_f32_32x32x16_bf16 v[208:223], v[104:107], a[84:87], v[208:223]
    ds_read_b64_tr_b16 v[98:99], v16 offset:12800
    buffer_load_dwordx4 v11, s[36:39], s70 offen offset:1024 lds
    v_mul_f32 v141, v141, v133
    v_mul_f32 v142, v142, v134
    v_mul_f32 v143, v143, v135
    v_mfma_f32_32x32x16_bf16 v[192:207], v[108:111], a[88:91], v[192:207]
    ds_read_b64_tr_b16 v[100:101], v16 offset:14336
    v_cvt_pk_bf16_f32 v128, v136, v137
    v_cvt_pk_bf16_f32 v129, v138, v139
    v_cvt_pk_bf16_f32 v130, v140, v141
    v_cvt_pk_bf16_f32 v131, v142, v143
    buffer_store_dwordx4 v[128:131], v2, s[52:55], s76 offen offset:0 sc1
    v_mfma_f32_32x32x16_bf16 v[208:223], v[108:111], a[92:95], v[208:223]
    ds_read_b64_tr_b16 v[102:103], v16 offset:14848
    v_add_u32 v16, 0xfffe0000, v16
    v_mul_f32 v144, v57, v144
    v_mul_f32 v145, v57, v145
    s_waitcnt lgkmcnt(4)
    v_mfma_f32_32x32x16_bf16 v[192:207], v[112:115], a[96:99], v[192:207]
    s_waitcnt vmcnt(9)
    s_barrier
    ds_read_b64_tr_b16 v[104:105], v16 offset:0
    v_mfma_f32_32x32x16_bf16 v[208:223], v[112:115], a[100:103], v[208:223]
    ds_read_b64_tr_b16 v[106:107], v16 offset:512
    v_mul_f32 v146, v57, v146
    v_mul_f32 v147, v57, v147
    v_mul_f32 v148, v57, v148
    v_mul_f32 v149, v57, v149
    v_mfma_f32_32x32x16_bf16 v[192:207], v[116:119], a[104:107], v[192:207]
    ds_read_b64_tr_b16 v[108:109], v16 offset:2048
    s_add_u32 s70, s70, 229376
    s_add_u32 m0, s71, 49152
    s_nop 0
    buffer_load_dwordx4 v8, s[32:35], s70 offen offset:0 lds
    v_mul_f32 v150, v57, v150
    v_mfma_f32_32x32x16_bf16 v[208:223], v[116:119], a[108:111], v[208:223]
    ds_read_b64_tr_b16 v[110:111], v16 offset:2560
    v_mul_f32 v151, v57, v151
    v_exp_f32 v144, -v144
    v_exp_f32 v145, -v145
    s_waitcnt lgkmcnt(4)
    v_mfma_f32_32x32x16_bf16 v[192:207], v[96:99], a[112:115], v[192:207]
    ds_read_b64_tr_b16 v[112:113], v16 offset:4096
    buffer_load_dwordx4 v9, s[32:35], s70 offen offset:1024 lds
    v_exp_f32 v146, -v146
    v_exp_f32 v147, -v147
    v_mfma_f32_32x32x16_bf16 v[208:223], v[96:99], a[116:119], v[208:223]
    ds_read_b64_tr_b16 v[114:115], v16 offset:4608
    v_exp_f32 v148, -v148
    v_exp_f32 v149, -v149
    v_mfma_f32_32x32x16_bf16 v[192:207], v[100:103], a[120:123], v[192:207]
    ds_read_b64_tr_b16 v[116:117], v16 offset:6144
    v_exp_f32 v150, -v150
    v_exp_f32 v151, -v151
    v_fma_f32 v144, v144, v59, v59
    v_mfma_f32_32x32x16_bf16 v[208:223], v[100:103], a[124:127], v[208:223]
    ds_read_b64_tr_b16 v[118:119], v16 offset:6656
    s_add_u32 m0, s71, 51200
    s_nop 0
    buffer_load_dwordx4 v10, s[36:39], s70 offen offset:0 lds
    s_waitcnt lgkmcnt(4)
    v_mfma_f32_32x32x16_bf16 v[192:207], v[104:107], a[128:131], v[192:207]
    ds_read_b64_tr_b16 v[96:97], v16 offset:8192
    v_fma_f32 v145, v145, v59, v59
    v_fma_f32 v146, v146, v59, v59
    v_fma_f32 v147, v147, v59, v59
    v_fma_f32 v148, v148, v59, v59
    v_fma_f32 v149, v149, v59, v59
    v_mfma_f32_32x32x16_bf16 v[208:223], v[104:107], a[132:135], v[208:223]
    ds_read_b64_tr_b16 v[98:99], v16 offset:8704
    buffer_load_dwordx4 v11, s[36:39], s70 offen offset:1024 lds
    v_fma_f32 v150, v150, v59, v59
    v_fma_f32 v151, v151, v59, v59
    v_rcp_f32 v144, v144
    v_mfma_f32_32x32x16_bf16 v[192:207], v[108:111], a[136:139], v[192:207]
    ds_read_b64_tr_b16 v[100:101], v16 offset:10240
    s_cmp_eq_u32 s97, 0
    s_cbranch_scc1 L_sk_67
    s_waitcnt vmcnt(7)
    v_xor_b32 v15, v22, v4
    v_bitop3_b32 v15, v15, v5, v22 bitop3:0xf6
    v_cmp_ne_u32 vcc, 0, v15
    s_cbranch_vccnz L_retry_cpQ
L_back_cpQ:
L_sk_67:
    v_mfma_f32_32x32x16_bf16 v[208:223], v[108:111], a[140:143], v[208:223]
    ds_read_b64_tr_b16 v[102:103], v16 offset:10752
    v_rcp_f32 v145, v145
    v_rcp_f32 v146, v146
    s_waitcnt lgkmcnt(4)
    v_mfma_f32_32x32x16_bf16 v[192:207], v[112:115], a[144:147], v[192:207]
    ds_read_b64_tr_b16 v[104:105], v16 offset:12288
    s_add_u32 s70, s70, 229376
    s_add_u32 m0, s71, 65536
    s_nop 0
    buffer_load_dwordx4 v8, s[32:35], s70 offen offset:0 lds
    v_mfma_f32_32x32x16_bf16 v[208:223], v[112:115], a[148:151], v[208:223]
    ds_read_b64_tr_b16 v[106:107], v16 offset:12800
    v_rcp_f32 v147, v147
    v_rcp_f32 v148, v148
    v_rcp_f32 v149, v149
    v_mfma_f32_32x32x16_bf16 v[192:207], v[116:119], a[152:155], v[192:207]
    ds_read_b64_tr_b16 v[108:109], v16 offset:14336
    buffer_load_dwordx4 v9, s[32:35], s70 offen offset:1024 lds
    v_rcp_f32 v150, v150
    v_mfma_f32_32x32x16_bf16 v[208:223], v[116:119], a[156:159], v[208:223]
    ds_read_b64_tr_b16 v[110:111], v16 offset:14848
    v_add_u32 v16, 0x4000, v16
    v_rcp_f32 v151, v151
    v_mul_f32 v152, v152, v144
    v_mul_f32 v153, v153, v145
    s_waitcnt lgkmcnt(4)
    v_mfma_f32_32x32x16_bf16 v[192:207], v[96:99], a[160:163], v[192:207]
    s_waitcnt vmcnt(11)
    s_barrier
    ds_read_b64_tr_b16 v[112:113], v16 offset:0
    v_mfma_f32_32x32x16_bf16 v[208:223], v[96:99], a[164:167], v[208:223]
    ds_read_b64_tr_b16 v[114:115], v16 offset:512
    s_add_u32 m0, s71, 67584
    s_nop 0
    buffer_load_dwordx4 v10, s[36:39], s70 offen offset:0 lds
    v_mfma_f32_32x32x16_bf16 v[192:207], v[100:103], a[168:171], v[192:207]
    ds_read_b64_tr_b16 v[116:117], v16 offset:2048
    v_mul_f32 v154, v154, v146
    v_mul_f32 v155, v155, v147
    v_mul_f32 v156, v156, v148
    v_mul_f32 v157, v157, v149
    v_mul_f32 v158, v158, v150
    v_mfma_f32_32x32x16_bf16 v[208:223], v[100:103], a[172:175], v[208:223]
    ds_read_b64_tr_b16 v[118:119], v16 offset:2560
    buffer_load_dwordx4 v11, s[36:39], s70 offen offset:1024 lds
    v_mul_f32 v159, v159, v151
    v_cvt_pk_bf16_f32 v144, v152, v153
    v_cvt_pk_bf16_f32 v145, v154, v155
    s_waitcnt lgkmcnt(4)
    v_mfma_f32_32x32x16_bf16 v[192:207], v[104:107], a[176:179], v[192:207]
    ds_read_b64_tr_b16 v[96:97], v16 offset:4096
    v_cvt_pk_bf16_f32 v146, v156, v157
    v_cvt_pk_bf16_f32 v147, v158, v159
    buffer_store_dwordx4 v[144:147], v2, s[52:55], s76 offen offset:1024 sc1
    v_mul_f32 v160, v56, v160
    v_mfma_f32_32x32x16_bf16 v[208:223], v[104:107], a[180:183], v[208:223]
    ds_read_b64_tr_b16 v[98:99], v16 offset:4608
    v_mul_f32 v161, v56, v161
    v_mul_f32 v162, v56, v162
    v_mul_f32 v163, v56, v163
    v_mul_f32 v164, v56, v164
    v_mul_f32 v165, v56, v165
    v_mfma_f32_32x32x16_bf16 v[192:207], v[108:111], a[184:187], v[192:207]
    ds_read_b64_tr_b16 v[100:101], v16 offset:6144
    v_mul_f32 v166, v56, v166
    v_mul_f32 v167, v56, v167
    v_exp_f32 v160, -v160
    v_exp_f32 v161, -v161
    v_mfma_f32_32x32x16_bf16 v[208:223], v[108:111], a[188:191], v[208:223]
    ds_read_b64_tr_b16 v[102:103], v16 offset:6656
    v_exp_f32 v162, -v162
    v_exp_f32 v163, -v163
    s_waitcnt lgkmcnt(4)
    v_mfma_f32_32x32x16_bf16 v[192:207], v[112:115], a[192:195], v[192:207]
    ds_read_b64_tr_b16 v[104:105], v16 offset:8192
    s_add_u32 s70, s70, 229376
    s_add_u32 m0, s71, 81920
    s_nop 0
    buffer_load_dwordx4 v8, s[32:35], s70 offen offset:0 lds
    v_mfma_f32_32x32x16_bf16 v[208:223], v[112:115], a[196:199], v[208:223]
    ds_read_b64_tr_b16 v[106:107], v16 offset:8704
    v_exp_f32 v164, -v164
    v_exp_f32 v165, -v165
    v_exp_f32 v166, -v166
    v_mfma_f32_32x32x16_bf16 v[192:207], v[116:119], a[200:203], v[192:207]
    ds_read_b64_tr_b16 v[108:109], v16 offset:10240
    buffer_load_dwordx4 v9, s[32:35], s70 offen offset:1024 lds
    v_exp_f32 v167, -v167
    v_mfma_f32_32x32x16_bf16 v[208:223], v[116:119], a[204:207], v[208:223]
    ds_read_b64_tr_b16 v[110:111], v16 offset:10752
    v_fma_f32 v160, v160, v58, v58
    v_fma_f32 v161, v161, v58, v58
    v_fma_f32 v162, v162, v58, v58
    v_fma_f32 v163, v163, v58, v58
    s_waitcnt lgkmcnt(4)
    v_mfma_f32_32x32x16_bf16 v[192:207], v[96:99], a[208:211], v[192:207]
    ds_read_b64_tr_b16 v[112:113], v16 offset:12288
    v_fma_f32 v164, v164, v58, v58
    v_fma_f32 v165, v165, v58, v58
    v_fma_f32 v166, v166, v58, v58
    v_fma_f32 v167, v167, v58, v58
    v_rcp_f32 v160, v160
    v_mfma_f32_32x32x16_bf16 v[208:223], v[96:99], a[212:215], v[208:223]
    ds_read_b64_tr_b16 v[114:115], v16 offset:12800
    s_add_u32 m0, s71, 83968
    s_nop 0
    buffer_load_dwordx4 v10, s[36:39], s70 offen offset:0 lds
    v_rcp_f32 v161, v161
    v_mfma_f32_32x32x16_bf16 v[192:207], v[100:103], a[216:219], v[192:207]
    ds_read_b64_tr_b16 v[116:117], v16 offset:14336
    v_rcp_f32 v162, v162
    v_rcp_f32 v163, v163
    v_mfma_f32_32x32x16_bf16 v[208:223], v[100:103], a[220:223], v[208:223]
    ds_read_b64_tr_b16 v[118:119], v16 offset:14848
    v_add_u32 v16, 0x8000, v120
    v_xor_b32 v17, 32, v16
    buffer_load_dwordx4 v11, s[36:39], s70 offen offset:1024 lds
    s_waitcnt lgkmcnt(4)
    v_mfma_f32_32x32x16_bf16 v[192:207], v[104:107], a[224:227], v[192:207]
    s_waitcnt vmcnt(14)
    s_barrier
    ds_read_b64_tr_b16 v[96:97], v16 offset:0
    v_mfma_f32_32x32x16_bf16 v[208:223], v[104:107], a[228:231], v[208:223]
    ds_read_b64_tr_b16 v[98:99], v16 offset:512
    v_rcp_f32 v164, v164
    v_rcp_f32 v165, v165
    v_rcp_f32 v166, v166
    v_mfma_f32_32x32x16_bf16 v[192:207], v[108:111], a[232:235], v[192:207]
    ds_read_b64_tr_b16 v[100:101], v17 offset:0
    s_add_u32 s70, s70, 229376
    s_mul_i32 s3, s1, 1835008
    s_sub_u32 s70, s70, s3
    s_add_u32 m0, s71, 98304
    v_rcp_f32 v167, v167
    v_mfma_f32_32x32x16_bf16 v[208:223], v[108:111], a[236:239], v[208:223]
    ds_read_b64_tr_b16 v[102:103], v17 offset:512
    buffer_load_dwordx4 v8, s[32:35], s70 offen offset:0 lds
    v_mul_f32 v168, v168, v160
    v_mul_f32 v169, v169, v161
    s_waitcnt lgkmcnt(4)
    v_mfma_f32_32x32x16_bf16 v[192:207], v[112:115], a[240:243], v[192:207]
    ds_read_b64_tr_b16 v[104:105], v16 offset:4096
    v_mul_f32 v170, v170, v162
    v_mul_f32 v171, v171, v163
    v_mul_f32 v172, v172, v164
    v_mul_f32 v173, v173, v165
    v_mul_f32 v174, v174, v166
    v_mfma_f32_32x32x16_bf16 v[208:223], v[112:115], a[244:247], v[208:223]
    ds_read_b64_tr_b16 v[106:107], v16 offset:4608
    buffer_load_dwordx4 v9, s[32:35], s70 offen offset:1024 lds
    v_mul_f32 v175, v175, v167
    v_cvt_pk_bf16_f32 v160, v168, v169
    v_cvt_pk_bf16_f32 v161, v170, v171
    v_mfma_f32_32x32x16_bf16 v[192:207], v[116:119], a[248:251], v[192:207]
    ds_read_b64_tr_b16 v[108:109], v17 offset:4096
    v_cvt_pk_bf16_f32 v162, v172, v173
    v_cvt_pk_bf16_f32 v163, v174, v175
    buffer_store_dwordx4 v[160:163], v2, s[52:55], s76 offen offset:2048 sc1
    v_mul_f32 v176, v57, v176
    v_mfma_f32_32x32x16_bf16 v[208:223], v[116:119], a[252:255], v[208:223]
    ds_read_b64_tr_b16 v[110:111], v17 offset:4608
    v_mul_f32 v177, v57, v177
    v_mul_f32 v178, v57, v178
    v_mul_f32 v179, v57, v179
    v_mul_f32 v180, v57, v180
    s_waitcnt lgkmcnt(4)
    v_mfma_f32_32x32x16_bf16 v[224:239], v[96:99], a[0:3], 0
    ds_read_b64_tr_b16 v[112:113], v16 offset:8192
    v_mul_f32 v181, v57, v181
    v_mul_f32 v182, v57, v182
    v_mul_f32 v183, v57, v183
    v_exp_f32 v176, -v176
    v_mfma_f32_32x32x16_bf16 v[240:255], v[96:99], a[4:7], 0
    ds_read_b64_tr_b16 v[114:115], v16 offset:8704
    v_exp_f32 v177, -v177
    v_exp_f32 v178, -v178
    v_exp_f32 v179, -v179
    v_mfma_f32_32x32x16_bf16 v[128:143], v[100:103], a[0:3], 0
    ds_read_b64_tr_b16 v[116:117], v17 offset:8192
    s_add_u32 m0, s71, 100352
    s_nop 0
    buffer_load_dwordx4 v10, s[36:39], s70 offen offset:0 lds
    v_mfma_f32_32x32x16_bf16 v[144:159], v[100:103], a[4:7], 0
    ds_read_b64_tr_b16 v[118:119], v17 offset:8704
    v_mfma_f32_32x32x16_bf16 v[224:239], v[32:35], v[48:51], v[224:239]
    buffer_load_dwordx4 v11, s[36:39], s70 offen offset:1024 lds
    v_exp_f32 v180, -v180
    v_exp_f32 v181, -v181
    s_waitcnt lgkmcnt(4)
    v_mfma_f32_32x32x16_bf16 v[224:239], v[104:107], a[8:11], v[224:239]
    ds_read_b64_tr_b16 v[96:97], v16 offset:12288
    v_exp_f32 v182, -v182
    v_exp_f32 v183, -v183
    v_fma_f32 v176, v176, v59, v59
    v_mfma_f32_32x32x16_bf16 v[240:255], v[104:107], a[12:15], v[240:255]
    ds_read_b64_tr_b16 v[98:99], v16 offset:12800
    v_add_u32 v16, 0x4000, v16
    v_fma_f32 v177, v177, v59, v59
    v_fma_f32 v178, v178, v59, v59
    v_fma_f32 v179, v179, v59, v59
    v_fma_f32 v180, v180, v59, v59
    v_mfma_f32_32x32x16_bf16 v[128:143], v[108:111], a[8:11], v[128:143]
    ds_read_b64_tr_b16 v[100:101], v17 offset:12288
    s_add_u32 s70, s70, 229376
    s_add_u32 m0, s71, 114688
    s_nop 0
    buffer_load_dwordx4 v8, s[32:35], s70 offen offset:0 lds
    v_mfma_f32_32x32x16_bf16 v[240:255], v[32:35], v[52:55], v[240:255]
    v_fma_f32 v181, v181, v59, v59
    v_fma_f32 v182, v182, v59, v59
    v_fma_f32 v183, v183, v59, v59
    v_rcp_f32 v176, v176
    v_rcp_f32 v177, v177
    v_mfma_f32_32x32x16_bf16 v[144:159], v[108:111], a[12:15], v[144:159]
    ds_read_b64_tr_b16 v[102:103], v17 offset:12800
    v_add_u32 v17, 0x4000, v17
    v_rcp_f32 v178, v178
    v_rcp_f32 v179, v179
    s_waitcnt lgkmcnt(4)
    v_mfma_f32_32x32x16_bf16 v[224:239], v[112:115], a[16:19], v[224:239]
    s_waitcnt vmcnt(15)
    s_barrier
    ds_read_b64_tr_b16 v[104:105], v16 offset:0
    v_mfma_f32_32x32x16_bf16 v[240:255], v[112:115], a[20:23], v[240:255]
    ds_read_b64_tr_b16 v[106:107], v16 offset:512
    buffer_load_dwordx4 v9, s[32:35], s70 offen offset:1024 lds
    v_mfma_f32_32x32x16_bf16 v[128:143], v[36:39], v[48:51], v[128:143]
    v_rcp_f32 v180, v180
    v_rcp_f32 v181, v181
    v_rcp_f32 v182, v182
    v_mfma_f32_32x32x16_bf16 v[128:143], v[116:119], a[16:19], v[128:143]
    ds_read_b64_tr_b16 v[108:109], v17 offset:0
    v_rcp_f32 v183, v183
    v_mul_f32 v184, v184, v176
    v_mul_f32 v185, v185, v177
    v_mul_f32 v186, v186, v178
    v_mfma_f32_32x32x16_bf16 v[144:159], v[116:119], a[20:23], v[144:159]
    ds_read_b64_tr_b16 v[110:111], v17 offset:512
    s_add_u32 m0, s71, 116736
    s_nop 0
    buffer_load_dwordx4 v10, s[36:39], s70 offen offset:0 lds
    v_mul_f32 v187, v187, v179
    s_waitcnt lgkmcnt(4)
    v_mfma_f32_32x32x16_bf16 v[224:239], v[96:99], a[24:27], v[224:239]
    ds_read_b64_tr_b16 v[112:113], v16 offset:4096
    v_mfma_f32_32x32x16_bf16 v[144:159], v[36:39], v[52:55], v[144:159]
    v_mul_f32 v188, v188, v180
    v_mul_f32 v189, v189, v181
    v_mul_f32 v190, v190, v182
    v_mul_f32 v191, v191, v183
    v_cvt_pk_bf16_f32 v176, v184, v185
    v_cvt_pk_bf16_f32 v177, v186, v187
    v_mfma_f32_32x32x16_bf16 v[240:255], v[96:99], a[28:31], v[240:255]
    ds_read_b64_tr_b16 v[114:115], v16 offset:4608
    buffer_load_dwordx4 v11, s[36:39], s70 offen offset:1024 lds
    v_cvt_pk_bf16_f32 v178, v188, v189
    v_cvt_pk_bf16_f32 v179, v190, v191
    buffer_store_dwordx4 v[176:179], v2, s[52:55], s76 offen offset:3072 sc1
    v_mfma_f32_32x32x16_bf16 v[128:143], v[100:103], a[24:27], v[128:143]
    ds_read_b64_tr_b16 v[116:117], v17 offset:4096
    v_and_b32 v19, 15, v1
    v_lshlrev_b32 v19, 3, v19
    v_mfma_f32_32x32x16_bf16 v[144:159], v[100:103], a[28:31], v[144:159]
    ds_read_b64_tr_b16 v[118:119], v17 offset:4608
    s_waitcnt lgkmcnt(4)
    v_mfma_f32_32x32x16_bf16 v[224:239], v[104:107], a[32:35], v[224:239]
    ds_read_b64_tr_b16 v[96:97], v16 offset:8192
    v_mfma_f32_32x32x16_bf16 v[240:255], v[104:107], a[36:39], v[240:255]
    ds_read_b64_tr_b16 v[98:99], v16 offset:8704
    v_mul_f32 v192, v56, v192
    v_mul_f32 v193, v56, v193
    v_mul_f32 v194, v56, v194
    v_mul_f32 v195, v56, v195
    v_exp_f32 v40, v192 clamp
    v_mfma_f32_32x32x16_bf16 v[128:143], v[108:111], a[32:35], v[128:143]
    ds_read_b64_tr_b16 v[100:101], v17 offset:8192
    s_add_u32 s70, s70, 229376
    s_add_u32 m0, s71, 131072
    s_nop 0
    buffer_load_dwordx4 v8, s[32:35], s70 offen offset:0 lds
    v_mfma_f32_32x32x16_bf16 v[144:159], v[108:111], a[36:39], v[144:159]
    ds_read_b64_tr_b16 v[102:103], v17 offset:8704
    v_exp_f32 v41, v193 clamp
    v_exp_f32 v42, v194 clamp
    v_exp_f32 v43, v195 clamp
    s_waitcnt lgkmcnt(4)
    v_mfma_f32_32x32x16_bf16 v[224:239], v[112:115], a[40:43], v[224:239]
    ds_read_b64_tr_b16 v[104:105], v16 offset:12288
    buffer_load_dwordx4 v9, s[32:35], s70 offen offset:1024 lds
    v_max_f32 v192, 0x35c1a2a0, v192
    v_max_f32 v193, 0x35c1a2a0, v193
    v_mfma_f32_32x32x16_bf16 v[240:255], v[112:115], a[44:47], v[240:255]
    ds_read_b64_tr_b16 v[106:107], v16 offset:12800
    v_add_u32 v16, 0x4000, v16
    v_max_f32 v194, 0x35c1a2a0, v194
    v_max_f32 v195, 0x35c1a2a0, v195
    v_fmac_f32 v40, 0x3f317218, v192
    v_fmac_f32 v41, 0x3f317218, v193
    v_mfma_f32_32x32x16_bf16 v[128:143], v[116:119], a[40:43], v[128:143]
    ds_read_b64_tr_b16 v[108:109], v17 offset:12288
    v_fmac_f32 v42, 0x3f317218, v194
    v_fmac_f32 v43, 0x3f317218, v195
    v_cvt_pk_bf16_f32 v192, v40, v41
    v_cvt_pk_bf16_f32 v193, v42, v43
    v_mul_f32 v196, v56, v196
    v_mfma_f32_32x32x16_bf16 v[144:159], v[116:119], a[44:47], v[144:159]
    ds_read_b64_tr_b16 v[110:111], v17 offset:12800
    v_add_u32 v17, 0x4000, v17
    s_add_u32 m0, s71, 133120
    s_nop 0
    buffer_load_dwordx4 v10, s[36:39], s70 offen offset:0 lds
    s_waitcnt lgkmcnt(4)
    v_mfma_f32_32x32x16_bf16 v[224:239], v[96:99], a[48:51], v[224:239]
    s_waitcnt vmcnt(18)
    s_barrier
    ds_read_b64_tr_b16 v[112:113], v16 offset:0
    v_mfma_f32_32x32x16_bf16 v[240:255], v[96:99], a[52:55], v[240:255]
    ds_read_b64_tr_b16 v[114:115], v16 offset:512
    buffer_load_dwordx4 v11, s[36:39], s70 offen offset:1024 lds
    v_mul_f32 v197, v56, v197
    v_mul_f32 v198, v56, v198
    v_mfma_f32_32x32x16_bf16 v[128:143], v[100:103], a[48:51], v[128:143]
    ds_read_b64_tr_b16 v[116:117], v17 offset:0
    v_mul_f32 v199, v56, v199
    v_exp_f32 v40, v196 clamp
    v_exp_f32 v41, v197 clamp
    v_mfma_f32_32x32x16_bf16 v[144:159], v[100:103], a[52:55], v[144:159]
    ds_read_b64_tr_b16 v[118:119], v17 offset:512
    v_exp_f32 v42, v198 clamp
    v_exp_f32 v43, v199 clamp
    s_waitcnt lgkmcnt(4)
    v_mfma_f32_32x32x16_bf16 v[224:239], v[104:107], a[56:59], v[224:239]
    ds_read_b64_tr_b16 v[96:97], v16 offset:4096
    s_add_u32 s70, s70, 229376
    s_add_u32 m0, s71, 0
    s_nop 0
    buffer_load_dwordx4 v8, s[32:35], s70 offen offset:0 lds
    v_max_f32 v196, 0x35c1a2a0, v196
    v_mfma_f32_32x32x16_bf16 v[240:255], v[104:107], a[60:63], v[240:255]
    ds_read_b64_tr_b16 v[98:99], v16 offset:4608
    v_max_f32 v197, 0x35c1a2a0, v197
    v_max_f32 v198, 0x35c1a2a0, v198
    v_max_f32 v199, 0x35c1a2a0, v199
    v_fmac_f32 v40, 0x3f317218, v196
    v_fmac_f32 v41, 0x3f317218, v197
    v_mfma_f32_32x32x16_bf16 v[128:143], v[108:111], a[56:59], v[128:143]
    ds_read_b64_tr_b16 v[100:101], v17 offset:4096
    buffer_load_dwordx4 v9, s[32:35], s70 offen offset:1024 lds
    v_fmac_f32 v42, 0x3f317218, v198
    v_fmac_f32 v43, 0x3f317218, v199
    v_cvt_pk_bf16_f32 v194, v40, v41
    v_mfma_f32_32x32x16_bf16 v[144:159], v[108:111], a[60:63], v[144:159]
    ds_read_b64_tr_b16 v[102:103], v17 offset:4608
    v_cvt_pk_bf16_f32 v195, v42, v43
    v_mul_f32 v200, v56, v200
    v_mul_f32 v201, v56, v201
    v_mul_f32 v202, v56, v202
    s_waitcnt lgkmcnt(4)
    v_mfma_f32_32x32x16_bf16 v[224:239], v[112:115], a[64:67], v[224:239]
    ds_read_b64_tr_b16 v[104:105], v16 offset:8192
    v_mul_f32 v203, v56, v203
    v_exp_f32 v40, v200 clamp
    v_exp_f32 v41, v201 clamp
    v_mfma_f32_32x32x16_bf16 v[240:255], v[112:115], a[68:71], v[240:255]
    ds_read_b64_tr_b16 v[106:107], v16 offset:8704
    s_add_u32 m0, s71, 2048
    s_nop 0
    buffer_load_dwordx4 v10, s[36:39], s70 offen offset:0 lds
    v_exp_f32 v42, v202 clamp
    v_mfma_f32_32x32x16_bf16 v[128:143], v[116:119], a[64:67], v[128:143]
    ds_read_b64_tr_b16 v[108:109], v17 offset:8192
    v_exp_f32 v43, v203 clamp
    v_max_f32 v200, 0x35c1a2a0, v200
    v_max_f32 v201, 0x35c1a2a0, v201
    v_max_f32 v202, 0x35c1a2a0, v202
    v_mfma_f32_32x32x16_bf16 v[144:159], v[116:119], a[68:71], v[144:159]
    ds_read_b64_tr_b16 v[110:111], v17 offset:8704
    buffer_load_dwordx4 v11, s[36:39], s70 offen offset:1024 lds
    v_max_f32 v203, 0x35c1a2a0, v203
    v_fmac_f32 v40, 0x3f317218, v200
    s_waitcnt lgkmcnt(4)
    v_mfma_f32_32x32x16_bf16 v[224:239], v[96:99], a[72:75], v[224:239]
    ds_read_b64_tr_b16 v[112:113], v16 offset:12288
    v_fmac_f32 v41, 0x3f317218, v201
    v_fmac_f32 v42, 0x3f317218, v202
    v_fmac_f32 v43, 0x3f317218, v203
    v_cvt_pk_bf16_f32 v196, v40, v41
    v_cvt_pk_bf16_f32 v197, v42, v43
    v_mfma_f32_32x32x16_bf16 v[240:255], v[96:99], a[76:79], v[240:255]
    ds_read_b64_tr_b16 v[114:115], v16 offset:12800
    v_add_u32 v16, 0x4000, v16
    v_mul_f32 v204, v56, v204
    v_mul_f32 v205, v56, v205
    v_mul_f32 v206, v56, v206
    v_mul_f32 v207, v56, v207
    v_mfma_f32_32x32x16_bf16 v[128:143], v[100:103], a[72:75], v[128:143]
    ds_read_b64_tr_b16 v[116:117], v17 offset:12288
    s_add_u32 s70, s70, 229376
    v_mov_b32 v4, v125
    v_add_u32 v5, s14, v4
    v_add_u32 v6, s14, v5
    v_add_u32 v7, s14, v6
    v_exp_f32 v40, v204 clamp
    v_mfma_f32_32x32x16_bf16 v[144:159], v[100:103], a[76:79], v[144:159]
    ds_read_b64_tr_b16 v[118:119], v17 offset:12800
    v_add_u32 v17, 0x4000, v17
    s_add_u32 m0, s71, 16384
    s_nop 0
    buffer_load_dwordx4 v4, s[56:59], s87 offen offset:0 sc1 lds
    s_waitcnt lgkmcnt(4)
    v_mfma_f32_32x32x16_bf16 v[224:239], v[104:107], a[80:83], v[224:239]
    s_waitcnt vmcnt(19)
    s_barrier
    ds_read_b64_tr_b16 v[96:97], v16 offset:0
    v_mfma_f32_32x32x16_bf16 v[240:255], v[104:107], a[84:87], v[240:255]
    ds_read_b64_tr_b16 v[98:99], v16 offset:512
    buffer_load_dwordx4 v5, s[56:59], s87 offen offset:1024 sc1 lds
    v_exp_f32 v41, v205 clamp
    v_mfma_f32_32x32x16_bf16 v[128:143], v[108:111], a[80:83], v[128:143]
    ds_read_b64_tr_b16 v[100:101], v17 offset:0
    v_exp_f32 v42, v206 clamp
    v_exp_f32 v43, v207 clamp
    v_mfma_f32_32x32x16_bf16 v[144:159], v[108:111], a[84:87], v[144:159]
    ds_read_b64_tr_b16 v[102:103], v17 offset:512
    v_max_f32 v204, 0x35c1a2a0, v204
    v_max_f32 v205, 0x35c1a2a0, v205
    v_max_f32 v206, 0x35c1a2a0, v206
    v_max_f32 v207, 0x35c1a2a0, v207
    s_waitcnt lgkmcnt(4)
    v_mfma_f32_32x32x16_bf16 v[224:239], v[112:115], a[88:91], v[224:239]
    ds_read_b64_tr_b16 v[104:105], v16 offset:4096
    buffer_load_dwordx4 v6, s[56:59], s87 offen offset:2048 sc1 lds
    v_fmac_f32 v40, 0x3f317218, v204
    v_fmac_f32 v41, 0x3f317218, v205
    v_fmac_f32 v42, 0x3f317218, v206
    v_mfma_f32_32x32x16_bf16 v[240:255], v[112:115], a[92:95], v[240:255]
    ds_read_b64_tr_b16 v[106:107], v16 offset:4608
    v_fmac_f32 v43, 0x3f317218, v207
    v_cvt_pk_bf16_f32 v198, v40, v41
    v_cvt_pk_bf16_f32 v199, v42, v43
    v_mul_f32 v208, v57, v208
    v_mul_f32 v209, v57, v209
    v_mfma_f32_32x32x16_bf16 v[128:143], v[116:119], a[88:91], v[128:143]
    ds_read_b64_tr_b16 v[108:109], v17 offset:4096
    buffer_load_dwordx4 v7, s[56:59], s87 offen offset:3072 sc1 lds
    v_mul_f32 v210, v57, v210
    v_mul_f32 v211, v57, v211
    v_exp_f32 v40, v208 clamp
    v_mfma_f32_32x32x16_bf16 v[144:159], v[116:119], a[92:95], v[144:159]
    ds_read_b64_tr_b16 v[110:111], v17 offset:4608
    v_exp_f32 v41, v209 clamp
    v_exp_f32 v42, v210 clamp
    s_waitcnt lgkmcnt(4)
    v_mfma_f32_32x32x16_bf16 v[224:239], v[96:99], a[96:99], v[224:239]
    ds_read_b64_tr_b16 v[112:113], v16 offset:8192
    v_exp_f32 v43, v211 clamp
    v_max_f32 v208, 0x35c1a2a0, v208
    v_max_f32 v209, 0x35c1a2a0, v209
    v_max_f32 v210, 0x35c1a2a0, v210
    v_mfma_f32_32x32x16_bf16 v[240:255], v[96:99], a[100:103], v[240:255]
    ds_read_b64_tr_b16 v[114:115], v16 offset:8704
    s_add_u32 s87, s87, s7
    s_add_u32 m0, s71, 32768
    s_nop 0
    buffer_load_dwordx4 v4, s[56:59], s87 offen offset:0 sc1 lds
    v_mfma_f32_32x32x16_bf16 v[128:143], v[100:103], a[96:99], v[128:143]
    ds_read_b64_tr_b16 v[116:117], v17 offset:8192
    v_max_f32 v211, 0x35c1a2a0, v211
    v_fmac_f32 v40, 0x3f317218, v208
    v_fmac_f32 v41, 0x3f317218, v209
    v_fmac_f32 v42, 0x3f317218, v210
    v_fmac_f32 v43, 0x3f317218, v211
    v_mfma_f32_32x32x16_bf16 v[144:159], v[100:103], a[100:103], v[144:159]
    ds_read_b64_tr_b16 v[118:119], v17 offset:8704
    buffer_load_dwordx4 v5, s[56:59], s87 offen offset:1024 sc1 lds
    v_cvt_pk_bf16_f32 v208, v40, v41
    v_cvt_pk_bf16_f32 v209, v42, v43
    v_mul_f32 v212, v57, v212
    s_waitcnt lgkmcnt(4)
    v_mfma_f32_32x32x16_bf16 v[224:239], v[104:107], a[104:107], v[224:239]
    ds_read_b64_tr_b16 v[96:97], v16 offset:12288
    v_mul_f32 v213, v57, v213
    v_mul_f32 v214, v57, v214
    v_mul_f32 v215, v57, v215
    v_exp_f32 v40, v212 clamp
    v_mfma_f32_32x32x16_bf16 v[240:255], v[104:107], a[108:111], v[240:255]
    ds_read_b64_tr_b16 v[98:99], v16 offset:12800
    v_add_u32 v16, 0x4000, v16
    v_exp_f32 v41, v213 clamp
    v_exp_f32 v42, v214 clamp
    v_mfma_f32_32x32x16_bf16 v[128:143], v[108:111], a[104:107], v[128:143]
    ds_read_b64_tr_b16 v[100:101], v17 offset:12288
    buffer_load_dwordx4 v6, s[56:59], s87 offen offset:2048 sc1 lds
    v_exp_f32 v43, v215 clamp
    v_max_f32 v212, 0x35c1a2a0, v212
    v_mfma_f32_32x32x16_bf16 v[144:159], v[108:111], a[108:111], v[144:159]
    ds_read_b64_tr_b16 v[102:103], v17 offset:12800
    v_add_u32 v17, 0x4000, v17
    v_max_f32 v213, 0x35c1a2a0, v213
    v_max_f32 v214, 0x35c1a2a0, v214
    v_max_f32 v215, 0x35c1a2a0, v215
    s_waitcnt lgkmcnt(4)
    v_mfma_f32_32x32x16_bf16 v[224:239], v[112:115], a[112:115], v[224:239]
    s_waitcnt vmcnt(20)
    s_barrier
    ds_read_b64_tr_b16 v[104:105], v16 offset:0
    v_mfma_f32_32x32x16_bf16 v[240:255], v[112:115], a[116:119], v[240:255]
    ds_read_b64_tr_b16 v[106:107], v16 offset:512
    buffer_load_dwordx4 v7, s[56:59], s87 offen offset:3072 sc1 lds
    v_fmac_f32 v40, 0x3f317218, v212
    v_fmac_f32 v41, 0x3f317218, v213
    v_fmac_f32 v42, 0x3f317218, v214
    v_mfma_f32_32x32x16_bf16 v[128:143], v[116:119], a[112:115], v[128:143]
    ds_read_b64_tr_b16 v[108:109], v17 offset:0
    v_fmac_f32 v43, 0x3f317218, v215
    v_cvt_pk_bf16_f32 v210, v40, v41
    v_cvt_pk_bf16_f32 v211, v42, v43
    v_mul_f32 v216, v57, v216
    v_mul_f32 v217, v57, v217
    v_mfma_f32_32x32x16_bf16 v[144:159], v[116:119], a[116:119], v[144:159]
    ds_read_b64_tr_b16 v[110:111], v17 offset:512
    s_add_u32 s87, s87, s7
    s_add_u32 m0, s71, 49152
    s_nop 0
    buffer_load_dwordx4 v4, s[56:59], s87 offen offset:0 sc1 lds
    s_waitcnt lgkmcnt(4)
    v_mfma_f32_32x32x16_bf16 v[224:239], v[96:99], a[120:123], v[224:239]
    ds_read_b64_tr_b16 v[112:113], v16 offset:4096
    v_mul_f32 v218, v57, v218
    v_mul_f32 v219, v57, v219
    v_exp_f32 v40, v216 clamp
    v_exp_f32 v41, v217 clamp
    v_mfma_f32_32x32x16_bf16 v[240:255], v[96:99], a[124:127], v[240:255]
    ds_read_b64_tr_b16 v[114:115], v16 offset:4608
    v_exp_f32 v42, v218 clamp
    v_exp_f32 v43, v219 clamp
    v_mfma_f32_32x32x16_bf16 v[128:143], v[100:103], a[120:123], v[128:143]
    ds_read_b64_tr_b16 v[116:117], v17 offset:4096
    buffer_load_dwordx4 v5, s[56:59], s87 offen offset:1024 sc1 lds
    v_max_f32 v216, 0x35c1a2a0, v216
    v_max_f32 v217, 0x35c1a2a0, v217
    v_max_f32 v218, 0x35c1a2a0, v218
    v_mfma_f32_32x32x16_bf16 v[144:159], v[100:103], a[124:127], v[144:159]
    ds_read_b64_tr_b16 v[118:119], v17 offset:4608
    v_max_f32 v219, 0x35c1a2a0, v219
    v_fmac_f32 v40, 0x3f317218, v216
    v_fmac_f32 v41, 0x3f317218, v217
    v_fmac_f32 v42, 0x3f317218, v218
    s_waitcnt lgkmcnt(4)
    v_mfma_f32_32x32x16_bf16 v[224:239], v[104:107], a[128:131], v[224:239]
    ds_read_b64_tr_b16 v[96:97], v16 offset:8192
    buffer_load_dwordx4 v6, s[56:59], s87 offen offset:2048 sc1 lds
    v_fmac_f32 v43, 0x3f317218, v219
    v_cvt_pk_bf16_f32 v212, v40, v41
    v_cvt_pk_bf16_f32 v213, v42, v43
    v_mfma_f32_32x32x16_bf16 v[240:255], v[104:107], a[132:135], v[240:255]
    ds_read_b64_tr_b16 v[98:99], v16 offset:8704
    v_mul_f32 v220, v57, v220
    v_mul_f32 v221, v57, v221
    v_mul_f32 v222, v57, v222
    v_mul_f32 v223, v57, v223
    v_exp_f32 v40, v220 clamp
    v_mfma_f32_32x32x16_bf16 v[128:143], v[108:111], a[128:131], v[128:143]
    ds_read_b64_tr_b16 v[100:101], v17 offset:8192
    v_exp_f32 v41, v221 clamp
    v_exp_f32 v42, v222 clamp
    v_mfma_f32_32x32x16_bf16 v[144:159], v[108:111], a[132:135], v[144:159]
    ds_read_b64_tr_b16 v[102:103], v17 offset:8704
    buffer_load_dwordx4 v7, s[56:59], s87 offen offset:3072 sc1 lds
    v_exp_f32 v43, v223 clamp
    v_max_f32 v220, 0x35c1a2a0, v220
    s_waitcnt lgkmcnt(4)
    v_mfma_f32_32x32x16_bf16 v[224:239], v[112:115], a[136:139], v[224:239]
    ds_read_b64_tr_b16 v[104:105], v16 offset:12288
    v_max_f32 v221, 0x35c1a2a0, v221
    v_max_f32 v222, 0x35c1a2a0, v222
    v_max_f32 v223, 0x35c1a2a0, v223
    v_fmac_f32 v40, 0x3f317218, v220
    v_fmac_f32 v41, 0x3f317218, v221
    v_mfma_f32_32x32x16_bf16 v[240:255], v[112:115], a[140:143], v[240:255]
    ds_read_b64_tr_b16 v[106:107], v16 offset:12800
    v_add_u32 v16, 0x4000, v16
    s_add_u32 s87, s87, s7
    s_add_u32 m0, s71, 65536
    s_nop 0
    buffer_load_dwordx4 v4, s[56:59], s87 offen offset:0 sc1 lds
    v_mfma_f32_32x32x16_bf16 v[128:143], v[116:119], a[136:139], v[128:143]
    ds_read_b64_tr_b16 v[108:109], v17 offset:12288
    v_fmac_f32 v42, 0x3f317218, v222
    v_fmac_f32 v43, 0x3f317218, v223
    v_cvt_pk_bf16_f32 v214, v40, v41
    v_cvt_pk_bf16_f32 v215, v42, v43
    v_mfma_f32_32x32x16_bf16 v[144:159], v[116:119], a[140:143], v[144:159]
    ds_read_b64_tr_b16 v[110:111], v17 offset:12800
    v_add_u32 v17, 0x4000, v17
    s_waitcnt lgkmcnt(4)
    v_mfma_f32_32x32x16_bf16 v[224:239], v[96:99], a[144:147], v[224:239]
    s_waitcnt vmcnt(22)
    s_barrier
    ds_read_b64_tr_b16 v[112:113], v16 offset:0
    v_mfma_f32_32x32x16_bf16 v[240:255], v[96:99], a[148:151], v[240:255]
    ds_read_b64_tr_b16 v[114:115], v16 offset:512
    buffer_load_dwordx4 v5, s[56:59], s87 offen offset:1024 sc1 lds
    v_mfma_f32_32x32x16_bf16 v[128:143], v[100:103], a[144:147], v[128:143]
    ds_read_b64_tr_b16 v[116:117], v17 offset:0
    v_mfma_f32_32x32x16_bf16 v[144:159], v[100:103], a[148:151], v[144:159]
    ds_read_b64_tr_b16 v[118:119], v17 offset:512
    buffer_load_dwordx4 v6, s[56:59], s87 offen offset:2048 sc1 lds
    s_waitcnt lgkmcnt(4)
    v_mfma_f32_32x32x16_bf16 v[224:239], v[104:107], a[152:155], v[224:239]
    ds_read_b64_tr_b16 v[96:97], v16 offset:4096
    v_mfma_f32_32x32x16_bf16 v[240:255], v[104:107], a[156:159], v[240:255]
    ds_read_b64_tr_b16 v[98:99], v16 offset:4608
    v_mfma_f32_32x32x16_bf16 v[128:143], v[108:111], a[152:155], v[128:143]
    ds_read_b64_tr_b16 v[100:101], v17 offset:4096
    buffer_load_dwordx4 v7, s[56:59], s87 offen offset:3072 sc1 lds
    v_mfma_f32_32x32x16_bf16 v[144:159], v[108:111], a[156:159], v[144:159]
    ds_read_b64_tr_b16 v[102:103], v17 offset:4608
    s_waitcnt lgkmcnt(4)
    v_mfma_f32_32x32x16_bf16 v[224:239], v[112:115], a[160:163], v[224:239]
    ds_read_b64_tr_b16 v[104:105], v16 offset:8192
    s_add_u32 s87, s87, s7
    s_add_u32 m0, s71, 81920
    s_nop 0
    buffer_load_dwordx4 v4, s[56:59], s87 offen offset:0 sc1 lds
    v_mfma_f32_32x32x16_bf16 v[240:255], v[112:115], a[164:167], v[240:255]
    ds_read_b64_tr_b16 v[106:107], v16 offset:8704
    v_mfma_f32_32x32x16_bf16 v[128:143], v[116:119], a[160:163], v[128:143]
    ds_read_b64_tr_b16 v[108:109], v17 offset:8192
    v_mfma_f32_32x32x16_bf16 v[144:159], v[116:119], a[164:167], v[144:159]
    ds_read_b64_tr_b16 v[110:111], v17 offset:8704
    buffer_load_dwordx4 v5, s[56:59], s87 offen offset:1024 sc1 lds
    s_waitcnt lgkmcnt(4)
    v_mfma_f32_32x32x16_bf16 v[224:239], v[96:99], a[168:171], v[224:239]
    ds_read_b64_tr_b16 v[112:113], v16 offset:12288
    v_mfma_f32_32x32x16_bf16 v[240:255], v[96:99], a[172:175], v[240:255]
    ds_read_b64_tr_b16 v[114:115], v16 offset:12800
    v_add_u32 v16, 0x4000, v16
    buffer_load_dwordx4 v6, s[56:59], s87 offen offset:2048 sc1 lds
    v_mfma_f32_32x32x16_bf16 v[128:143], v[100:103], a[168:171], v[128:143]
    ds_read_b64_tr_b16 v[116:117], v17 offset:12288
    v_mfma_f32_32x32x16_bf16 v[144:159], v[100:103], a[172:175], v[144:159]
    ds_read_b64_tr_b16 v[118:119], v17 offset:12800
    v_add_u32 v17, 0x4000, v17
    s_waitcnt lgkmcnt(4)
    v_mfma_f32_32x32x16_bf16 v[224:239], v[104:107], a[176:179], v[224:239]
    s_waitcnt vmcnt(23)
    s_barrier
    ds_read_b64_tr_b16 v[96:97], v16 offset:0
    v_mfma_f32_32x32x16_bf16 v[240:255], v[104:107], a[180:183], v[240:255]
    ds_read_b64_tr_b16 v[98:99], v16 offset:512
    buffer_load_dwordx4 v7, s[56:59], s87 offen offset:3072 sc1 lds
    v_mfma_f32_32x32x16_bf16 v[128:143], v[108:111], a[176:179], v[128:143]
    ds_read_b64_tr_b16 v[100:101], v17 offset:0
    v_mfma_f32_32x32x16_bf16 v[144:159], v[108:111], a[180:183], v[144:159]
    ds_read_b64_tr_b16 v[102:103], v17 offset:512
    s_add_u32 s87, s87, s7
    s_add_u32 m0, s71, 98304
    s_nop 0
    buffer_load_dwordx4 v4, s[56:59], s87 offen offset:0 sc1 lds
    s_waitcnt lgkmcnt(4)
    v_mfma_f32_32x32x16_bf16 v[224:239], v[112:115], a[184:187], v[224:239]
    ds_read_b64_tr_b16 v[104:105], v16 offset:4096
    v_mfma_f32_32x32x16_bf16 v[240:255], v[112:115], a[188:191], v[240:255]
    ds_read_b64_tr_b16 v[106:107], v16 offset:4608
    v_mfma_f32_32x32x16_bf16 v[128:143], v[116:119], a[184:187], v[128:143]
    ds_read_b64_tr_b16 v[108:109], v17 offset:4096
    buffer_load_dwordx4 v5, s[56:59], s87 offen offset:1024 sc1 lds
    v_mfma_f32_32x32x16_bf16 v[144:159], v[116:119], a[188:191], v[144:159]
    ds_read_b64_tr_b16 v[110:111], v17 offset:4608
    s_waitcnt lgkmcnt(4)
    v_mfma_f32_32x32x16_bf16 v[224:239], v[96:99], a[192:195], v[224:239]
    ds_read_b64_tr_b16 v[112:113], v16 offset:8192
    buffer_load_dwordx4 v6, s[56:59], s87 offen offset:2048 sc1 lds
    v_mfma_f32_32x32x16_bf16 v[240:255], v[96:99], a[196:199], v[240:255]
    ds_read_b64_tr_b16 v[114:115], v16 offset:8704
    buffer_load_dwordx2 v[46:47], v19, s[48:51], s92 offen sc1
    v_mfma_f32_32x32x16_bf16 v[128:143], v[100:103], a[192:195], v[128:143]
    ds_read_b64_tr_b16 v[116:117], v17 offset:8192
    v_mfma_f32_32x32x16_bf16 v[144:159], v[100:103], a[196:199], v[144:159]
    ds_read_b64_tr_b16 v[118:119], v17 offset:8704
    s_waitcnt lgkmcnt(4)
    v_mfma_f32_32x32x16_bf16 v[224:239], v[104:107], a[200:203], v[224:239]
    ds_read_b64_tr_b16 v[96:97], v16 offset:12288
    v_mfma_f32_32x32x16_bf16 v[240:255], v[104:107], a[204:207], v[240:255]
    ds_read_b64_tr_b16 v[98:99], v16 offset:12800
    v_add_u32 v16, 0xfffe0000, v16
    buffer_load_dwordx4 v7, s[56:59], s87 offen offset:3072 sc1 lds
    v_mfma_f32_32x32x16_bf16 v[128:143], v[108:111], a[200:203], v[128:143]
    ds_read_b64_tr_b16 v[100:101], v17 offset:12288
    v_mfma_f32_32x32x16_bf16 v[144:159], v[108:111], a[204:207], v[144:159]
    ds_read_b64_tr_b16 v[102:103], v17 offset:12800
    v_add_u32 v17, 0xfffe0000, v17
    s_add_u32 s87, s87, s7
    s_waitcnt lgkmcnt(4)
    v_mfma_f32_32x32x16_bf16 v[224:239], v[112:115], a[208:211], v[224:239]
    s_waitcnt vmcnt(25)
    s_barrier
    ds_read_b64_tr_b16 v[104:105], v16 offset:0
    v_mfma_f32_32x32x16_bf16 v[240:255], v[112:115], a[212:215], v[240:255]
    ds_read_b64_tr_b16 v[106:107], v16 offset:512
    s_add_u32 m0, s71, 114688
    s_nop 0
    buffer_load_dwordx4 v4, s[56:59], s87 offen offset:0 sc1 lds
    v_mfma_f32_32x32x16_bf16 v[128:143], v[116:119], a[208:211], v[128:143]
    ds_read_b64_tr_b16 v[108:109], v17 offset:0
    v_mfma_f32_32x32x16_bf16 v[144:159], v[116:119], a[212:215], v[144:159]
    ds_read_b64_tr_b16 v[110:111], v17 offset:512
    buffer_load_dwordx4 v5, s[56:59], s87 offen offset:1024 sc1 lds
    s_waitcnt lgkmcnt(4)
    v_mfma_f32_32x32x16_bf16 v[224:239], v[96:99], a[216:219], v[224:239]
    ds_read_b64_tr_b16 v[112:113], v16 offset:4096
    v_mfma_f32_32x32x16_bf16 v[240:255], v[96:99], a[220:223], v[240:255]
    ds_read_b64_tr_b16 v[114:115], v16 offset:4608
    v_mfma_f32_32x32x16_bf16 v[128:143], v[100:103], a[216:219], v[128:143]
    ds_read_b64_tr_b16 v[116:117], v17 offset:4096
    buffer_load_dwordx4 v6, s[56:59], s87 offen offset:2048 sc1 lds
    v_mfma_f32_32x32x16_bf16 v[144:159], v[100:103], a[220:223], v[144:159]
    ds_read_b64_tr_b16 v[118:119], v17 offset:4608
    s_waitcnt lgkmcnt(4)
    v_mfma_f32_32x32x16_bf16 v[224:239], v[104:107], a[224:227], v[224:239]
    ds_read_b64_tr_b16 v[96:97], v16 offset:8192
    buffer_load_dwordx4 v7, s[56:59], s87 offen offset:3072 sc1 lds
    v_mfma_f32_32x32x16_bf16 v[240:255], v[104:107], a[228:231], v[240:255]
    ds_read_b64_tr_b16 v[98:99], v16 offset:8704
    s_waitcnt vmcnt(5)
    v_xor_b32 v15, s65, v46
    v_bitop3_b32 v15, v15, v47, s66 bitop3:0xf6
    v_cmp_ne_u32 vcc, 0, v15
    s_cbranch_vccnz L_retry_kvf
L_back_kvf:
    v_and_b32 v19, 31, v1
    v_mfma_f32_32x32x16_bf16 v[128:143], v[108:111], a[224:227], v[128:143]
    ds_read_b64_tr_b16 v[100:101], v17 offset:8192
    v_lshlrev_b32 v19, 4, v19
    v_lshrrev_b32 v20, 5, v1
    v_mad_u32_u24 v19, v20, s10, v19
    v_lshlrev_b32 v20, 30, v20
    v_and_b32 v0, 15, v1
    v_mfma_f32_32x32x16_bf16 v[144:159], v[108:111], a[228:231], v[144:159]
    ds_read_b64_tr_b16 v[102:103], v17 offset:8704
    s_add_u32 s87, s87, s7
    v_mad_u32_u24 v20, v0, s10, v20
    v_and_b32 v0, 16, v1
    v_add_u32 v20, v20, v0
    buffer_load_dwordx4 v[160:163], v20, s[48:51], s91 offen offset:512 sc1
    s_waitcnt lgkmcnt(4)
    v_mfma_f32_32x32x16_bf16 v[224:239], v[112:115], a[232:235], v[224:239]
    ds_read_b64_tr_b16 v[104:105], v16 offset:12288
    v_mfma_f32_32x32x16_bf16 v[240:255], v[112:115], a[236:239], v[240:255]
    ds_read_b64_tr_b16 v[106:107], v16 offset:12800
    buffer_load_dwordx4 v[64:67], v19, s[48:51], s91 offen offset:0 sc1
    buffer_load_dwordx4 v[68:71], v19, s[48:51], s91 offen offset:1280 sc1
    buffer_load_dwordx4 v[72:75], v19, s[48:51], s91 offen offset:2560 sc1
    v_mfma_f32_32x32x16_bf16 v[128:143], v[116:119], a[232:235], v[128:143]
    ds_read_b64_tr_b16 v[108:109], v17 offset:12288
    v_mfma_f32_32x32x16_bf16 v[144:159], v[116:119], a[236:239], v[144:159]
    ds_read_b64_tr_b16 v[110:111], v17 offset:12800
    s_waitcnt lgkmcnt(4)
    v_mfma_f32_32x32x16_bf16 v[224:239], v[96:99], a[240:243], v[224:239]
    s_barrier
    v_mfma_f32_32x32x16_bf16 v[240:255], v[96:99], a[244:247], v[240:255]
    v_mfma_f32_32x32x16_bf16 v[128:143], v[100:103], a[240:243], v[128:143]
    v_mfma_f32_32x32x16_bf16 v[144:159], v[100:103], a[244:247], v[144:159]
    s_add_u32 s91, s91, 3840
    buffer_load_dwordx4 v[76:79], v19, s[48:51], s91 offen offset:0 sc1
    buffer_load_dwordx4 v[80:83], v19, s[48:51], s91 offen offset:1280 sc1
    buffer_load_dwordx4 v[84:87], v19, s[48:51], s91 offen offset:2560 sc1
    s_waitcnt lgkmcnt(0)
    v_mfma_f32_32x32x16_bf16 v[224:239], v[104:107], a[248:251], v[224:239]
    s_barrier
    v_mfma_f32_32x32x16_bf16 v[240:255], v[104:107], a[252:255], v[240:255]
    v_mfma_f32_32x32x16_bf16 v[128:143], v[108:111], a[248:251], v[128:143]
    v_mfma_f32_32x32x16_bf16 v[144:159], v[108:111], a[252:255], v[144:159]
    v_xor_b32 v16, 0, v122
    v_xor_b32 v17, 32, v122
    s_mul_i32 s85, s64, 6
    s_add_u32 s85, s85, s62
    s_lshl_b32 s85, s85, 1
    s_add_u32 s85, s85, 4
    s_lshl_b32 s85, s85, 11
    s_add_u32 s85, s85, s73
    v_xor_b32 v12, 64, v122
    v_xor_b32 v13, 96, v122
    v_mul_f32 v224, v56, v224
    v_mul_f32 v225, v56, v225
    v_mul_f32 v226, v56, v226
    v_mul_f32 v227, v56, v227
    v_mul_f32 v228, v56, v228
    v_mul_f32 v229, v56, v229
    v_add_u32 v16, 0x4000, v16
    v_add_u32 v17, 0x4000, v17
    v_mul_f32 v230, v56, v230
    v_mul_f32 v231, v56, v231
    v_exp_f32 v224, -v224
    v_exp_f32 v225, -v225
    v_exp_f32 v226, -v226
    v_exp_f32 v227, -v227
    v_add_u32 v12, 0x4000, v12
    v_add_u32 v13, 0x4000, v13
    s_add_u32 s91, s91, 3840
    buffer_load_dwordx4 v[88:91], v19, s[48:51], s91 offen offset:0 sc1
    v_exp_f32 v228, -v228
    v_exp_f32 v229, -v229
    v_exp_f32 v230, -v230
    v_exp_f32 v231, -v231
    v_fma_f32 v224, v224, v58, v58
    v_fma_f32 v225, v225, v58, v58
    s_waitcnt vmcnt(33)
    ds_read_b64_tr_b16 a[0:1], v16 offset:0
    v_fma_f32 v226, v226, v58, v58
    v_fma_f32 v227, v227, v58, v58
    v_fma_f32 v228, v228, v58, v58
    v_fma_f32 v229, v229, v58, v58
    v_fma_f32 v230, v230, v58, v58
    v_fma_f32 v231, v231, v58, v58
    ds_read_b64_tr_b16 a[2:3], v16 offset:1024
    ds_read_b64_tr_b16 a[4:5], v17 offset:0
    buffer_load_dwordx4 v[92:95], v19, s[48:51], s91 offen offset:1280 sc1
    s_add_u32 s95, s71, 147456
    v_add_u32 v19, s95, v2
    s_lshl_b32 s95, s62, 12
    s_add_u32 s95, s95, 147456
    v_add_u32 v20, s95, v2
    s_lshl_b32 s95, s64, 1
    v_rcp_f32 v224, v224
    v_rcp_f32 v225, v225
    v_rcp_f32 v226, v226
    v_rcp_f32 v227, v227
    v_rcp_f32 v228, v228
    v_rcp_f32 v229, v229
    s_add_u32 m0, s71, 131072
    s_nop 0
    buffer_load_dwordx4 v4, s[56:59], s87 offen offset:0 sc1 lds
    ds_read_b64_tr_b16 a[6:7], v17 offset:1024
    ds_read_b64_tr_b16 a[8:9], v12 offset:0
    s_add_u32 s95, s95, s62
    s_lshl_b32 s95, s95, 12
    s_add_u32 s95, s95, 229376
    s_add_u32 s95, s95, s73
    v_mov_b32 v46, s66
    v_rcp_f32 v230, v230
    v_rcp_f32 v231, v231
    v_mul_f32 v232, v232, v224
    v_mul_f32 v233, v233, v225
    v_mul_f32 v234, v234, v226
    v_mul_f32 v235, v235, v227
    buffer_load_dwordx4 v5, s[56:59], s87 offen offset:1024 sc1 lds
    ds_read_b64_tr_b16 a[10:11], v12 offset:1024
    ds_read_b64_tr_b16 a[12:13], v13 offset:0
    v_mul_f32 v236, v236, v228
    v_mul_f32 v237, v237, v229
    v_mul_f32 v238, v238, v230
    v_mul_f32 v239, v239, v231
    v_cvt_pk_bf16_f32 v224, v232, v233
    v_cvt_pk_bf16_f32 v225, v234, v235
    buffer_load_dwordx4 v6, s[56:59], s87 offen offset:2048 sc1 lds
    ds_read_b64_tr_b16 a[14:15], v13 offset:1024
    v_add_u32 v16, 0x4000, v16
    v_cvt_pk_bf16_f32 v226, v236, v237
    v_cvt_pk_bf16_f32 v227, v238, v239
    buffer_store_dwordx4 v[224:227], v2, s[52:55], s85 offen offset:0 sc1
    v_mul_f32 v240, v57, v240
    v_mul_f32 v241, v57, v241
    v_mul_f32 v242, v57, v242
    v_add_u32 v17, 0x4000, v17
    v_add_u32 v12, 0x4000, v12
    v_mul_f32 v243, v57, v243
    v_mul_f32 v244, v57, v244
    v_mul_f32 v245, v57, v245
    v_mul_f32 v246, v57, v246
    v_mul_f32 v247, v57, v247
    v_exp_f32 v240, -v240
    v_add_u32 v13, 0x4000, v13
    s_waitcnt vmcnt(34)
    v_exp_f32 v241, -v241
    v_exp_f32 v242, -v242
    v_exp_f32 v243, -v243
    v_exp_f32 v244, -v244
    v_exp_f32 v245, -v245
    v_exp_f32 v246, -v246
    buffer_load_dwordx4 v7, s[56:59], s87 offen offset:3072 sc1 lds
    ds_read_b64_tr_b16 a[16:17], v16 offset:0
    ds_read_b64_tr_b16 a[18:19], v16 offset:1024
    v_exp_f32 v247, -v247
    v_fma_f32 v240, v240, v59, v59
    v_fma_f32 v241, v241, v59, v59
    v_fma_f32 v242, v242, v59, v59
    v_fma_f32 v243, v243, v59, v59
    v_fma_f32 v244, v244, v59, v59
    ds_read_b64_tr_b16 a[20:21], v17 offset:0
    ds_read_b64_tr_b16 a[22:23], v17 offset:1024
    v_fma_f32 v245, v245, v59, v59
    v_fma_f32 v246, v246, v59, v59
    v_fma_f32 v247, v247, v59, v59
    v_rcp_f32 v240, v240
    v_rcp_f32 v241, v241
    v_rcp_f32 v242, v242
    s_add_u32 s87, s87, s7
    s_add_u32 m0, s71, 0
    s_nop 0
    buffer_load_dwordx4 v4, s[56:59], s87 offen offset:0 sc1 lds
    ds_read_b64_tr_b16 a[24:25], v12 offset:0
    ds_read_b64_tr_b16 a[26:27], v12 offset:1024
    s_waitcnt vmcnt(10)
    v_mfma_f32_16x16x32_bf16 v[28:31], v[60:63], v[160:163], 0
    v_mfma_f32_16x16x32_bf16 v[32:35], v[60:63], v[64:67], 0
    v_mfma_f32_16x16x32_bf16 v[32:35], v[60:63], v[68:71], v[32:35]
    v_mfma_f32_16x16x32_bf16 v[32:35], v[60:63], v[72:75], v[32:35]
    v_mfma_f32_16x16x32_bf16 v[32:35], v[60:63], v[76:79], v[32:35]
    s_nop 3
    v_add_f32 v28, v28, v28 row_ror:8 row_mask:0xf bank_mask:0xf
    v_rcp_f32 v243, v243
    v_rcp_f32 v244, v244
    v_rcp_f32 v245, v245
    v_rcp_f32 v246, v246
    v_rcp_f32 v247, v247
    v_mul_f32 v248, v248, v240
    buffer_load_dwordx4 v5, s[56:59], s87 offen offset:1024 sc1 lds
    ds_read_b64_tr_b16 a[28:29], v13 offset:0
    ds_read_b64_tr_b16 a[30:31], v13 offset:1024
    v_add_f32 v29, v29, v29 row_ror:8 row_mask:0xf bank_mask:0xf
    v_add_f32 v30, v30, v30 row_ror:8 row_mask:0xf bank_mask:0xf
    v_add_f32 v31, v31, v31 row_ror:8 row_mask:0xf bank_mask:0xf
    v_add_f32 v28, v28, v28 row_ror:4 row_mask:0xf bank_mask:0xf
    v_add_f32 v29, v29, v29 row_ror:4 row_mask:0xf bank_mask:0xf
    v_add_f32 v30, v30, v30 row_ror:4 row_mask:0xf bank_mask:0xf
    v_add_f32 v31, v31, v31 row_ror:4 row_mask:0xf bank_mask:0xf
    v_mul_f32 v249, v249, v241
    v_mul_f32 v250, v250, v242
    v_mul_f32 v251, v251, v243
    v_mul_f32 v252, v252, v244
    v_mul_f32 v253, v253, v245
    v_mul_f32 v254, v254, v246
    buffer_load_dwordx4 v6, s[56:59], s87 offen offset:2048 sc1 lds
    s_waitcnt lgkmcnt(8)
    v_add_u32 v16, 0x4000, v16
    v_add_f32 v28, v28, v28 row_ror:2 row_mask:0xf bank_mask:0xf
    v_add_f32 v29, v29, v29 row_ror:2 row_mask:0xf bank_mask:0xf
    v_add_f32 v30, v30, v30 row_ror:2 row_mask:0xf bank_mask:0xf
    v_add_f32 v31, v31, v31 row_ror:2 row_mask:0xf bank_mask:0xf
    v_add_f32 v28, v28, v28 row_ror:1 row_mask:0xf bank_mask:0xf
    v_add_f32 v29, v29, v29 row_ror:1 row_mask:0xf bank_mask:0xf
    v_add_f32 v30, v30, v30 row_ror:1 row_mask:0xf bank_mask:0xf
    v_mul_f32 v255, v255, v247
    v_cvt_pk_bf16_f32 v240, v248, v249
    v_cvt_pk_bf16_f32 v241, v250, v251
    v_cvt_pk_bf16_f32 v242, v252, v253
    v_cvt_pk_bf16_f32 v243, v254, v255
    buffer_store_dwordx4 v[240:243], v2, s[52:55], s85 offen offset:1024 sc1
    buffer_load_dwordx4 v7, s[56:59], s87 offen offset:3072 sc1 lds
    v_add_u32 v17, 0x4000, v17
    v_add_u32 v12, 0x4000, v12
    v_add_f32 v31, v31, v31 row_ror:1 row_mask:0xf bank_mask:0xf
    s_waitcnt vmcnt(10)
    v_mfma_f32_16x16x32_bf16 v[32:35], v[60:63], v[80:83], v[32:35]
    v_mfma_f32_16x16x32_bf16 v[32:35], v[60:63], v[84:87], v[32:35]
    v_mfma_f32_16x16x32_bf16 v[32:35], v[60:63], v[88:91], v[32:35]
    v_mfma_f32_16x16x32_bf16 v[32:35], v[60:63], v[92:95], v[32:35]
    v_cvt_pk_bf16_f32 v26, v28, v29
    v_mul_f32 v128, v56, v128
    v_mul_f32 v129, v56, v129
    v_mul_f32 v130, v56, v130
    v_mul_f32 v131, v56, v131
    v_mul_f32 v132, v56, v132
    v_mul_f32 v133, v56, v133
    s_add_u32 s87, s87, s7
    s_sub_u32 s87, s87, s8
    s_add_u32 m0, s71, 16384
    s_nop 0
    buffer_load_dwordx4 v4, s[56:59], s87 offen offset:0 sc1 lds
    v_add_u32 v13, 0x4000, v13
    s_waitcnt vmcnt(37)
    v_cvt_pk_bf16_f32 v27, v30, v31
    v_mul_f32 v134, v56, v134
    v_mul_f32 v135, v56, v135
    v_exp_f32 v128, -v128
    v_exp_f32 v129, -v129
    v_exp_f32 v130, -v130
    v_exp_f32 v131, -v131
    buffer_load_dwordx4 v5, s[56:59], s87 offen offset:1024 sc1 lds
    ds_read_b64_tr_b16 a[32:33], v16 offset:0
    ds_read_b64_tr_b16 a[34:35], v16 offset:1024
    v_cvt_pk_bf16_f32 v24, v32, v33
    v_cvt_pk_bf16_f32 v25, v34, v35
    s_nop 0
    v_permlane16_swap_b32 v24, v26
    v_permlane16_swap_b32 v25, v27
    ds_write_b128 v19, v[24:27]
    v_exp_f32 v132, -v132
    v_exp_f32 v133, -v133
    v_exp_f32 v134, -v134
    v_exp_f32 v135, -v135
    v_fma_f32 v128, v128, v58, v58
    v_fma_f32 v129, v129, v58, v58
    buffer_load_dwordx4 v6, s[56:59], s87 offen offset:2048 sc1 lds
    ds_read_b64_tr_b16 a[36:37], v17 offset:0
    ds_read_b64_tr_b16 a[38:39], v17 offset:1024
    v_fma_f32 v130, v130, v58, v58
    v_fma_f32 v131, v131, v58, v58
    v_fma_f32 v132, v132, v58, v58
    v_fma_f32 v133, v133, v58, v58
    v_fma_f32 v134, v134, v58, v58
    v_fma_f32 v135, v135, v58, v58
    buffer_load_dwordx4 v7, s[56:59], s87 offen offset:3072 sc1 lds
    ds_read_b64_tr_b16 a[40:41], v12 offset:0
    ds_read_b64_tr_b16 a[42:43], v12 offset:1024
    s_waitcnt lgkmcnt(4)
    s_barrier
    ds_read_b128 v[48:51], v20
    ds_read_b128 v[52:55], v20 offset:8192
    s_cmp_lg_u32 s93, 0
    s_cbranch_scc1 L_sk_68
    s_mov_b64 exec, 1
    buffer_store_dword v46, off, s[48:51], s93 sc1
    s_mov_b64 exec, -1
L_sk_68:
    v_rcp_f32 v128, v128
    v_rcp_f32 v129, v129
    v_rcp_f32 v130, v130
    v_rcp_f32 v131, v131
    v_rcp_f32 v132, v132
    v_rcp_f32 v133, v133
    s_add_u32 s87, s87, s7
    ds_read_b64_tr_b16 a[44:45], v13 offset:0
    ds_read_b64_tr_b16 a[46:47], v13 offset:1024
    v_rcp_f32 v134, v134
    v_rcp_f32 v135, v135
    v_mul_f32 v136, v136, v128
    v_mul_f32 v137, v137, v129
    v_mul_f32 v138, v138, v130
    v_mul_f32 v139, v139, v131
    s_waitcnt lgkmcnt(11)
    v_add_u32 v16, 0x4000, v16
    v_mul_f32 v140, v140, v132
    v_mul_f32 v141, v141, v133
    v_mul_f32 v142, v142, v134
    v_mul_f32 v143, v143, v135
    v_cvt_pk_bf16_f32 v128, v136, v137
    v_cvt_pk_bf16_f32 v129, v138, v139
    s_add_u32 m0, s71, 32768
    s_nop 0
    buffer_load_dwordx4 v4, s[56:59], s87 offen offset:0 sc1 lds
    v_add_u32 v17, 0x4000, v17
    v_add_u32 v12, 0x4000, v12
    s_waitcnt lgkmcnt(2)
    v_mfma_f32_32x32x16_bf16 v[64:79], v[48:51], v[192:195], 0
    v_mfma_f32_32x32x16_bf16 v[80:95], v[52:55], v[196:199], 0
    v_mfma_f32_32x32x16_bf16 v[160:175], v[48:51], v[208:211], 0
    v_mfma_f32_32x32x16_bf16 v[176:191], v[52:55], v[212:215], 0
    s_nop 8
    v_add_f32 v72, 0x358637bd, v72
    v_rcp_f32 v72, v72
    v_cvt_pk_bf16_f32 v130, v140, v141
    v_cvt_pk_bf16_f32 v131, v142, v143
    buffer_store_dwordx4 v[128:131], v2, s[52:55], s85 offen offset:2048 sc1
    v_mul_f32 v144, v57, v144
    v_mul_f32 v145, v57, v145
    v_mul_f32 v146, v57, v146
    buffer_load_dwordx4 v5, s[56:59], s87 offen offset:1024 sc1 lds
    v_add_u32 v13, 0x4000, v13
    s_waitcnt vmcnt(39)
    v_mul_f32 v64, 0x3f317218, v64
    v_mul_f32 v73, 0x3f317218, v72
    v_mul_f32 v64, v72, v64
    v_mul_f32 v65, v73, v65
    v_mul_f32 v66, v73, v66
    v_mul_f32 v67, v73, v67
    v_mul_f32 v68, v73, v68
    v_mul_f32 v147, v57, v147
    v_mul_f32 v148, v57, v148
    v_mul_f32 v149, v57, v149
    v_mul_f32 v150, v57, v150
    v_mul_f32 v151, v57, v151
    v_exp_f32 v144, -v144
    buffer_load_dwordx4 v6, s[56:59], s87 offen offset:2048 sc1 lds
    ds_read_b64_tr_b16 a[48:49], v16 offset:0
    ds_read_b64_tr_b16 a[50:51], v16 offset:1024
    v_mul_f32 v69, v73, v69
    v_mul_f32 v70, v73, v70
    v_mul_f32 v71, v73, v71
    v_cvt_pk_bf16_f32 v76, v64, v65
    v_cvt_pk_bf16_f32 v77, v66, v67
    v_cvt_pk_bf16_f32 v78, v68, v69
    v_cvt_pk_bf16_f32 v79, v70, v71
    v_exp_f32 v145, -v145
    v_exp_f32 v146, -v146
    v_exp_f32 v147, -v147
    v_exp_f32 v148, -v148
    v_exp_f32 v149, -v149
    v_exp_f32 v150, -v150
    buffer_load_dwordx4 v7, s[56:59], s87 offen offset:3072 sc1 lds
    ds_read_b64_tr_b16 a[52:53], v17 offset:0
    ds_read_b64_tr_b16 a[54:55], v17 offset:1024
    buffer_store_dwordx4 v[76:79], v2, s[52:55], s95 offen offset:0 sc1
    v_add_f32 v88, 0x358637bd, v88
    v_rcp_f32 v88, v88
    v_mul_f32 v80, 0x3f317218, v80
    v_mul_f32 v89, 0x3f317218, v88
    v_mul_f32 v80, v88, v80
    v_mul_f32 v81, v89, v81
    v_exp_f32 v151, -v151
    v_fma_f32 v144, v144, v59, v59
    v_fma_f32 v145, v145, v59, v59
    v_fma_f32 v146, v146, v59, v59
    v_fma_f32 v147, v147, v59, v59
    v_fma_f32 v148, v148, v59, v59
    s_add_u32 s87, s87, s7
    ds_read_b64_tr_b16 a[56:57], v12 offset:0
    ds_read_b64_tr_b16 a[58:59], v12 offset:1024
    v_mul_f32 v82, v89, v82
    v_mul_f32 v83, v89, v83
    v_mul_f32 v84, v89, v84
    v_mul_f32 v85, v89, v85
    v_mul_f32 v86, v89, v86
    v_mul_f32 v87, v89, v87
    v_cvt_pk_bf16_f32 v92, v80, v81
    v_fma_f32 v149, v149, v59, v59
    v_fma_f32 v150, v150, v59, v59
    v_fma_f32 v151, v151, v59, v59
    v_rcp_f32 v144, v144
    v_rcp_f32 v145, v145
    v_rcp_f32 v146, v146
    ds_read_b64_tr_b16 a[60:61], v13 offset:0
    ds_read_b64_tr_b16 a[62:63], v13 offset:1024
    v_cvt_pk_bf16_f32 v93, v82, v83
    v_cvt_pk_bf16_f32 v94, v84, v85
    v_cvt_pk_bf16_f32 v95, v86, v87
    buffer_store_dwordx4 v[92:95], v2, s[52:55], s95 offen offset:2048 sc1
    v_add_f32 v168, 0x358637bd, v168
    v_rcp_f32 v168, v168
    v_mul_f32 v160, 0x3f317218, v160
    v_rcp_f32 v147, v147
    v_rcp_f32 v148, v148
    v_rcp_f32 v149, v149
    v_rcp_f32 v150, v150
    v_rcp_f32 v151, v151
    v_mul_f32 v152, v152, v144
    s_waitcnt lgkmcnt(8)
    v_add_u32 v16, 0x4000, v16
    v_mul_f32 v169, 0x3f317218, v168
    v_mul_f32 v160, v168, v160
    v_mul_f32 v161, v169, v161
    v_mul_f32 v162, v169, v162
    v_mul_f32 v163, v169, v163
    v_mul_f32 v164, v169, v164
    v_mul_f32 v165, v169, v165
    v_mul_f32 v153, v153, v145
    v_mul_f32 v154, v154, v146
    v_mul_f32 v155, v155, v147
    v_mul_f32 v156, v156, v148
    v_mul_f32 v157, v157, v149
    v_mul_f32 v158, v158, v150
    s_add_u32 m0, s71, 49152
    s_nop 0
    buffer_load_dwordx4 v4, s[56:59], s87 offen offset:0 sc1 lds
    v_add_u32 v17, 0x4000, v17
    v_add_u32 v12, 0x4000, v12
    v_mul_f32 v166, v169, v166
    v_mul_f32 v167, v169, v167
    v_cvt_pk_bf16_f32 v172, v160, v161
    v_cvt_pk_bf16_f32 v173, v162, v163
    v_cvt_pk_bf16_f32 v174, v164, v165
    v_cvt_pk_bf16_f32 v175, v166, v167
    buffer_store_dwordx4 v[172:175], v2, s[52:55], s95 offen offset:1024 sc1
    v_mul_f32 v159, v159, v151
    v_cvt_pk_bf16_f32 v144, v152, v153
    v_cvt_pk_bf16_f32 v145, v154, v155
    v_cvt_pk_bf16_f32 v146, v156, v157
    v_cvt_pk_bf16_f32 v147, v158, v159
    buffer_store_dwordx4 v[144:147], v2, s[52:55], s85 offen offset:3072 sc1
    buffer_load_dwordx4 v5, s[56:59], s87 offen offset:1024 sc1 lds
    v_add_u32 v13, 0x4000, v13
    s_waitcnt vmcnt(43)
    v_add_f32 v184, 0x358637bd, v184
    v_rcp_f32 v184, v184
    v_mul_f32 v176, 0x3f317218, v176
    v_mul_f32 v185, 0x3f317218, v184
    v_mul_f32 v176, v184, v176
    v_mul_f32 v177, v185, v177
    v_mul_f32 v178, v185, v178
    ds_read_b64_tr_b16 a[64:65], v16 offset:0
    ds_read_b64_tr_b16 a[66:67], v16 offset:1024
    v_mul_f32 v179, v185, v179
    v_mul_f32 v180, v185, v180
    v_mul_f32 v181, v185, v181
    v_mul_f32 v182, v185, v182
    v_mul_f32 v183, v185, v183
    v_cvt_pk_bf16_f32 v188, v176, v177
    v_cvt_pk_bf16_f32 v189, v178, v179
    buffer_load_dwordx4 v6, s[56:59], s87 offen offset:2048 sc1 lds
    ds_read_b64_tr_b16 a[68:69], v17 offset:0
    ds_read_b64_tr_b16 a[70:71], v17 offset:1024
    v_cvt_pk_bf16_f32 v190, v180, v181
    v_cvt_pk_bf16_f32 v191, v182, v183
    buffer_store_dwordx4 v[188:191], v2, s[52:55], s95 offen offset:3072 sc1
    ds_read_b64_tr_b16 a[72:73], v12 offset:0
    ds_read_b64_tr_b16 a[74:75], v12 offset:1024
    ds_read_b64_tr_b16 a[76:77], v13 offset:0
    ds_read_b64_tr_b16 a[78:79], v13 offset:1024
    s_waitcnt lgkmcnt(8)
    v_add_u32 v16, 0x4000, v16
    v_add_u32 v17, 0x4000, v17
    v_add_u32 v12, 0x4000, v12
    v_add_u32 v13, 0x4000, v13
    s_waitcnt vmcnt(40)
    ds_read_b64_tr_b16 a[80:81], v16 offset:0
    ds_read_b64_tr_b16 a[82:83], v16 offset:1024
    ds_read_b64_tr_b16 a[84:85], v17 offset:0
    ds_read_b64_tr_b16 a[86:87], v17 offset:1024
    ds_read_b64_tr_b16 a[88:89], v12 offset:0
    ds_read_b64_tr_b16 a[90:91], v12 offset:1024
    ds_read_b64_tr_b16 a[92:93], v13 offset:0
    ds_read_b64_tr_b16 a[94:95], v13 offset:1024
    s_waitcnt lgkmcnt(8)
    v_add_u32 v16, 0x4000, v16
    v_add_u32 v17, 0x4000, v17
    v_add_u32 v12, 0x4000, v12
    v_add_u32 v13, 0x4000, v13
    s_waitcnt vmcnt(36)
    ds_read_b64_tr_b16 a[96:97], v16 offset:0
    ds_read_b64_tr_b16 a[98:99], v16 offset:1024
    ds_read_b64_tr_b16 a[100:101], v17 offset:0
    ds_read_b64_tr_b16 a[102:103], v17 offset:1024
    buffer_load_dwordx4 v7, s[56:59], s87 offen offset:3072 sc1 lds
    ds_read_b64_tr_b16 a[104:105], v12 offset:0
    ds_read_b64_tr_b16 a[106:107], v12 offset:1024
    ds_read_b64_tr_b16 a[108:109], v13 offset:0
    ds_read_b64_tr_b16 a[110:111], v13 offset:1024
    s_waitcnt lgkmcnt(8)
    v_add_u32 v16, 0x4000, v16
    v_add_u32 v17, 0x4000, v17
    v_add_u32 v12, 0x4000, v12
    v_add_u32 v13, 0x4000, v13
    s_waitcnt vmcnt(23)
    ds_read_b64_tr_b16 a[112:113], v16 offset:0
    ds_read_b64_tr_b16 a[114:115], v16 offset:1024
    ds_read_b64_tr_b16 a[116:117], v17 offset:0
    ds_read_b64_tr_b16 a[118:119], v17 offset:1024
    ds_read_b64_tr_b16 a[120:121], v12 offset:0
    ds_read_b64_tr_b16 a[122:123], v12 offset:1024
    ds_read_b64_tr_b16 a[124:125], v13 offset:0
    ds_read_b64_tr_b16 a[126:127], v13 offset:1024
    s_add_u32 s87, s87, s7
    s_add_u32 m0, s71, 65536
    s_nop 0
    buffer_load_dwordx4 v4, s[56:59], s87 offen offset:0 sc1 lds
    s_waitcnt lgkmcnt(8)
    v_add_u32 v16, 0xfffe0000, v16
    v_add_u32 v17, 0xfffe0000, v17
    v_add_u32 v12, 0xfffe0000, v12
    v_add_u32 v13, 0xfffe0000, v13
    s_waitcnt vmcnt(19)
    ds_read_b64_tr_b16 a[128:129], v16 offset:0
    ds_read_b64_tr_b16 a[130:131], v16 offset:1024
    ds_read_b64_tr_b16 a[132:133], v17 offset:0
    ds_read_b64_tr_b16 a[134:135], v17 offset:1024
    ds_read_b64_tr_b16 a[136:137], v12 offset:0
    ds_read_b64_tr_b16 a[138:139], v12 offset:1024
    ds_read_b64_tr_b16 a[140:141], v13 offset:0
    ds_read_b64_tr_b16 a[142:143], v13 offset:1024
    v_mov_b32 v44, s65
    v_mov_b32 v45, s66
    s_add_u32 s78, s74, 28672
    s_waitcnt vmcnt(5)
    s_mov_b64 exec, 1
    buffer_store_dwordx2 v[44:45], off, s[48:51], s78 sc1
    s_mov_b64 exec, -1
    buffer_load_dwordx4 v5, s[56:59], s87 offen offset:1024 sc1 lds
    s_waitcnt lgkmcnt(8)
    v_add_u32 v16, 0x4000, v16
    v_add_u32 v17, 0x4000, v17
    v_add_u32 v12, 0x4000, v12
    v_add_u32 v13, 0x4000, v13
    s_waitcnt vmcnt(17)
    ds_read_b64_tr_b16 a[144:145], v16 offset:0
    ds_read_b64_tr_b16 a[146:147], v16 offset:1024
    ds_read_b64_tr_b16 a[148:149], v17 offset:0
    ds_read_b64_tr_b16 a[150:151], v17 offset:1024
    ds_read_b64_tr_b16 a[152:153], v12 offset:0
    ds_read_b64_tr_b16 a[154:155], v12 offset:1024
    ds_read_b64_tr_b16 a[156:157], v13 offset:0
    ds_read_b64_tr_b16 a[158:159], v13 offset:1024
    buffer_load_dwordx4 v6, s[56:59], s87 offen offset:2048 sc1 lds
    s_waitcnt lgkmcnt(8)
    v_add_u32 v16, 0x4000, v16
    v_add_u32 v17, 0x4000, v17
    v_add_u32 v12, 0x4000, v12
    v_add_u32 v13, 0x4000, v13
    s_waitcnt vmcnt(13)
    ds_read_b64_tr_b16 a[160:161], v16 offset:0
    ds_read_b64_tr_b16 a[162:163], v16 offset:1024
    ds_read_b64_tr_b16 a[164:165], v17 offset:0
    ds_read_b64_tr_b16 a[166:167], v17 offset:1024
    ds_read_b64_tr_b16 a[168:169], v12 offset:0
    ds_read_b64_tr_b16 a[170:171], v12 offset:1024
    ds_read_b64_tr_b16 a[172:173], v13 offset:0
    ds_read_b64_tr_b16 a[174:175], v13 offset:1024
    s_waitcnt lgkmcnt(8)
    buffer_load_dwordx4 v7, s[56:59], s87 offen offset:3072 sc1 lds
    v_mov_b32 v44, s65
    v_mov_b32 v45, s66
    s_add_u32 s78, s74, 20480
    s_waitcnt vmcnt(6)
    s_mov_b64 exec, 1
    buffer_store_dwordx2 v[44:45], off, s[48:51], s78 sc1
    s_mov_b64 exec, -1
    s_add_u32 s87, s87, s7
    s_add_u32 m0, s71, 81920
    s_nop 0
    buffer_load_dwordx4 v4, s[56:59], s87 offen offset:0 sc1 lds
    buffer_load_dwordx4 v5, s[56:59], s87 offen offset:1024 sc1 lds
    buffer_load_dwordx4 v6, s[56:59], s87 offen offset:2048 sc1 lds
    buffer_load_dwordx4 v7, s[56:59], s87 offen offset:3072 sc1 lds
    s_add_u32 s87, s87, s7
    s_add_u32 m0, s71, 98304
    s_nop 0
    buffer_load_dwordx4 v4, s[56:59], s87 offen offset:0 sc1 lds
    v_add_u32 v16, 0x4000, v16
    v_add_u32 v17, 0x4000, v17
    buffer_load_dwordx4 v5, s[56:59], s87 offen offset:1024 sc1 lds
    v_add_u32 v12, 0x4000, v12
    v_add_u32 v13, 0x4000, v13
    s_waitcnt vmcnt(12)
    ds_read_b64_tr_b16 a[176:177], v16 offset:0
    ds_read_b64_tr_b16 a[178:179], v16 offset:1024
    ds_read_b64_tr_b16 a[180:181], v17 offset:0
    ds_read_b64_tr_b16 a[182:183], v17 offset:1024
    ds_read_b64_tr_b16 a[184:185], v12 offset:0
    ds_read_b64_tr_b16 a[186:187], v12 offset:1024
    ds_read_b64_tr_b16 a[188:189], v13 offset:0
    ds_read_b64_tr_b16 a[190:191], v13 offset:1024
    s_waitcnt lgkmcnt(8)
    buffer_load_dwordx4 v6, s[56:59], s87 offen offset:2048 sc1 lds
    buffer_load_dwordx4 v7, s[56:59], s87 offen offset:3072 sc1 lds
    s_add_u32 s87, s87, s7
    s_add_u32 m0, s71, 114688
    s_nop 0
    buffer_load_dwordx4 v4, s[56:59], s87 offen offset:0 sc1 lds
    buffer_load_dwordx4 v5, s[56:59], s87 offen offset:1024 sc1 lds
    v_add_u32 v16, 0x4000, v16
    v_add_u32 v17, 0x4000, v17
    v_add_u32 v12, 0x4000, v12
    v_add_u32 v13, 0x4000, v13
    s_waitcnt vmcnt(11)
    ds_read_b64_tr_b16 a[192:193], v16 offset:0
    ds_read_b64_tr_b16 a[194:195], v16 offset:1024
    ds_read_b64_tr_b16 a[196:197], v17 offset:0
    ds_read_b64_tr_b16 a[198:199], v17 offset:1024
    ds_read_b64_tr_b16 a[200:201], v12 offset:0
    ds_read_b64_tr_b16 a[202:203], v12 offset:1024
    ds_read_b64_tr_b16 a[204:205], v13 offset:0
    ds_read_b64_tr_b16 a[206:207], v13 offset:1024
    s_waitcnt lgkmcnt(8)
    buffer_load_dwordx4 v6, s[56:59], s87 offen offset:2048 sc1 lds
    buffer_load_dwordx4 v7, s[56:59], s87 offen offset:3072 sc1 lds
    s_add_u32 s87, s87, s7
    s_cmp_lg_u32 s12, 0
    s_cbranch_scc1 L_sk_69
    s_add_u32 m0, s71, 131072
    s_nop 0
    buffer_load_dwordx4 v4, s[56:59], s87 offen offset:0 sc1 lds
    buffer_load_dwordx4 v5, s[56:59], s87 offen offset:1024 sc1 lds
    buffer_load_dwordx4 v6, s[56:59], s87 offen offset:2048 sc1 lds
    buffer_load_dwordx4 v7, s[56:59], s87 offen offset:3072 sc1 lds
    s_add_u32 s87, s87, s7
L_sk_69:
    v_add_u32 v16, 0x4000, v16
    v_add_u32 v17, 0x4000, v17
    v_add_u32 v12, 0x4000, v12
    v_add_u32 v13, 0x4000, v13
    s_cmp_lg_u32 s12, 0
    s_cbranch_scc1 L_wc_71
    s_waitcnt vmcnt(12)
    s_branch L_we_70
L_wc_71:
    s_waitcnt vmcnt(8)
L_we_70:
    ds_read_b64_tr_b16 a[208:209], v16 offset:0
    ds_read_b64_tr_b16 a[210:211], v16 offset:1024
    ds_read_b64_tr_b16 a[212:213], v17 offset:0
    ds_read_b64_tr_b16 a[214:215], v17 offset:1024
    ds_read_b64_tr_b16 a[216:217], v12 offset:0
    ds_read_b64_tr_b16 a[218:219], v12 offset:1024
    ds_read_b64_tr_b16 a[220:221], v13 offset:0
    ds_read_b64_tr_b16 a[222:223], v13 offset:1024
    s_waitcnt lgkmcnt(8)
    s_cmp_lg_u32 s12, 0
    s_cbranch_scc1 L_sk_72
    s_add_u32 m0, s71, 0
    s_nop 0
    buffer_load_dwordx4 v4, s[56:59], s87 offen offset:0 sc1 lds
    buffer_load_dwordx4 v5, s[56:59], s87 offen offset:1024 sc1 lds
    buffer_load_dwordx4 v6, s[56:59], s87 offen offset:2048 sc1 lds
    buffer_load_dwordx4 v7, s[56:59], s87 offen offset:3072 sc1 lds
    s_add_u32 s87, s87, s7
L_sk_72:
    s_cmp_eq_u32 s60, 0
    s_cselect_b32 s77, 15, 31
    v_and_b32 v21, s77, v1
    v_lshlrev_b32 v21, 3, v21
    v_and_b32 v22, 15, v1
    v_lshlrev_b32 v22, 4, v22
    v_bfe_u32 v23, v1, 4, 1
    v_lshl_add_u32 v22, v23, 9, v22
    v_lshrrev_b32 v23, 5, v1
    v_lshl_add_u32 v22, v23, 11, v22
    v_add_u32 v16, 0x4000, v16
    v_add_u32 v17, 0x4000, v17
    v_add_u32 v12, 0x4000, v12
    v_add_u32 v13, 0x4000, v13
    s_cmp_lg_u32 s12, 0
    s_cbranch_scc1 L_wc_74
    s_waitcnt vmcnt(12)
    s_branch L_we_73
L_wc_74:
    s_waitcnt vmcnt(4)
L_we_73:
    ds_read_b64_tr_b16 a[224:225], v16 offset:0
    ds_read_b64_tr_b16 a[226:227], v16 offset:1024
    ds_read_b64_tr_b16 a[228:229], v17 offset:0
    ds_read_b64_tr_b16 a[230:231], v17 offset:1024
    ds_read_b64_tr_b16 a[232:233], v12 offset:0
    ds_read_b64_tr_b16 a[234:235], v12 offset:1024
    ds_read_b64_tr_b16 a[236:237], v13 offset:0
    ds_read_b64_tr_b16 a[238:239], v13 offset:1024
    s_waitcnt lgkmcnt(8)
    buffer_load_dwordx2 v[48:49], v21, s[48:51], s90 offen sc1
    s_cmp_lg_u32 s13, 0
    s_cbranch_scc1 L_sk_75
    s_add_u32 m0, s71, 16384
    s_nop 0
    buffer_load_dwordx4 v4, s[56:59], s87 offen offset:0 sc1 lds
    buffer_load_dwordx4 v5, s[56:59], s87 offen offset:1024 sc1 lds
    buffer_load_dwordx4 v6, s[56:59], s87 offen offset:2048 sc1 lds
    buffer_load_dwordx4 v7, s[56:59], s87 offen offset:3072 sc1 lds
    s_add_u32 s87, s87, s7
L_sk_75:
    v_add_u32 v16, 0x4000, v16
    v_add_u32 v17, 0x4000, v17
    v_add_u32 v12, 0x4000, v12
    v_add_u32 v13, 0x4000, v13
    s_cmp_lg_u32 s12, 0
    s_cbranch_scc1 L_wc_77
    s_cmp_lg_u32 s13, 0
    s_cbranch_scc1 L_wc_78
    s_waitcnt vmcnt(13)
    s_branch L_we_76
L_wc_78:
    s_waitcnt vmcnt(9)
    s_branch L_we_76
L_wc_77:
    s_cmp_lg_u32 s13, 0
    s_cbranch_scc1 L_wc_79
    s_waitcnt vmcnt(5)
    s_branch L_we_76
L_wc_79:
    s_waitcnt vmcnt(1)
L_we_76:
    ds_read_b64_tr_b16 a[240:241], v16 offset:0
    ds_read_b64_tr_b16 a[242:243], v16 offset:1024
    ds_read_b64_tr_b16 a[244:245], v17 offset:0
    ds_read_b64_tr_b16 a[246:247], v17 offset:1024
    ds_read_b64_tr_b16 a[248:249], v12 offset:0
    ds_read_b64_tr_b16 a[250:251], v12 offset:1024
    ds_read_b64_tr_b16 a[252:253], v13 offset:0
    ds_read_b64_tr_b16 a[254:255], v13 offset:1024
    s_waitcnt lgkmcnt(8)
    v_add_u32 v16, 0x4000, v16
    v_add_u32 v17, 0x4000, v17
    v_add_u32 v12, 0x4000, v12
    v_add_u32 v13, 0x4000, v13
    s_cmp_lg_u32 s13, 0
    s_cbranch_scc1 L_wc_81
    s_waitcnt vmcnt(9)
    s_branch L_we_80
L_wc_81:
    s_waitcnt vmcnt(5)
L_we_80:
    ds_read_b64_tr_b16 v[72:73], v16 offset:0
    ds_read_b64_tr_b16 v[74:75], v16 offset:1024
    ds_read_b64_tr_b16 v[76:77], v17 offset:0
    ds_read_b64_tr_b16 v[78:79], v17 offset:1024
    ds_read_b64_tr_b16 v[80:81], v12 offset:0
    ds_read_b64_tr_b16 v[82:83], v12 offset:1024
    ds_read_b64_tr_b16 v[84:85], v13 offset:0
    ds_read_b64_tr_b16 v[86:87], v13 offset:1024
    s_waitcnt lgkmcnt(8)
    v_add_u32 v16, 0xfffe0000, v16
    v_add_u32 v17, 0xfffe0000, v17
    v_add_u32 v12, 0xfffe0000, v12
    v_add_u32 v13, 0xfffe0000, v13
    s_cmp_lg_u32 s13, 0
    s_cbranch_scc1 L_wc_83
    s_waitcnt vmcnt(5)
    s_branch L_we_82
L_wc_83:
    s_waitcnt vmcnt(1)
L_we_82:
    ds_read_b64_tr_b16 v[88:89], v16 offset:0
    ds_read_b64_tr_b16 v[90:91], v16 offset:1024
    ds_read_b64_tr_b16 v[92:93], v17 offset:0
    ds_read_b64_tr_b16 v[94:95], v17 offset:1024
    ds_read_b64_tr_b16 v[96:97], v12 offset:0
    ds_read_b64_tr_b16 v[98:99], v12 offset:1024
    ds_read_b64_tr_b16 v[100:101], v13 offset:0
    ds_read_b64_tr_b16 v[102:103], v13 offset:1024
    s_waitcnt lgkmcnt(8)
    s_cmp_lg_u32 s13, 0
    s_cbranch_scc1 L_wc_85
    s_waitcnt vmcnt(4)
    s_branch L_we_84
L_wc_85:
    s_waitcnt vmcnt(0)
L_we_84:
    v_xor_b32 v15, s65, v48
    v_bitop3_b32 v15, v15, v49, s66 bitop3:0xf6
    v_cmp_ne_u32 vcc, 0, v15
    s_cbranch_vccnz L_retry_paQ
L_back_paQ:
    buffer_load_dwordx4 v[192:195], v22, s[52:55], s88 offen offset:0 sc1
    buffer_load_dwordx4 v[196:199], v22, s[52:55], s88 offen offset:256 sc1
    buffer_load_dwordx4 v[200:203], v22, s[52:55], s88 offen offset:1024 sc1
    buffer_load_dwordx4 v[204:207], v22, s[52:55], s88 offen offset:1280 sc1
    s_add_u32 s88, s88, 4096
    buffer_load_dwordx4 v[208:211], v22, s[52:55], s88 offen offset:0 sc1
    buffer_load_dwordx4 v[212:215], v22, s[52:55], s88 offen offset:256 sc1
    buffer_load_dwordx4 v[216:219], v22, s[52:55], s88 offen offset:1024 sc1
    buffer_load_dwordx4 v[220:223], v22, s[52:55], s88 offen offset:1280 sc1
    s_add_u32 s88, s88, 4096
    buffer_load_dwordx4 v[224:227], v22, s[52:55], s88 offen offset:0 sc1
    buffer_load_dwordx4 v[228:231], v22, s[52:55], s88 offen offset:256 sc1
    buffer_load_dwordx4 v[232:235], v22, s[52:55], s88 offen offset:1024 sc1
    buffer_load_dwordx4 v[236:239], v22, s[52:55], s88 offen offset:1280 sc1
    s_add_u32 s88, s88, 4096
    v_add_u32 v16, 0x4000, v16
    v_add_u32 v17, 0x4000, v17
    v_add_u32 v12, 0x4000, v12
    v_add_u32 v13, 0x4000, v13
    s_waitcnt vmcnt(12)
    ds_read_b64_tr_b16 v[104:105], v16 offset:0
    ds_read_b64_tr_b16 v[106:107], v16 offset:1024
    ds_read_b64_tr_b16 v[108:109], v17 offset:0
    ds_read_b64_tr_b16 v[110:111], v17 offset:1024
    ds_read_b64_tr_b16 v[112:113], v12 offset:0
    ds_read_b64_tr_b16 v[114:115], v12 offset:1024
    ds_read_b64_tr_b16 v[116:117], v13 offset:0
    ds_read_b64_tr_b16 v[118:119], v13 offset:1024
    s_waitcnt lgkmcnt(8)
    s_waitcnt lgkmcnt(0)
L_p2:
    s_waitcnt vmcnt(10)
    v_mfma_f32_16x16x32_bf16 v[128:131], a[0:3], v[192:195], 0
    buffer_load_dwordx4 v[240:243], v22, s[52:55], s88 offen offset:0 sc1
    v_mfma_f32_16x16x32_bf16 v[132:135], a[4:7], v[192:195], 0
    v_mfma_f32_16x16x32_bf16 v[136:139], a[8:11], v[192:195], 0
    v_mfma_f32_16x16x32_bf16 v[140:143], a[12:15], v[192:195], 0
    v_mfma_f32_16x16x32_bf16 v[144:147], a[0:3], v[196:199], 0
    buffer_load_dwordx4 v[244:247], v22, s[52:55], s88 offen offset:256 sc1
    v_mfma_f32_16x16x32_bf16 v[148:151], a[4:7], v[196:199], 0
    v_mfma_f32_16x16x32_bf16 v[152:155], a[8:11], v[196:199], 0
    v_mfma_f32_16x16x32_bf16 v[156:159], a[12:15], v[196:199], 0
    s_waitcnt vmcnt(10)
    v_mfma_f32_16x16x32_bf16 v[160:163], a[0:3], v[200:203], 0
    buffer_load_dwordx4 v[248:251], v22, s[52:55], s88 offen offset:1024 sc1
    v_mfma_f32_16x16x32_bf16 v[164:167], a[4:7], v[200:203], 0
    v_mfma_f32_16x16x32_bf16 v[168:171], a[8:11], v[200:203], 0
    v_mfma_f32_16x16x32_bf16 v[172:175], a[12:15], v[200:203], 0
    v_mfma_f32_16x16x32_bf16 v[176:179], a[0:3], v[204:207], 0
    buffer_load_dwordx4 v[252:255], v22, s[52:55], s88 offen offset:1280 sc1
    s_add_u32 s88, s88, 4096
    v_mfma_f32_16x16x32_bf16 v[180:183], a[4:7], v[204:207], 0
    v_mfma_f32_16x16x32_bf16 v[184:187], a[8:11], v[204:207], 0
    v_mfma_f32_16x16x32_bf16 v[188:191], a[12:15], v[204:207], 0
    s_waitcnt vmcnt(10)
    v_mfma_f32_16x16x32_bf16 v[128:131], a[16:19], v[208:211], v[128:131]
    buffer_load_dwordx4 v[192:195], v22, s[52:55], s88 offen offset:0 sc1
    v_mfma_f32_16x16x32_bf16 v[132:135], a[20:23], v[208:211], v[132:135]
    v_lshrrev_b32 v0, 3, v1
    v_mfma_f32_16x16x32_bf16 v[136:139], a[24:27], v[208:211], v[136:139]
    v_and_b32 v18, 7, v1
    v_mfma_f32_16x16x32_bf16 v[140:143], a[28:31], v[208:211], v[140:143]
    v_mfma_f32_16x16x32_bf16 v[144:147], a[16:19], v[212:215], v[144:147]
    buffer_load_dwordx4 v[196:199], v22, s[52:55], s88 offen offset:256 sc1
    v_mfma_f32_16x16x32_bf16 v[148:151], a[20:23], v[212:215], v[148:151]
    v_lshlrev_b32 v18, 4, v18
    v_mfma_f32_16x16x32_bf16 v[152:155], a[24:27], v[212:215], v[152:155]
    v_lshl_add_u32 v18, v0, 10, v18
    v_mfma_f32_16x16x32_bf16 v[156:159], a[28:31], v[212:215], v[156:159]
    s_waitcnt vmcnt(10)
    v_mfma_f32_16x16x32_bf16 v[160:163], a[16:19], v[216:219], v[160:163]
    buffer_load_dwordx4 v[200:203], v22, s[52:55], s88 offen offset:1024 sc1
    v_mfma_f32_16x16x32_bf16 v[164:167], a[20:23], v[216:219], v[164:167]
    s_lshl_b32 s76, s67, 2
    v_mfma_f32_16x16x32_bf16 v[168:171], a[24:27], v[216:219], v[168:171]
    s_add_u32 s76, s76, s60
    v_mfma_f32_16x16x32_bf16 v[172:175], a[28:31], v[216:219], v[172:175]
    v_mfma_f32_16x16x32_bf16 v[176:179], a[16:19], v[220:223], v[176:179]
    buffer_load_dwordx4 v[204:207], v22, s[52:55], s88 offen offset:1280 sc1
    s_add_u32 s88, s88, 4096
    v_mfma_f32_16x16x32_bf16 v[180:183], a[20:23], v[220:223], v[180:183]
    s_lshl_b32 s76, s76, 14
    v_mfma_f32_16x16x32_bf16 v[184:187], a[24:27], v[220:223], v[184:187]
    s_lshl_b32 s77, s68, 7
    v_mfma_f32_16x16x32_bf16 v[188:191], a[28:31], v[220:223], v[188:191]
    s_waitcnt vmcnt(10)
    v_mfma_f32_16x16x32_bf16 v[128:131], a[32:35], v[224:227], v[128:131]
    buffer_load_dwordx4 v[208:211], v22, s[52:55], s88 offen offset:0 sc1
    v_mfma_f32_16x16x32_bf16 v[132:135], a[36:39], v[224:227], v[132:135]
    s_add_u32 s76, s76, s77
    v_mfma_f32_16x16x32_bf16 v[136:139], a[40:43], v[224:227], v[136:139]
    s_add_u32 s77, s76, 8192
    v_mfma_f32_16x16x32_bf16 v[140:143], a[44:47], v[224:227], v[140:143]
    v_mfma_f32_16x16x32_bf16 v[144:147], a[32:35], v[228:231], v[144:147]
    buffer_load_dwordx4 v[212:215], v22, s[52:55], s88 offen offset:256 sc1
    v_mfma_f32_16x16x32_bf16 v[148:151], a[36:39], v[228:231], v[148:151]
    buffer_load_dwordx4 v[64:67], v18, s[24:27], s76 offen
    v_mfma_f32_16x16x32_bf16 v[152:155], a[40:43], v[228:231], v[152:155]
    buffer_load_dwordx4 v[68:71], v18, s[24:27], s77 offen
    v_mfma_f32_16x16x32_bf16 v[156:159], a[44:47], v[228:231], v[156:159]
    s_waitcnt vmcnt(12)
    v_mfma_f32_16x16x32_bf16 v[160:163], a[32:35], v[232:235], v[160:163]
    buffer_load_dwordx4 v[216:219], v22, s[52:55], s88 offen offset:1024 sc1
    v_mfma_f32_16x16x32_bf16 v[164:167], a[36:39], v[232:235], v[164:167]
    v_and_b32 v4, 15, v1
    v_mfma_f32_16x16x32_bf16 v[168:171], a[40:43], v[232:235], v[168:171]
    v_lshlrev_b32 v4, 8, v4
    v_mfma_f32_16x16x32_bf16 v[172:175], a[44:47], v[232:235], v[172:175]
    v_mfma_f32_16x16x32_bf16 v[176:179], a[32:35], v[236:239], v[176:179]
    buffer_load_dwordx4 v[220:223], v22, s[52:55], s88 offen offset:1280 sc1
    s_add_u32 s88, s88, 4096
    v_mfma_f32_16x16x32_bf16 v[180:183], a[36:39], v[236:239], v[180:183]
    v_lshrrev_b32 v0, 4, v1
    v_mfma_f32_16x16x32_bf16 v[184:187], a[40:43], v[236:239], v[184:187]
    v_xor_b32 v0, v0, v1
    v_mfma_f32_16x16x32_bf16 v[188:191], a[44:47], v[236:239], v[188:191]
    s_waitcnt vmcnt(12)
    v_mfma_f32_16x16x32_bf16 v[128:131], a[48:51], v[240:243], v[128:131]
    buffer_load_dwordx4 v[224:227], v22, s[52:55], s88 offen offset:0 sc1
    v_mfma_f32_16x16x32_bf16 v[132:135], a[52:55], v[240:243], v[132:135]
    v_and_b32 v0, 7, v0
    v_mfma_f32_16x16x32_bf16 v[136:139], a[56:59], v[240:243], v[136:139]
    v_lshl_add_u32 v4, v0, 4, v4
    v_mfma_f32_16x16x32_bf16 v[140:143], a[60:63], v[240:243], v[140:143]
    v_mfma_f32_16x16x32_bf16 v[144:147], a[48:51], v[244:247], v[144:147]
    buffer_load_dwordx4 v[228:231], v22, s[52:55], s88 offen offset:256 sc1
    v_mfma_f32_16x16x32_bf16 v[148:151], a[52:55], v[244:247], v[148:151]
    v_add_u32 v4, s71, v4
    v_mfma_f32_16x16x32_bf16 v[152:155], a[56:59], v[244:247], v[152:155]
    v_xor_b32 v5, 64, v4
    v_mfma_f32_16x16x32_bf16 v[156:159], a[60:63], v[244:247], v[156:159]
    s_waitcnt vmcnt(12)
    v_mfma_f32_16x16x32_bf16 v[160:163], a[48:51], v[248:251], v[160:163]
    buffer_load_dwordx4 v[232:235], v22, s[52:55], s88 offen offset:1024 sc1
    v_mfma_f32_16x16x32_bf16 v[164:167], a[52:55], v[248:251], v[164:167]
    v_lshrrev_b32 v0, 3, v1
    v_mfma_f32_16x16x32_bf16 v[168:171], a[56:59], v[248:251], v[168:171]
    v_lshlrev_b32 v12, 8, v0
    v_mfma_f32_16x16x32_bf16 v[172:175], a[60:63], v[248:251], v[172:175]
    v_mfma_f32_16x16x32_bf16 v[176:179], a[48:51], v[252:255], v[176:179]
    buffer_load_dwordx4 v[236:239], v22, s[52:55], s88 offen offset:1280 sc1
    s_add_u32 s88, s88, 4096
    v_mfma_f32_16x16x32_bf16 v[180:183], a[52:55], v[252:255], v[180:183]
    v_and_b32 v13, 7, v1
    v_mfma_f32_16x16x32_bf16 v[184:187], a[56:59], v[252:255], v[184:187]
    v_lshlrev_b32 v13, 1, v13
    v_mfma_f32_16x16x32_bf16 v[188:191], a[60:63], v[252:255], v[188:191]
    s_waitcnt vmcnt(12)
    v_mfma_f32_16x16x32_bf16 v[128:131], a[64:67], v[192:195], v[128:131]
    buffer_load_dwordx4 v[240:243], v22, s[52:55], s88 offen offset:0 sc1
    v_mfma_f32_16x16x32_bf16 v[132:135], a[68:71], v[192:195], v[132:135]
    v_xor_b32 v0, v0, v13
    v_mfma_f32_16x16x32_bf16 v[136:139], a[72:75], v[192:195], v[136:139]
    v_lshl_add_u32 v12, v0, 4, v12
    v_mfma_f32_16x16x32_bf16 v[140:143], a[76:79], v[192:195], v[140:143]
    v_mfma_f32_16x16x32_bf16 v[144:147], a[64:67], v[196:199], v[144:147]
    buffer_load_dwordx4 v[244:247], v22, s[52:55], s88 offen offset:256 sc1
    v_mfma_f32_16x16x32_bf16 v[148:151], a[68:71], v[196:199], v[148:151]
    s_lshl_b32 s78, s60, 14
    v_mfma_f32_16x16x32_bf16 v[152:155], a[72:75], v[196:199], v[152:155]
    v_add_u32 v12, s78, v12
    v_mfma_f32_16x16x32_bf16 v[156:159], a[76:79], v[196:199], v[156:159]
    s_waitcnt vmcnt(12)
    v_mfma_f32_16x16x32_bf16 v[160:163], a[64:67], v[200:203], v[160:163]
    buffer_load_dwordx4 v[248:251], v22, s[52:55], s88 offen offset:1024 sc1
    v_mfma_f32_16x16x32_bf16 v[164:167], a[68:71], v[200:203], v[164:167]
    v_xor_b32 v13, 16, v12
    v_mfma_f32_16x16x32_bf16 v[168:171], a[72:75], v[200:203], v[168:171]
    s_mov_b32 s78, 0xbfb8aa3b
    v_mfma_f32_16x16x32_bf16 v[172:175], a[76:79], v[200:203], v[172:175]
    v_mfma_f32_16x16x32_bf16 v[176:179], a[64:67], v[204:207], v[176:179]
    buffer_load_dwordx4 v[252:255], v22, s[52:55], s88 offen offset:1280 sc1
    s_add_u32 s88, s88, 4096
    v_mfma_f32_16x16x32_bf16 v[180:183], a[68:71], v[204:207], v[180:183]
    s_mov_b32 s79, 0xbfb8aa3b
    v_mfma_f32_16x16x32_bf16 v[184:187], a[72:75], v[204:207], v[184:187]
    v_mfma_f32_16x16x32_bf16 v[188:191], a[76:79], v[204:207], v[188:191]
    s_waitcnt vmcnt(12)
    v_mfma_f32_16x16x32_bf16 v[128:131], a[80:83], v[208:211], v[128:131]
    buffer_load_dwordx4 v[192:195], v22, s[52:55], s88 offen offset:0 sc1
    v_mfma_f32_16x16x32_bf16 v[132:135], a[84:87], v[208:211], v[132:135]
    v_mfma_f32_16x16x32_bf16 v[136:139], a[88:91], v[208:211], v[136:139]
    v_mfma_f32_16x16x32_bf16 v[140:143], a[92:95], v[208:211], v[140:143]
    v_mfma_f32_16x16x32_bf16 v[144:147], a[80:83], v[212:215], v[144:147]
    buffer_load_dwordx4 v[196:199], v22, s[52:55], s88 offen offset:256 sc1
    v_mfma_f32_16x16x32_bf16 v[148:151], a[84:87], v[212:215], v[148:151]
    v_mfma_f32_16x16x32_bf16 v[152:155], a[88:91], v[212:215], v[152:155]
    v_mfma_f32_16x16x32_bf16 v[156:159], a[92:95], v[212:215], v[156:159]
    s_waitcnt vmcnt(10)
    v_mfma_f32_16x16x32_bf16 v[160:163], a[80:83], v[216:219], v[160:163]
    buffer_load_dwordx4 v[200:203], v22, s[52:55], s88 offen offset:1024 sc1
    v_mfma_f32_16x16x32_bf16 v[164:167], a[84:87], v[216:219], v[164:167]
    v_mfma_f32_16x16x32_bf16 v[168:171], a[88:91], v[216:219], v[168:171]
    v_mfma_f32_16x16x32_bf16 v[172:175], a[92:95], v[216:219], v[172:175]
    v_mfma_f32_16x16x32_bf16 v[176:179], a[80:83], v[220:223], v[176:179]
    buffer_load_dwordx4 v[204:207], v22, s[52:55], s88 offen offset:1280 sc1
    s_add_u32 s88, s88, 4096
    v_mfma_f32_16x16x32_bf16 v[180:183], a[84:87], v[220:223], v[180:183]
    v_mfma_f32_16x16x32_bf16 v[184:187], a[88:91], v[220:223], v[184:187]
    v_mfma_f32_16x16x32_bf16 v[188:191], a[92:95], v[220:223], v[188:191]
    s_waitcnt vmcnt(10)
    v_mfma_f32_16x16x32_bf16 v[128:131], a[96:99], v[224:227], v[128:131]
    s_sub_u32 s88, s88, s9
    buffer_load_dwordx4 v[208:211], v22, s[52:55], s88 offen offset:0 sc1
    v_mfma_f32_16x16x32_bf16 v[132:135], a[100:103], v[224:227], v[132:135]
    v_mfma_f32_16x16x32_bf16 v[136:139], a[104:107], v[224:227], v[136:139]
    v_mfma_f32_16x16x32_bf16 v[140:143], a[108:111], v[224:227], v[140:143]
    v_mfma_f32_16x16x32_bf16 v[144:147], a[96:99], v[228:231], v[144:147]
    buffer_load_dwordx4 v[212:215], v22, s[52:55], s88 offen offset:256 sc1
    v_mfma_f32_16x16x32_bf16 v[148:151], a[100:103], v[228:231], v[148:151]
    v_mfma_f32_16x16x32_bf16 v[152:155], a[104:107], v[228:231], v[152:155]
    v_mfma_f32_16x16x32_bf16 v[156:159], a[108:111], v[228:231], v[156:159]
    s_waitcnt vmcnt(10)
    v_mfma_f32_16x16x32_bf16 v[160:163], a[96:99], v[232:235], v[160:163]
    buffer_load_dwordx4 v[216:219], v22, s[52:55], s88 offen offset:1024 sc1
    v_mfma_f32_16x16x32_bf16 v[164:167], a[100:103], v[232:235], v[164:167]
    v_mfma_f32_16x16x32_bf16 v[168:171], a[104:107], v[232:235], v[168:171]
    v_mfma_f32_16x16x32_bf16 v[172:175], a[108:111], v[232:235], v[172:175]
    v_mfma_f32_16x16x32_bf16 v[176:179], a[96:99], v[236:239], v[176:179]
    buffer_load_dwordx4 v[220:223], v22, s[52:55], s88 offen offset:1280 sc1
    s_add_u32 s88, s88, 4096
    v_mfma_f32_16x16x32_bf16 v[180:183], a[100:103], v[236:239], v[180:183]
    v_mfma_f32_16x16x32_bf16 v[184:187], a[104:107], v[236:239], v[184:187]
    v_mfma_f32_16x16x32_bf16 v[188:191], a[108:111], v[236:239], v[188:191]
    s_waitcnt vmcnt(10)
    v_mfma_f32_16x16x32_bf16 v[128:131], a[112:115], v[240:243], v[128:131]
    buffer_load_dwordx4 v[224:227], v22, s[52:55], s88 offen offset:0 sc1
    v_mfma_f32_16x16x32_bf16 v[132:135], a[116:119], v[240:243], v[132:135]
    v_mfma_f32_16x16x32_bf16 v[136:139], a[120:123], v[240:243], v[136:139]
    v_mfma_f32_16x16x32_bf16 v[140:143], a[124:127], v[240:243], v[140:143]
    v_mfma_f32_16x16x32_bf16 v[144:147], a[112:115], v[244:247], v[144:147]
    buffer_load_dwordx4 v[228:231], v22, s[52:55], s88 offen offset:256 sc1
    v_mfma_f32_16x16x32_bf16 v[148:151], a[116:119], v[244:247], v[148:151]
    v_mfma_f32_16x16x32_bf16 v[152:155], a[120:123], v[244:247], v[152:155]
    v_mfma_f32_16x16x32_bf16 v[156:159], a[124:127], v[244:247], v[156:159]
    s_waitcnt vmcnt(10)
    v_mfma_f32_16x16x32_bf16 v[160:163], a[112:115], v[248:251], v[160:163]
    buffer_load_dwordx4 v[232:235], v22, s[52:55], s88 offen offset:1024 sc1
    v_mfma_f32_16x16x32_bf16 v[164:167], a[116:119], v[248:251], v[164:167]
    v_mfma_f32_16x16x32_bf16 v[168:171], a[120:123], v[248:251], v[168:171]
    v_mfma_f32_16x16x32_bf16 v[172:175], a[124:127], v[248:251], v[172:175]
    v_mfma_f32_16x16x32_bf16 v[176:179], a[112:115], v[252:255], v[176:179]
    buffer_load_dwordx4 v[236:239], v22, s[52:55], s88 offen offset:1280 sc1
    s_add_u32 s88, s88, 4096
    v_mfma_f32_16x16x32_bf16 v[180:183], a[116:119], v[252:255], v[180:183]
    v_mfma_f32_16x16x32_bf16 v[184:187], a[120:123], v[252:255], v[184:187]
    v_mfma_f32_16x16x32_bf16 v[188:191], a[124:127], v[252:255], v[188:191]
    s_waitcnt vmcnt(10)
    v_mfma_f32_16x16x32_bf16 v[128:131], a[128:131], v[192:195], v[128:131]
    buffer_load_dwordx4 v[240:243], v22, s[52:55], s88 offen offset:0 sc1
    v_mfma_f32_16x16x32_bf16 v[132:135], a[132:135], v[192:195], v[132:135]
    v_lshlrev_b32 v24, 16, v64
    v_mfma_f32_16x16x32_bf16 v[136:139], a[136:139], v[192:195], v[136:139]
    v_and_b32 v25, 0xffff0000, v64
    v_mfma_f32_16x16x32_bf16 v[140:143], a[140:143], v[192:195], v[140:143]
    v_lshlrev_b32 v26, 16, v65
    v_mfma_f32_16x16x32_bf16 v[144:147], a[128:131], v[196:199], v[144:147]
    buffer_load_dwordx4 v[244:247], v22, s[52:55], s88 offen offset:256 sc1
    v_mfma_f32_16x16x32_bf16 v[148:151], a[132:135], v[196:199], v[148:151]
    v_and_b32 v27, 0xffff0000, v65
    v_mfma_f32_16x16x32_bf16 v[152:155], a[136:139], v[196:199], v[152:155]
    v_lshlrev_b32 v28, 16, v66
    v_mfma_f32_16x16x32_bf16 v[156:159], a[140:143], v[196:199], v[156:159]
    v_and_b32 v29, 0xffff0000, v66
    s_waitcnt vmcnt(10)
    v_mfma_f32_16x16x32_bf16 v[160:163], a[128:131], v[200:203], v[160:163]
    buffer_load_dwordx4 v[248:251], v22, s[52:55], s88 offen offset:1024 sc1
    v_mfma_f32_16x16x32_bf16 v[164:167], a[132:135], v[200:203], v[164:167]
    v_lshlrev_b32 v30, 16, v67
    v_mfma_f32_16x16x32_bf16 v[168:171], a[136:139], v[200:203], v[168:171]
    v_and_b32 v31, 0xffff0000, v67
    v_mfma_f32_16x16x32_bf16 v[172:175], a[140:143], v[200:203], v[172:175]
    v_lshlrev_b32 v32, 16, v68
    v_mfma_f32_16x16x32_bf16 v[176:179], a[128:131], v[204:207], v[176:179]
    buffer_load_dwordx4 v[252:255], v22, s[52:55], s88 offen offset:1280 sc1
    s_add_u32 s88, s88, 4096
    v_mfma_f32_16x16x32_bf16 v[180:183], a[132:135], v[204:207], v[180:183]
    v_and_b32 v33, 0xffff0000, v68
    v_mfma_f32_16x16x32_bf16 v[184:187], a[136:139], v[204:207], v[184:187]
    v_lshlrev_b32 v34, 16, v69
    v_mfma_f32_16x16x32_bf16 v[188:191], a[140:143], v[204:207], v[188:191]
    v_and_b32 v35, 0xffff0000, v69
    s_waitcnt vmcnt(10)
    v_mfma_f32_16x16x32_bf16 v[128:131], a[144:147], v[208:211], v[128:131]
    buffer_load_dwordx4 v[192:195], v22, s[52:55], s88 offen offset:0 sc1
    v_mfma_f32_16x16x32_bf16 v[132:135], a[148:151], v[208:211], v[132:135]
    v_lshlrev_b32 v36, 16, v70
    v_mfma_f32_16x16x32_bf16 v[136:139], a[152:155], v[208:211], v[136:139]
    v_and_b32 v37, 0xffff0000, v70
    v_mfma_f32_16x16x32_bf16 v[140:143], a[156:159], v[208:211], v[140:143]
    v_lshlrev_b32 v38, 16, v71
    v_mfma_f32_16x16x32_bf16 v[144:147], a[144:147], v[212:215], v[144:147]
    buffer_load_dwordx4 v[196:199], v22, s[52:55], s88 offen offset:256 sc1
    v_mfma_f32_16x16x32_bf16 v[148:151], a[148:151], v[212:215], v[148:151]
    v_and_b32 v39, 0xffff0000, v71
    v_mfma_f32_16x16x32_bf16 v[152:155], a[152:155], v[212:215], v[152:155]
    v_mfma_f32_16x16x32_bf16 v[156:159], a[156:159], v[212:215], v[156:159]
    s_waitcnt vmcnt(10)
    v_mfma_f32_16x16x32_bf16 v[160:163], a[144:147], v[216:219], v[160:163]
    buffer_load_dwordx4 v[200:203], v22, s[52:55], s88 offen offset:1024 sc1
    v_mfma_f32_16x16x32_bf16 v[164:167], a[148:151], v[216:219], v[164:167]
    v_mfma_f32_16x16x32_bf16 v[168:171], a[152:155], v[216:219], v[168:171]
    v_mfma_f32_16x16x32_bf16 v[172:175], a[156:159], v[216:219], v[172:175]
    v_mfma_f32_16x16x32_bf16 v[176:179], a[144:147], v[220:223], v[176:179]
    buffer_load_dwordx4 v[204:207], v22, s[52:55], s88 offen offset:1280 sc1
    s_add_u32 s88, s88, 4096
    v_mfma_f32_16x16x32_bf16 v[180:183], a[148:151], v[220:223], v[180:183]
    v_mfma_f32_16x16x32_bf16 v[184:187], a[152:155], v[220:223], v[184:187]
    v_mfma_f32_16x16x32_bf16 v[188:191], a[156:159], v[220:223], v[188:191]
    s_waitcnt vmcnt(10)
    v_mfma_f32_16x16x32_bf16 v[128:131], a[160:163], v[224:227], v[128:131]
    buffer_load_dwordx4 v[208:211], v22, s[52:55], s88 offen offset:0 sc1
    v_mfma_f32_16x16x32_bf16 v[132:135], a[164:167], v[224:227], v[132:135]
    v_mfma_f32_16x16x32_bf16 v[136:139], a[168:171], v[224:227], v[136:139]
    v_mfma_f32_16x16x32_bf16 v[140:143], a[172:175], v[224:227], v[140:143]
    v_mfma_f32_16x16x32_bf16 v[144:147], a[160:163], v[228:231], v[144:147]
    buffer_load_dwordx4 v[212:215], v22, s[52:55], s88 offen offset:256 sc1
    v_mfma_f32_16x16x32_bf16 v[148:151], a[164:167], v[228:231], v[148:151]
    v_mfma_f32_16x16x32_bf16 v[152:155], a[168:171], v[228:231], v[152:155]
    v_mfma_f32_16x16x32_bf16 v[156:159], a[172:175], v[228:231], v[156:159]
    s_waitcnt vmcnt(10)
    v_mfma_f32_16x16x32_bf16 v[160:163], a[160:163], v[232:235], v[160:163]
    buffer_load_dwordx4 v[216:219], v22, s[52:55], s88 offen offset:1024 sc1
    v_mfma_f32_16x16x32_bf16 v[164:167], a[164:167], v[232:235], v[164:167]
    v_mfma_f32_16x16x32_bf16 v[168:171], a[168:171], v[232:235], v[168:171]
    v_mfma_f32_16x16x32_bf16 v[172:175], a[172:175], v[232:235], v[172:175]
    v_mfma_f32_16x16x32_bf16 v[176:179], a[160:163], v[236:239], v[176:179]
    buffer_load_dwordx4 v[220:223], v22, s[52:55], s88 offen offset:1280 sc1
    s_add_u32 s88, s88, 4096
    v_mfma_f32_16x16x32_bf16 v[180:183], a[164:167], v[236:239], v[180:183]
    v_mfma_f32_16x16x32_bf16 v[184:187], a[168:171], v[236:239], v[184:187]
    v_mfma_f32_16x16x32_bf16 v[188:191], a[172:175], v[236:239], v[188:191]
    s_waitcnt vmcnt(10)
    v_mfma_f32_16x16x32_bf16 v[128:131], a[176:179], v[240:243], v[128:131]
    buffer_load_dwordx4 v[224:227], v22, s[52:55], s88 offen offset:0 sc1
    v_mfma_f32_16x16x32_bf16 v[132:135], a[180:183], v[240:243], v[132:135]
    v_mfma_f32_16x16x32_bf16 v[136:139], a[184:187], v[240:243], v[136:139]
    v_mfma_f32_16x16x32_bf16 v[140:143], a[188:191], v[240:243], v[140:143]
    v_mfma_f32_16x16x32_bf16 v[144:147], a[176:179], v[244:247], v[144:147]
    buffer_load_dwordx4 v[228:231], v22, s[52:55], s88 offen offset:256 sc1
    v_mfma_f32_16x16x32_bf16 v[148:151], a[180:183], v[244:247], v[148:151]
    v_mfma_f32_16x16x32_bf16 v[152:155], a[184:187], v[244:247], v[152:155]
    v_mfma_f32_16x16x32_bf16 v[156:159], a[188:191], v[244:247], v[156:159]
    s_waitcnt vmcnt(10)
    v_mfma_f32_16x16x32_bf16 v[160:163], a[176:179], v[248:251], v[160:163]
    buffer_load_dwordx4 v[232:235], v22, s[52:55], s88 offen offset:1024 sc1
    v_mfma_f32_16x16x32_bf16 v[164:167], a[180:183], v[248:251], v[164:167]
    v_mfma_f32_16x16x32_bf16 v[168:171], a[184:187], v[248:251], v[168:171]
    v_mfma_f32_16x16x32_bf16 v[172:175], a[188:191], v[248:251], v[172:175]
    v_mfma_f32_16x16x32_bf16 v[176:179], a[176:179], v[252:255], v[176:179]
    buffer_load_dwordx4 v[236:239], v22, s[52:55], s88 offen offset:1280 sc1
    s_add_u32 s88, s88, 4096
    v_mfma_f32_16x16x32_bf16 v[180:183], a[180:183], v[252:255], v[180:183]
    v_mfma_f32_16x16x32_bf16 v[184:187], a[184:187], v[252:255], v[184:187]
    v_mfma_f32_16x16x32_bf16 v[188:191], a[188:191], v[252:255], v[188:191]
    s_waitcnt vmcnt(10)
    v_mfma_f32_16x16x32_bf16 v[128:131], a[192:195], v[192:195], v[128:131]
    buffer_load_dwordx4 v[240:243], v22, s[52:55], s88 offen offset:0 sc1
    v_mfma_f32_16x16x32_bf16 v[132:135], a[196:199], v[192:195], v[132:135]
    v_mfma_f32_16x16x32_bf16 v[136:139], a[200:203], v[192:195], v[136:139]
    v_mfma_f32_16x16x32_bf16 v[140:143], a[204:207], v[192:195], v[140:143]
    v_mfma_f32_16x16x32_bf16 v[144:147], a[192:195], v[196:199], v[144:147]
    buffer_load_dwordx4 v[244:247], v22, s[52:55], s88 offen offset:256 sc1
    v_mfma_f32_16x16x32_bf16 v[148:151], a[196:199], v[196:199], v[148:151]
    v_mfma_f32_16x16x32_bf16 v[152:155], a[200:203], v[196:199], v[152:155]
    v_mfma_f32_16x16x32_bf16 v[156:159], a[204:207], v[196:199], v[156:159]
    s_waitcnt vmcnt(10)
    v_mfma_f32_16x16x32_bf16 v[160:163], a[192:195], v[200:203], v[160:163]
    buffer_load_dwordx4 v[248:251], v22, s[52:55], s88 offen offset:1024 sc1
    v_mfma_f32_16x16x32_bf16 v[164:167], a[196:199], v[200:203], v[164:167]
    v_mfma_f32_16x16x32_bf16 v[168:171], a[200:203], v[200:203], v[168:171]
    v_mfma_f32_16x16x32_bf16 v[172:175], a[204:207], v[200:203], v[172:175]
    v_mfma_f32_16x16x32_bf16 v[176:179], a[192:195], v[204:207], v[176:179]
    buffer_load_dwordx4 v[252:255], v22, s[52:55], s88 offen offset:1280 sc1
    s_add_u32 s88, s88, 4096
    v_mfma_f32_16x16x32_bf16 v[180:183], a[196:199], v[204:207], v[180:183]
    v_mfma_f32_16x16x32_bf16 v[184:187], a[200:203], v[204:207], v[184:187]
    v_mfma_f32_16x16x32_bf16 v[188:191], a[204:207], v[204:207], v[188:191]
    s_cmp_eq_u32 s60, 0
    s_cbranch_scc1 L_w13
    s_waitcnt vmcnt(10)
    v_mfma_f32_16x16x32_bf16 v[128:131], a[208:211], v[208:211], v[128:131]
    buffer_load_dwordx4 v[192:195], v22, s[52:55], s88 offen offset:0 sc1
    v_mfma_f32_16x16x32_bf16 v[132:135], a[212:215], v[208:211], v[132:135]
    v_mfma_f32_16x16x32_bf16 v[136:139], a[216:219], v[208:211], v[136:139]
    v_mfma_f32_16x16x32_bf16 v[140:143], a[220:223], v[208:211], v[140:143]
    v_mfma_f32_16x16x32_bf16 v[144:147], a[208:211], v[212:215], v[144:147]
    buffer_load_dwordx4 v[196:199], v22, s[52:55], s88 offen offset:256 sc1
    v_mfma_f32_16x16x32_bf16 v[148:151], a[212:215], v[212:215], v[148:151]
    v_mfma_f32_16x16x32_bf16 v[152:155], a[216:219], v[212:215], v[152:155]
    v_mfma_f32_16x16x32_bf16 v[156:159], a[220:223], v[212:215], v[156:159]
    s_waitcnt vmcnt(10)
    v_mfma_f32_16x16x32_bf16 v[160:163], a[208:211], v[216:219], v[160:163]
    buffer_load_dwordx4 v[200:203], v22, s[52:55], s88 offen offset:1024 sc1
    v_mfma_f32_16x16x32_bf16 v[164:167], a[212:215], v[216:219], v[164:167]
    v_mfma_f32_16x16x32_bf16 v[168:171], a[216:219], v[216:219], v[168:171]
    v_mfma_f32_16x16x32_bf16 v[172:175], a[220:223], v[216:219], v[172:175]
    v_mfma_f32_16x16x32_bf16 v[176:179], a[208:211], v[220:223], v[176:179]
    buffer_load_dwordx4 v[204:207], v22, s[52:55], s88 offen offset:1280 sc1
    s_add_u32 s88, s88, 4096
    v_mfma_f32_16x16x32_bf16 v[180:183], a[212:215], v[220:223], v[180:183]
    v_mfma_f32_16x16x32_bf16 v[184:187], a[216:219], v[220:223], v[184:187]
    v_mfma_f32_16x16x32_bf16 v[188:191], a[220:223], v[220:223], v[188:191]
    s_waitcnt vmcnt(10)
    v_mfma_f32_16x16x32_bf16 v[128:131], a[224:227], v[224:227], v[128:131]
    buffer_load_dwordx4 v[208:211], v22, s[52:55], s88 offen offset:0 sc1
    v_mfma_f32_16x16x32_bf16 v[132:135], a[228:231], v[224:227], v[132:135]
    v_mfma_f32_16x16x32_bf16 v[136:139], a[232:235], v[224:227], v[136:139]
    v_mfma_f32_16x16x32_bf16 v[140:143], a[236:239], v[224:227], v[140:143]
    v_mfma_f32_16x16x32_bf16 v[144:147], a[224:227], v[228:231], v[144:147]
    buffer_load_dwordx4 v[212:215], v22, s[52:55], s88 offen offset:256 sc1
    v_mfma_f32_16x16x32_bf16 v[148:151], a[228:231], v[228:231], v[148:151]
    v_mfma_f32_16x16x32_bf16 v[152:155], a[232:235], v[228:231], v[152:155]
    v_mfma_f32_16x16x32_bf16 v[156:159], a[236:239], v[228:231], v[156:159]
    s_waitcnt vmcnt(10)
    v_mfma_f32_16x16x32_bf16 v[160:163], a[224:227], v[232:235], v[160:163]
    buffer_load_dwordx4 v[216:219], v22, s[52:55], s88 offen offset:1024 sc1
    v_mfma_f32_16x16x32_bf16 v[164:167], a[228:231], v[232:235], v[164:167]
    v_mfma_f32_16x16x32_bf16 v[168:171], a[232:235], v[232:235], v[168:171]
    v_mfma_f32_16x16x32_bf16 v[172:175], a[236:239], v[232:235], v[172:175]
    v_mfma_f32_16x16x32_bf16 v[176:179], a[224:227], v[236:239], v[176:179]
    buffer_load_dwordx4 v[220:223], v22, s[52:55], s88 offen offset:1280 sc1
    s_add_u32 s88, s88, 4096
    v_mfma_f32_16x16x32_bf16 v[180:183], a[228:231], v[236:239], v[180:183]
    v_mfma_f32_16x16x32_bf16 v[184:187], a[232:235], v[236:239], v[184:187]
    v_mfma_f32_16x16x32_bf16 v[188:191], a[236:239], v[236:239], v[188:191]
    s_cmp_eq_u32 s60, 3
    s_cbranch_scc1 L_w15
    s_waitcnt vmcnt(10)
    v_mfma_f32_16x16x32_bf16 v[128:131], a[240:243], v[240:243], v[128:131]
    buffer_load_dwordx4 v[224:227], v22, s[52:55], s88 offen offset:0 sc1
    v_mfma_f32_16x16x32_bf16 v[132:135], a[244:247], v[240:243], v[132:135]
    v_mfma_f32_16x16x32_bf16 v[136:139], a[248:251], v[240:243], v[136:139]
    v_mfma_f32_16x16x32_bf16 v[140:143], a[252:255], v[240:243], v[140:143]
    v_mfma_f32_16x16x32_bf16 v[144:147], a[240:243], v[244:247], v[144:147]
    buffer_load_dwordx4 v[228:231], v22, s[52:55], s88 offen offset:256 sc1
    v_mfma_f32_16x16x32_bf16 v[148:151], a[244:247], v[244:247], v[148:151]
    v_mfma_f32_16x16x32_bf16 v[152:155], a[248:251], v[244:247], v[152:155]
    v_mfma_f32_16x16x32_bf16 v[156:159], a[252:255], v[244:247], v[156:159]
    s_waitcnt vmcnt(10)
    v_mfma_f32_16x16x32_bf16 v[160:163], a[240:243], v[248:251], v[160:163]
    buffer_load_dwordx4 v[232:235], v22, s[52:55], s88 offen offset:1024 sc1
    v_mfma_f32_16x16x32_bf16 v[164:167], a[244:247], v[248:251], v[164:167]
    v_mfma_f32_16x16x32_bf16 v[168:171], a[248:251], v[248:251], v[168:171]
    v_mfma_f32_16x16x32_bf16 v[172:175], a[252:255], v[248:251], v[172:175]
    v_mfma_f32_16x16x32_bf16 v[176:179], a[240:243], v[252:255], v[176:179]
    buffer_load_dwordx4 v[236:239], v22, s[52:55], s88 offen offset:1280 sc1
    s_add_u32 s88, s88, 4096
    v_mfma_f32_16x16x32_bf16 v[180:183], a[244:247], v[252:255], v[180:183]
    v_mfma_f32_16x16x32_bf16 v[184:187], a[248:251], v[252:255], v[184:187]
    v_mfma_f32_16x16x32_bf16 v[188:191], a[252:255], v[252:255], v[188:191]
    s_waitcnt vmcnt(10)
    v_mfma_f32_16x16x32_bf16 v[128:131], v[72:75], v[192:195], v[128:131]
    v_mfma_f32_16x16x32_bf16 v[132:135], v[76:79], v[192:195], v[132:135]
    v_mfma_f32_16x16x32_bf16 v[136:139], v[80:83], v[192:195], v[136:139]
    v_mfma_f32_16x16x32_bf16 v[140:143], v[84:87], v[192:195], v[140:143]
    v_mfma_f32_16x16x32_bf16 v[144:147], v[72:75], v[196:199], v[144:147]
    v_mfma_f32_16x16x32_bf16 v[148:151], v[76:79], v[196:199], v[148:151]
    v_mfma_f32_16x16x32_bf16 v[152:155], v[80:83], v[196:199], v[152:155]
    v_mfma_f32_16x16x32_bf16 v[156:159], v[84:87], v[196:199], v[156:159]
    s_waitcnt vmcnt(8)
    v_mfma_f32_16x16x32_bf16 v[160:163], v[72:75], v[200:203], v[160:163]
    v_mfma_f32_16x16x32_bf16 v[164:167], v[76:79], v[200:203], v[164:167]
    v_mfma_f32_16x16x32_bf16 v[168:171], v[80:83], v[200:203], v[168:171]
    v_mfma_f32_16x16x32_bf16 v[172:175], v[84:87], v[200:203], v[172:175]
    v_mfma_f32_16x16x32_bf16 v[176:179], v[72:75], v[204:207], v[176:179]
    v_mfma_f32_16x16x32_bf16 v[180:183], v[76:79], v[204:207], v[180:183]
    v_mfma_f32_16x16x32_bf16 v[184:187], v[80:83], v[204:207], v[184:187]
    v_mfma_f32_16x16x32_bf16 v[188:191], v[84:87], v[204:207], v[188:191]
    s_waitcnt vmcnt(6)
    v_mfma_f32_16x16x32_bf16 v[128:131], v[88:91], v[208:211], v[128:131]
    v_mfma_f32_16x16x32_bf16 v[132:135], v[92:95], v[208:211], v[132:135]
    v_mfma_f32_16x16x32_bf16 v[136:139], v[96:99], v[208:211], v[136:139]
    v_mfma_f32_16x16x32_bf16 v[140:143], v[100:103], v[208:211], v[140:143]
    v_mfma_f32_16x16x32_bf16 v[144:147], v[88:91], v[212:215], v[144:147]
    v_mfma_f32_16x16x32_bf16 v[148:151], v[92:95], v[212:215], v[148:151]
    v_mfma_f32_16x16x32_bf16 v[152:155], v[96:99], v[212:215], v[152:155]
    v_mfma_f32_16x16x32_bf16 v[156:159], v[100:103], v[212:215], v[156:159]
    s_waitcnt vmcnt(4)
    v_mfma_f32_16x16x32_bf16 v[160:163], v[88:91], v[216:219], v[160:163]
    v_mfma_f32_16x16x32_bf16 v[164:167], v[92:95], v[216:219], v[164:167]
    v_mfma_f32_16x16x32_bf16 v[168:171], v[96:99], v[216:219], v[168:171]
    v_mfma_f32_16x16x32_bf16 v[172:175], v[100:103], v[216:219], v[172:175]
    v_mfma_f32_16x16x32_bf16 v[176:179], v[88:91], v[220:223], v[176:179]
    v_mfma_f32_16x16x32_bf16 v[180:183], v[92:95], v[220:223], v[180:183]
    v_mfma_f32_16x16x32_bf16 v[184:187], v[96:99], v[220:223], v[184:187]
    v_mfma_f32_16x16x32_bf16 v[188:191], v[100:103], v[220:223], v[188:191]
    s_waitcnt vmcnt(2)
    v_mfma_f32_16x16x32_bf16 v[128:131], v[104:107], v[224:227], v[128:131]
    v_mfma_f32_16x16x32_bf16 v[132:135], v[108:111], v[224:227], v[132:135]
    v_mfma_f32_16x16x32_bf16 v[136:139], v[112:115], v[224:227], v[136:139]
    v_mfma_f32_16x16x32_bf16 v[140:143], v[116:119], v[224:227], v[140:143]
    v_mfma_f32_16x16x32_bf16 v[144:147], v[104:107], v[228:231], v[144:147]
    v_mfma_f32_16x16x32_bf16 v[148:151], v[108:111], v[228:231], v[148:151]
    v_mfma_f32_16x16x32_bf16 v[152:155], v[112:115], v[228:231], v[152:155]
    v_mfma_f32_16x16x32_bf16 v[156:159], v[116:119], v[228:231], v[156:159]
    s_waitcnt vmcnt(0)
    v_mfma_f32_16x16x32_bf16 v[160:163], v[104:107], v[232:235], v[160:163]
    ds_write_b128 v4, v[128:131] offset:0
    v_mfma_f32_16x16x32_bf16 v[164:167], v[108:111], v[232:235], v[164:167]
    ds_write_b128 v5, v[132:135] offset:0
    v_mfma_f32_16x16x32_bf16 v[168:171], v[112:115], v[232:235], v[168:171]
    ds_write_b128 v4, v[136:139] offset:128
    v_mfma_f32_16x16x32_bf16 v[172:175], v[116:119], v[232:235], v[172:175]
    ds_write_b128 v5, v[140:143] offset:128
    v_mfma_f32_16x16x32_bf16 v[176:179], v[104:107], v[236:239], v[176:179]
    ds_write_b128 v4, v[144:147] offset:16384
    v_mfma_f32_16x16x32_bf16 v[180:183], v[108:111], v[236:239], v[180:183]
    ds_write_b128 v5, v[148:151] offset:16384
    v_mfma_f32_16x16x32_bf16 v[184:187], v[112:115], v[236:239], v[184:187]
    ds_write_b128 v4, v[152:155] offset:16512
    v_mfma_f32_16x16x32_bf16 v[188:191], v[116:119], v[236:239], v[188:191]
    ds_write_b128 v5, v[156:159] offset:16512
    ds_write_b128 v4, v[160:163] offset:32768
    ds_write_b128 v5, v[164:167] offset:32768
    ds_write_b128 v4, v[168:171] offset:32896
    ds_write_b128 v5, v[172:175] offset:32896
    ds_write_b128 v4, v[176:179] offset:49152
    ds_write_b128 v5, v[180:183] offset:49152
    ds_write_b128 v4, v[184:187] offset:49280
    ds_write_b128 v5, v[188:191] offset:49280
L_red2:
    s_waitcnt vmcnt(0) lgkmcnt(0)
    s_barrier
    ds_read_b128 v[200:203], v12 offset:4096
    ds_read_b128 v[204:207], v13 offset:4096
    ds_read_b128 v[208:211], v12 offset:8192
    ds_read_b128 v[212:215], v13 offset:8192
    ds_read_b128 v[216:219], v12 offset:12288
    ds_read_b128 v[220:223], v13 offset:12288
    ds_read_b128 v[192:195], v12 offset:0
    ds_read_b128 v[196:199], v13 offset:0
    ds_read_b128 v[232:235], v12 offset:6144
    ds_read_b128 v[236:239], v13 offset:6144
    ds_read_b128 v[240:243], v12 offset:10240
    ds_read_b128 v[244:247], v13 offset:10240
    ds_read_b128 v[248:251], v12 offset:14336
    ds_read_b128 v[252:255], v13 offset:14336
    ds_read_b128 v[224:227], v12 offset:2048
    ds_read_b128 v[228:231], v13 offset:2048
    s_waitcnt lgkmcnt(12)
    v_pk_add_f32 v[200:201], v[200:201], v[208:209]
    v_pk_add_f32 v[202:203], v[202:203], v[210:211]
    v_pk_add_f32 v[204:205], v[204:205], v[212:213]
    v_pk_add_f32 v[206:207], v[206:207], v[214:215]
    s_waitcnt lgkmcnt(10)
    v_pk_add_f32 v[200:201], v[200:201], v[216:217]
    v_pk_add_f32 v[202:203], v[202:203], v[218:219]
    v_pk_add_f32 v[204:205], v[204:205], v[220:221]
    v_pk_add_f32 v[206:207], v[206:207], v[222:223]
    v_pk_mul_f32 v[208:209], v[200:201], s[78:79]
    v_pk_mul_f32 v[210:211], v[202:203], s[78:79]
    v_pk_mul_f32 v[212:213], v[204:205], s[78:79]
    v_pk_mul_f32 v[214:215], v[206:207], s[78:79]
    v_exp_f32 v208, v208
    v_exp_f32 v209, v209
    v_exp_f32 v210, v210
    v_exp_f32 v211, v211
    v_exp_f32 v212, v212
    v_exp_f32 v213, v213
    v_exp_f32 v214, v214
    v_exp_f32 v215, v215
    s_waitcnt lgkmcnt(8)
    v_pk_mul_f32 v[192:193], v[192:193], v[200:201]
    v_pk_mul_f32 v[194:195], v[194:195], v[202:203]
    v_pk_mul_f32 v[196:197], v[196:197], v[204:205]
    v_pk_mul_f32 v[198:199], v[198:199], v[206:207]
    v_pk_add_f32 v[208:209], v[208:209], 1.0 op_sel_hi:[1,0]
    v_pk_add_f32 v[210:211], v[210:211], 1.0 op_sel_hi:[1,0]
    v_pk_add_f32 v[212:213], v[212:213], 1.0 op_sel_hi:[1,0]
    v_pk_add_f32 v[214:215], v[214:215], 1.0 op_sel_hi:[1,0]
    v_rcp_f32 v208, v208
    v_rcp_f32 v209, v209
    v_rcp_f32 v210, v210
    v_rcp_f32 v211, v211
    v_rcp_f32 v212, v212
    v_rcp_f32 v213, v213
    v_rcp_f32 v214, v214
    v_rcp_f32 v215, v215
    v_pk_fma_f32 v[192:193], v[192:193], v[208:209], v[24:25]
    v_pk_fma_f32 v[194:195], v[194:195], v[210:211], v[26:27]
    v_pk_fma_f32 v[196:197], v[196:197], v[212:213], v[28:29]
    v_pk_fma_f32 v[198:199], v[198:199], v[214:215], v[30:31]
    v_cvt_pk_bf16_f32 v200, v192, v193
    v_cvt_pk_bf16_f32 v201, v194, v195
    v_cvt_pk_bf16_f32 v202, v196, v197
    v_cvt_pk_bf16_f32 v203, v198, v199
    buffer_store_dwordx4 v[200:203], v18, s[44:47], s76 offen sc1
    s_waitcnt lgkmcnt(4)
    v_pk_add_f32 v[232:233], v[232:233], v[240:241]
    v_pk_add_f32 v[234:235], v[234:235], v[242:243]
    v_pk_add_f32 v[236:237], v[236:237], v[244:245]
    v_pk_add_f32 v[238:239], v[238:239], v[246:247]
    s_waitcnt lgkmcnt(2)
    v_pk_add_f32 v[232:233], v[232:233], v[248:249]
    v_pk_add_f32 v[234:235], v[234:235], v[250:251]
    v_pk_add_f32 v[236:237], v[236:237], v[252:253]
    v_pk_add_f32 v[238:239], v[238:239], v[254:255]
    v_pk_mul_f32 v[240:241], v[232:233], s[78:79]
    v_pk_mul_f32 v[242:243], v[234:235], s[78:79]
    v_pk_mul_f32 v[244:245], v[236:237], s[78:79]
    v_pk_mul_f32 v[246:247], v[238:239], s[78:79]
    v_exp_f32 v240, v240
    v_exp_f32 v241, v241
    v_exp_f32 v242, v242
    v_exp_f32 v243, v243
    v_exp_f32 v244, v244
    v_exp_f32 v245, v245
    v_exp_f32 v246, v246
    v_exp_f32 v247, v247
    s_waitcnt lgkmcnt(0)
    v_pk_mul_f32 v[224:225], v[224:225], v[232:233]
    v_pk_mul_f32 v[226:227], v[226:227], v[234:235]
    v_pk_mul_f32 v[228:229], v[228:229], v[236:237]
    v_pk_mul_f32 v[230:231], v[230:231], v[238:239]
    v_pk_add_f32 v[240:241], v[240:241], 1.0 op_sel_hi:[1,0]
    v_pk_add_f32 v[242:243], v[242:243], 1.0 op_sel_hi:[1,0]
    v_pk_add_f32 v[244:245], v[244:245], 1.0 op_sel_hi:[1,0]
    v_pk_add_f32 v[246:247], v[246:247], 1.0 op_sel_hi:[1,0]
    v_rcp_f32 v240, v240
    v_rcp_f32 v241, v241
    v_rcp_f32 v242, v242
    v_rcp_f32 v243, v243
    v_rcp_f32 v244, v244
    v_rcp_f32 v245, v245
    v_rcp_f32 v246, v246
    v_rcp_f32 v247, v247
    v_pk_fma_f32 v[224:225], v[224:225], v[240:241], v[32:33]
    v_pk_fma_f32 v[226:227], v[226:227], v[242:243], v[34:35]
    v_pk_fma_f32 v[228:229], v[228:229], v[244:245], v[36:37]
    v_pk_fma_f32 v[230:231], v[230:231], v[246:247], v[38:39]
    v_cvt_pk_bf16_f32 v232, v224, v225
    v_cvt_pk_bf16_f32 v233, v226, v227
    v_cvt_pk_bf16_f32 v234, v228, v229
    v_cvt_pk_bf16_f32 v235, v230, v231
    buffer_store_dwordx4 v[232:235], v18, s[44:47], s77 offen sc1
L_exit:
    s_endpgm
L_retry_Hg:
    s_mov_b32 s94, 20000
L_retry_Hg_loop:
    s_nop 4
    buffer_load_dwordx2 v[44:45], v18, s[48:51], 0 offen sc1
    buffer_load_dwordx4 v[24:27], v21, s[48:51], s79 offen sc1
    buffer_load_dwordx4 v[28:31], v21, s[48:51], s80 offen sc1
    buffer_load_dwordx4 v[32:35], v19, s[48:51], s81 offen sc1
    buffer_load_dwordx4 v[36:39], v19, s[48:51], s82 offen sc1
    buffer_load_dwordx4 v[40:43], v19, s[48:51], s83 offen sc1
    s_waitcnt vmcnt(0)
    v_xor_b32 v80, s65, v45
    v_bitop3_b32 v80, v80, v25, s65 bitop3:0xf6
    v_bitop3_b32 v80, v80, v27, s65 bitop3:0xf6
    v_bitop3_b32 v80, v80, v29, s65 bitop3:0xf6
    v_bitop3_b32 v80, v80, v31, s65 bitop3:0xf6
    v_bitop3_b32 v80, v80, v33, s65 bitop3:0xf6
    v_bitop3_b32 v80, v80, v35, s65 bitop3:0xf6
    v_bitop3_b32 v80, v80, v37, s65 bitop3:0xf6
    v_bitop3_b32 v80, v80, v39, s65 bitop3:0xf6
    v_bitop3_b32 v80, v80, v41, s65 bitop3:0xf6
    v_bitop3_b32 v80, v80, v43, s65 bitop3:0xf6
    v_cmp_ne_u32 vcc, 0, v80
    s_cbranch_vccz L_back_Hg
    s_sub_u32 s94, s94, 1
    s_cmp_lg_u32 s94, 0
    s_cbranch_scc1 L_retry_Hg_loop
    s_branch L_back_Hg
L_retry_cpH:
    s_mov_b32 s94, 20000
L_retry_cpH_loop:
    s_nop 4
    buffer_load_dwordx2 v[4:5], v21, s[48:51], s0 offen sc1
    s_waitcnt vmcnt(0)
    v_xor_b32 v15, v22, v4
    v_bitop3_b32 v15, v15, v5, v22 bitop3:0xf6
    v_cmp_ne_u32 vcc, 0, v15
    s_cbranch_vccz L_back_cpH
    s_sub_u32 s94, s94, 1
    s_cmp_lg_u32 s94, 0
    s_cbranch_scc1 L_retry_cpH_loop
    s_branch L_back_cpH
L_retry_paH:
    s_mov_b32 s94, 20000
L_retry_paH_loop:
    s_nop 4
    buffer_load_dwordx2 v[48:49], v21, s[48:51], s90 offen sc1
    s_waitcnt vmcnt(0)
    v_xor_b32 v15, s65, v48
    v_bitop3_b32 v15, v15, v49, s66 bitop3:0xf6
    v_cmp_ne_u32 vcc, 0, v15
    s_cbranch_vccz L_back_paH
    s_sub_u32 s94, s94, 1
    s_cmp_lg_u32 s94, 0
    s_cbranch_scc1 L_retry_paH_loop
    s_branch L_back_paH
L_retry_Qg:
    s_mov_b32 s94, 20000
L_retry_Qg_loop:
    s_nop 4
    buffer_load_dwordx2 v[44:45], v18, s[48:51], 0 offen sc1
    buffer_load_dwordx4 v[24:27], v19, s[48:51], s79 offen sc1
    buffer_load_dwordx4 v[28:31], v19, s[48:51], s80 offen sc1
    buffer_load_dwordx4 v[32:35], v19, s[48:51], s81 offen sc1
    buffer_load_dwordx4 v[36:39], v19, s[48:51], s82 offen sc1
    buffer_load_dwordx4 v[40:43], v21, s[48:51], s83 offen sc1
    s_waitcnt vmcnt(0)
    v_xor_b32 v80, s65, v45
    v_bitop3_b32 v80, v80, v25, s65 bitop3:0xf6
    v_bitop3_b32 v80, v80, v27, s65 bitop3:0xf6
    v_bitop3_b32 v80, v80, v29, s65 bitop3:0xf6
    v_bitop3_b32 v80, v80, v31, s65 bitop3:0xf6
    v_bitop3_b32 v80, v80, v33, s65 bitop3:0xf6
    v_bitop3_b32 v80, v80, v35, s65 bitop3:0xf6
    v_bitop3_b32 v80, v80, v37, s65 bitop3:0xf6
    v_bitop3_b32 v80, v80, v39, s65 bitop3:0xf6
    v_bitop3_b32 v80, v80, v41, s65 bitop3:0xf6
    v_bitop3_b32 v80, v80, v43, s65 bitop3:0xf6
    v_cmp_ne_u32 vcc, 0, v80
    s_cbranch_vccz L_back_Qg
    s_sub_u32 s94, s94, 1
    s_cmp_lg_u32 s94, 0
    s_cbranch_scc1 L_retry_Qg_loop
    s_branch L_back_Qg
L_retry_cpQ:
    s_mov_b32 s94, 20000
L_retry_cpQ_loop:
    s_nop 4
    buffer_load_dwordx2 v[4:5], v21, s[48:51], s0 offen sc1
    s_waitcnt vmcnt(0)
    v_xor_b32 v15, v22, v4
    v_bitop3_b32 v15, v15, v5, v22 bitop3:0xf6
    v_cmp_ne_u32 vcc, 0, v15
    s_cbranch_vccz L_back_cpQ
    s_sub_u32 s94, s94, 1
    s_cmp_lg_u32 s94, 0
    s_cbranch_scc1 L_retry_cpQ_loop
    s_branch L_back_cpQ
L_retry_kvf:
    s_mov_b32 s94, 20000
L_retry_kvf_loop:
    s_nop 4
    buffer_load_dwordx2 v[46:47], v19, s[48:51], s92 offen sc1
    s_waitcnt vmcnt(0)
    v_xor_b32 v15, s65, v46
    v_bitop3_b32 v15, v15, v47, s66 bitop3:0xf6
    v_cmp_ne_u32 vcc, 0, v15
    s_cbranch_vccz L_back_kvf
    s_sub_u32 s94, s94, 1
    s_cmp_lg_u32 s94, 0
    s_cbranch_scc1 L_retry_kvf_loop
    s_branch L_back_kvf
L_retry_paQ:
    s_mov_b32 s94, 20000
L_retry_paQ_loop:
    s_nop 4
    buffer_load_dwordx2 v[48:49], v21, s[48:51], s90 offen sc1
    s_waitcnt vmcnt(0)
    v_xor_b32 v15, s65, v48
    v_bitop3_b32 v15, v15, v49, s66 bitop3:0xf6
    v_cmp_ne_u32 vcc, 0, v15
    s_cbranch_vccz L_back_paQ
    s_sub_u32 s94, s94, 1
    s_cmp_lg_u32 s94, 0
    s_cbranch_scc1 L_retry_paQ_loop
    s_branch L_back_paQ
L_w13:
    s_waitcnt vmcnt(10)
    v_mfma_f32_16x16x32_bf16 v[128:131], a[208:211], v[208:211], v[128:131]
    v_mfma_f32_16x16x32_bf16 v[132:135], a[212:215], v[208:211], v[132:135]
    v_mfma_f32_16x16x32_bf16 v[136:139], a[216:219], v[208:211], v[136:139]
    v_mfma_f32_16x16x32_bf16 v[140:143], a[220:223], v[208:211], v[140:143]
    v_mfma_f32_16x16x32_bf16 v[144:147], a[208:211], v[212:215], v[144:147]
    v_mfma_f32_16x16x32_bf16 v[148:151], a[212:215], v[212:215], v[148:151]
    v_mfma_f32_16x16x32_bf16 v[152:155], a[216:219], v[212:215], v[152:155]
    v_mfma_f32_16x16x32_bf16 v[156:159], a[220:223], v[212:215], v[156:159]
    s_waitcnt vmcnt(8)
    v_mfma_f32_16x16x32_bf16 v[160:163], a[208:211], v[216:219], v[160:163]
    v_mfma_f32_16x16x32_bf16 v[164:167], a[212:215], v[216:219], v[164:167]
    v_mfma_f32_16x16x32_bf16 v[168:171], a[216:219], v[216:219], v[168:171]
    v_mfma_f32_16x16x32_bf16 v[172:175], a[220:223], v[216:219], v[172:175]
    v_mfma_f32_16x16x32_bf16 v[176:179], a[208:211], v[220:223], v[176:179]
    v_mfma_f32_16x16x32_bf16 v[180:183], a[212:215], v[220:223], v[180:183]
    v_mfma_f32_16x16x32_bf16 v[184:187], a[216:219], v[220:223], v[184:187]
    v_mfma_f32_16x16x32_bf16 v[188:191], a[220:223], v[220:223], v[188:191]
    s_waitcnt vmcnt(6)
    v_mfma_f32_16x16x32_bf16 v[128:131], a[224:227], v[224:227], v[128:131]
    v_mfma_f32_16x16x32_bf16 v[132:135], a[228:231], v[224:227], v[132:135]
    v_mfma_f32_16x16x32_bf16 v[136:139], a[232:235], v[224:227], v[136:139]
    v_mfma_f32_16x16x32_bf16 v[140:143], a[236:239], v[224:227], v[140:143]
    v_mfma_f32_16x16x32_bf16 v[144:147], a[224:227], v[228:231], v[144:147]
    v_mfma_f32_16x16x32_bf16 v[148:151], a[228:231], v[228:231], v[148:151]
    v_mfma_f32_16x16x32_bf16 v[152:155], a[232:235], v[228:231], v[152:155]
    v_mfma_f32_16x16x32_bf16 v[156:159], a[236:239], v[228:231], v[156:159]
    s_waitcnt vmcnt(4)
    v_mfma_f32_16x16x32_bf16 v[160:163], a[224:227], v[232:235], v[160:163]
    v_mfma_f32_16x16x32_bf16 v[164:167], a[228:231], v[232:235], v[164:167]
    v_mfma_f32_16x16x32_bf16 v[168:171], a[232:235], v[232:235], v[168:171]
    v_mfma_f32_16x16x32_bf16 v[172:175], a[236:239], v[232:235], v[172:175]
    v_mfma_f32_16x16x32_bf16 v[176:179], a[224:227], v[236:239], v[176:179]
    v_mfma_f32_16x16x32_bf16 v[180:183], a[228:231], v[236:239], v[180:183]
    v_mfma_f32_16x16x32_bf16 v[184:187], a[232:235], v[236:239], v[184:187]
    v_mfma_f32_16x16x32_bf16 v[188:191], a[236:239], v[236:239], v[188:191]
    s_waitcnt vmcnt(2)
    v_mfma_f32_16x16x32_bf16 v[128:131], a[240:243], v[240:243], v[128:131]
    v_mfma_f32_16x16x32_bf16 v[132:135], a[244:247], v[240:243], v[132:135]
    v_mfma_f32_16x16x32_bf16 v[136:139], a[248:251], v[240:243], v[136:139]
    v_mfma_f32_16x16x32_bf16 v[140:143], a[252:255], v[240:243], v[140:143]
    v_mfma_f32_16x16x32_bf16 v[144:147], a[240:243], v[244:247], v[144:147]
    v_mfma_f32_16x16x32_bf16 v[148:151], a[244:247], v[244:247], v[148:151]
    v_mfma_f32_16x16x32_bf16 v[152:155], a[248:251], v[244:247], v[152:155]
    v_mfma_f32_16x16x32_bf16 v[156:159], a[252:255], v[244:247], v[156:159]
    s_waitcnt vmcnt(0)
    v_mfma_f32_16x16x32_bf16 v[160:163], a[240:243], v[248:251], v[160:163]
    ds_write_b128 v4, v[128:131] offset:0
    v_mfma_f32_16x16x32_bf16 v[164:167], a[244:247], v[248:251], v[164:167]
    ds_write_b128 v5, v[132:135] offset:0
    v_mfma_f32_16x16x32_bf16 v[168:171], a[248:251], v[248:251], v[168:171]
    ds_write_b128 v4, v[136:139] offset:128
    v_mfma_f32_16x16x32_bf16 v[172:175], a[252:255], v[248:251], v[172:175]
    ds_write_b128 v5, v[140:143] offset:128
    v_mfma_f32_16x16x32_bf16 v[176:179], a[240:243], v[252:255], v[176:179]
    ds_write_b128 v4, v[144:147] offset:16384
    v_mfma_f32_16x16x32_bf16 v[180:183], a[244:247], v[252:255], v[180:183]
    ds_write_b128 v5, v[148:151] offset:16384
    v_mfma_f32_16x16x32_bf16 v[184:187], a[248:251], v[252:255], v[184:187]
    ds_write_b128 v4, v[152:155] offset:16512
    v_mfma_f32_16x16x32_bf16 v[188:191], a[252:255], v[252:255], v[188:191]
    ds_write_b128 v5, v[156:159] offset:16512
    ds_write_b128 v4, v[160:163] offset:32768
    ds_write_b128 v5, v[164:167] offset:32768
    ds_write_b128 v4, v[168:171] offset:32896
    ds_write_b128 v5, v[172:175] offset:32896
    ds_write_b128 v4, v[176:179] offset:49152
    ds_write_b128 v5, v[180:183] offset:49152
    ds_write_b128 v4, v[184:187] offset:49280
    ds_write_b128 v5, v[188:191] offset:49280
    s_branch L_red2
L_w15:
    s_waitcnt vmcnt(10)
    v_mfma_f32_16x16x32_bf16 v[128:131], a[240:243], v[240:243], v[128:131]
    v_mfma_f32_16x16x32_bf16 v[132:135], a[244:247], v[240:243], v[132:135]
    v_mfma_f32_16x16x32_bf16 v[136:139], a[248:251], v[240:243], v[136:139]
    v_mfma_f32_16x16x32_bf16 v[140:143], a[252:255], v[240:243], v[140:143]
    v_mfma_f32_16x16x32_bf16 v[144:147], a[240:243], v[244:247], v[144:147]
    v_mfma_f32_16x16x32_bf16 v[148:151], a[244:247], v[244:247], v[148:151]
    v_mfma_f32_16x16x32_bf16 v[152:155], a[248:251], v[244:247], v[152:155]
    v_mfma_f32_16x16x32_bf16 v[156:159], a[252:255], v[244:247], v[156:159]
    s_waitcnt vmcnt(8)
    v_mfma_f32_16x16x32_bf16 v[160:163], a[240:243], v[248:251], v[160:163]
    v_mfma_f32_16x16x32_bf16 v[164:167], a[244:247], v[248:251], v[164:167]
    v_mfma_f32_16x16x32_bf16 v[168:171], a[248:251], v[248:251], v[168:171]
    v_mfma_f32_16x16x32_bf16 v[172:175], a[252:255], v[248:251], v[172:175]
    v_mfma_f32_16x16x32_bf16 v[176:179], a[240:243], v[252:255], v[176:179]
    v_mfma_f32_16x16x32_bf16 v[180:183], a[244:247], v[252:255], v[180:183]
    v_mfma_f32_16x16x32_bf16 v[184:187], a[248:251], v[252:255], v[184:187]
    v_mfma_f32_16x16x32_bf16 v[188:191], a[252:255], v[252:255], v[188:191]
    s_waitcnt vmcnt(6)
    v_mfma_f32_16x16x32_bf16 v[128:131], v[72:75], v[192:195], v[128:131]
    v_mfma_f32_16x16x32_bf16 v[132:135], v[76:79], v[192:195], v[132:135]
    v_mfma_f32_16x16x32_bf16 v[136:139], v[80:83], v[192:195], v[136:139]
    v_mfma_f32_16x16x32_bf16 v[140:143], v[84:87], v[192:195], v[140:143]
    v_mfma_f32_16x16x32_bf16 v[144:147], v[72:75], v[196:199], v[144:147]
    v_mfma_f32_16x16x32_bf16 v[148:151], v[76:79], v[196:199], v[148:151]
    v_mfma_f32_16x16x32_bf16 v[152:155], v[80:83], v[196:199], v[152:155]
    v_mfma_f32_16x16x32_bf16 v[156:159], v[84:87], v[196:199], v[156:159]
    s_waitcnt vmcnt(4)
    v_mfma_f32_16x16x32_bf16 v[160:163], v[72:75], v[200:203], v[160:163]
    v_mfma_f32_16x16x32_bf16 v[164:167], v[76:79], v[200:203], v[164:167]
    v_mfma_f32_16x16x32_bf16 v[168:171], v[80:83], v[200:203], v[168:171]
    v_mfma_f32_16x16x32_bf16 v[172:175], v[84:87], v[200:203], v[172:175]
    v_mfma_f32_16x16x32_bf16 v[176:179], v[72:75], v[204:207], v[176:179]
    v_mfma_f32_16x16x32_bf16 v[180:183], v[76:79], v[204:207], v[180:183]
    v_mfma_f32_16x16x32_bf16 v[184:187], v[80:83], v[204:207], v[184:187]
    v_mfma_f32_16x16x32_bf16 v[188:191], v[84:87], v[204:207], v[188:191]
    s_waitcnt vmcnt(2)
    v_mfma_f32_16x16x32_bf16 v[128:131], v[88:91], v[208:211], v[128:131]
    v_mfma_f32_16x16x32_bf16 v[132:135], v[92:95], v[208:211], v[132:135]
    v_mfma_f32_16x16x32_bf16 v[136:139], v[96:99], v[208:211], v[136:139]
    v_mfma_f32_16x16x32_bf16 v[140:143], v[100:103], v[208:211], v[140:143]
    v_mfma_f32_16x16x32_bf16 v[144:147], v[88:91], v[212:215], v[144:147]
    v_mfma_f32_16x16x32_bf16 v[148:151], v[92:95], v[212:215], v[148:151]
    v_mfma_f32_16x16x32_bf16 v[152:155], v[96:99], v[212:215], v[152:155]
    v_mfma_f32_16x16x32_bf16 v[156:159], v[100:103], v[212:215], v[156:159]
    s_waitcnt vmcnt(0)
    v_mfma_f32_16x16x32_bf16 v[160:163], v[88:91], v[216:219], v[160:163]
    ds_write_b128 v4, v[128:131] offset:0
    v_mfma_f32_16x16x32_bf16 v[164:167], v[92:95], v[216:219], v[164:167]
    ds_write_b128 v5, v[132:135] offset:0
    v_mfma_f32_16x16x32_bf16 v[168:171], v[96:99], v[216:219], v[168:171]
    ds_write_b128 v4, v[136:139] offset:128
    v_mfma_f32_16x16x32_bf16 v[172:175], v[100:103], v[216:219], v[172:175]
    ds_write_b128 v5, v[140:143] offset:128
    v_mfma_f32_16x16x32_bf16 v[176:179], v[88:91], v[220:223], v[176:179]
    ds_write_b128 v4, v[144:147] offset:16384
    v_mfma_f32_16x16x32_bf16 v[180:183], v[92:95], v[220:223], v[180:183]
    ds_write_b128 v5, v[148:151] offset:16384
    v_mfma_f32_16x16x32_bf16 v[184:187], v[96:99], v[220:223], v[184:187]
    ds_write_b128 v4, v[152:155] offset:16512
    v_mfma_f32_16x16x32_bf16 v[188:191], v[100:103], v[220:223], v[188:191]
    ds_write_b128 v5, v[156:159] offset:16512
    ds_write_b128 v4, v[160:163] offset:32768
    ds_write_b128 v5, v[164:167] offset:32768
    ds_write_b128 v4, v[168:171] offset:32896
    ds_write_b128 v5, v[172:175] offset:32896
    ds_write_b128 v4, v[176:179] offset:49152
    ds_write_b128 v5, v[180:183] offset:49152
    ds_write_b128 v4, v[184:187] offset:49280
    ds_write_b128 v5, v[188:191] offset:49280
    s_branch L_red2
L_codeend:
.section .rodata,"a"
.p2align 6
.amdhsa_kernel recurrent_scan__linear_attn_block__glu_gated_glu__prompt_kernel
  .amdhsa_next_free_vgpr 512
  .amdhsa_next_free_sgpr 102
  .amdhsa_accum_offset 256
  .amdhsa_group_segment_fixed_size 0
  .amdhsa_kernarg_size 80
  .amdhsa_user_sgpr_count 2
  .amdhsa_user_sgpr_kernarg_segment_ptr 1
  .amdhsa_system_sgpr_workgroup_id_x 1
  .amdhsa_float_denorm_mode_32 3
.end_amdhsa_kernel
```
